```python
import torch

def _softmax(x, axis=-1):
    return torch.softmax(x, dim=axis)

def _gelu(x):
    return torch.nn.functional.gelu(x, approximate='tanh')

def _silu(x):
    return torch.nn.functional.silu(x)

def _sigmoid(x):
    return torch.sigmoid(x)

def _layernorm(x, axis=-1, eps=1e-05):
    m = x.mean(dim=axis, keepdim=True)
    v = x.var(dim=axis, keepdim=True, unbiased=False)
    return (x - m) / torch.sqrt(v + eps)

def _scatter_add(tgt, idx, src, axis=0):
    return tgt.clone().index_add_(axis, idx, src)

def _segment_sum(src, seg, n):
    out = torch.zeros((n,) + src.shape[1:], dtype=src.dtype)
    return out.index_add_(0, seg, src)

def _pad(x, pw):
    flat = tuple((v for pair in reversed(pw) for v in pair))
    return torch.nn.functional.pad(x, flat)
kernel_name = 'sequential_preLN__softmax_full_mha__mixer_gmlp__prompt'

def setup_inputs():

    _w = lambda a: (lambda t: t.to(torch.bfloat16) if t.is_floating_point() else t)(torch.as_tensor(a))

    def _A_setup():
        B, S, D = (1, 2048, 448)
        return {'x': _w((lambda *s: torch.randn(*s, dtype=torch.bfloat16) * 0.05)(B, S, D)), 'wqkv': _w((lambda *s: torch.randn(*s, dtype=torch.bfloat16) * 0.05)(D, 3 * D)), 'wo': _w((lambda *s: torch.randn(*s, dtype=torch.bfloat16) * 0.05)(D, D))}
    _A_in = _A_setup()

    def _B_setup():
        B, S, D, F = (1, 2048, 448, 1792)
        Fh = F // 2
        return {'x': _w((lambda *s: torch.randn(*s, dtype=torch.bfloat16) * 0.05)(B, S, D)), 'w_in': _w((lambda *s: torch.randn(*s, dtype=torch.bfloat16) * 0.4)(D, 2 * Fh)), 'w_sp': _w(0.01 * (lambda *s: torch.randn(*s, dtype=torch.bfloat16) * 0.4)(S, S)), 'b_sp': _w(1.0 + 0.01 * (lambda *s: torch.randn(*s, dtype=torch.bfloat16) * 0.05)(S)), 'w_out': _w((lambda *s: torch.randn(*s, dtype=torch.bfloat16) * 0.05)(Fh, D))}
    _B_in = _B_setup()
    return {'A_x': _A_in['x'], 'A_wqkv': _A_in['wqkv'], 'A_wo': _A_in['wo'], 'B_x': _B_in['x'], 'B_w_in': _B_in['w_in'], 'B_w_sp': _B_in['w_sp'], 'B_b_sp': _B_in['b_sp'], 'B_w_out': _B_in['w_out']}

def reference(A_x, A_wqkv, A_wo, B_x, B_w_in, B_w_sp, B_b_sp, B_w_out):

    def _A_ref(x, wqkv, wo):
        B, S, D = x.shape
        H = 16
        Dh = D // H
        qkv = (lambda x, *d: x.permute(*d))((x @ wqkv).reshape(B, S, 3, H, Dh), 2, 0, 3, 1, 4)
        q, k, v = (qkv[0], qkv[1], qkv[2])
        scale = Dh ** (-0.5)
        scores = torch.einsum('bhqd,bhkd->bhqk', q, k) * scale
        p = _softmax(scores, axis=-1)
        o = torch.einsum('bhqk,bhkd->bhqd', p, v)
        return (lambda x, *d: x.permute(*d))(o, 0, 2, 1, 3).reshape(B, S, D) @ wo

    def _B_ref(x, w_in, w_sp, b_sp, w_out):
        B, S, D = x.shape
        F = w_in.shape[-1]
        Fh = F // 2
        z = _gelu(torch.einsum('bsd,df->bsf', x, w_in))
        z1 = z[..., :Fh].clone()
        z2 = _layernorm(z[..., Fh:], axis=-1)
        g = torch.einsum('ts,bsf->btf', w_sp, z2) + b_sp[None, :, None]
        return torch.einsum('bsf,fd->bsd', z1 * g, w_out)
    x = A_x
    h = x + _A_ref(_layernorm(x, axis=-1), A_wqkv, A_wo)
    h2 = h + _B_ref(_layernorm(h, axis=-1), B_w_in, B_w_sp, B_b_sp, B_w_out)
    return h2
```

```asm
; @launch grid=(256,1,1) block=(256,1,1) lds=163840
.amdgcn_target "amdgcn-amd-amdhsa--gfx950"
.text
.globl sequential_preLN__softmax_full_mha__mixer_gmlp__prompt_kernel
.p2align 8
.type sequential_preLN__softmax_full_mha__mixer_gmlp__prompt_kernel,@function
sequential_preLN__softmax_full_mha__mixer_gmlp__prompt_kernel:
    s_cmp_ge_u32 s2, 256
    s_cbranch_scc1 L_end
    s_load_dwordx2 s[4:5], s[0:1], 0
    s_load_dwordx2 s[8:9], s[0:1], 8
    s_load_dwordx2 s[36:37], s[0:1], 80
    s_load_dwordx2 s[16:17], s[0:1], 32
    s_load_dwordx2 s[12:13], s[0:1], 16
    s_load_dwordx2 s[20:21], s[0:1], 40
    s_load_dwordx2 s[24:25], s[0:1], 48
    s_load_dwordx2 s[28:29], s[0:1], 56
    s_load_dwordx2 s[32:33], s[0:1], 64
    s_getpc_b64 s[52:53]
L_pc_1:
    s_sub_u32 s52, s52, L_pc_1-sequential_preLN__softmax_full_mha__mixer_gmlp__prompt_kernel
    s_subb_u32 s53, s53, 0
    s_bfe_u32 s54, s2, 0x30003
    s_lshl_b32 s54, s54, 13
    v_lshrrev_b32 v240, 2, v0
    v_lshlrev_b32 v240, 7, v240
    v_add_u32 v240, s54, v240
    v_min_u32 v240, L_end-sequential_preLN__softmax_full_mha__mixer_gmlp__prompt_kernel, v240
    global_load_dword v241, v240, s[52:53]
    s_mov_b32 s6, 0x1c0000
    s_mov_b32 s7, 0x20000
    s_mov_b32 s10, 0x126000
    s_mov_b32 s11, 0x20000
    s_mov_b32 s38, 0x1700000
    s_mov_b32 s39, 0x20000
    s_mov_b32 s18, 0x188000
    s_mov_b32 s19, 0x20000
    s_mov_b32 s14, 0x62000
    s_mov_b32 s15, 0x20000
    s_mov_b32 s22, 0x800000
    s_mov_b32 s23, 0x20000
    s_mov_b32 s26, 0x1000
    s_mov_b32 s27, 0x20000
    s_mov_b32 s30, 0xc4000
    s_mov_b32 s31, 0x20000
    s_mov_b32 s34, 0x1c0000
    s_mov_b32 s35, 0x20000
    v_lshrrev_b32 v2, 6, v0
    v_and_b32 v1, 63, v0
    v_readfirstlane_b32 s40, v2
    s_and_b32 s48, s2, 7
    s_lshr_b32 s49, s2, 3
    s_lshl_b32 s41, s48, 2
    s_lshr_b32 s50, s49, 3
    s_add_u32 s41, s41, s50
    s_and_b32 s42, s49, 7
    s_mov_b32 s64, 0
    s_mov_b32 s65, -1
    s_mov_b32 s71, 0
    s_lshr_b32 s41, s48, 1
    s_lshl_b32 s41, s41, 3
    s_lshr_b32 s50, s49, 2
    s_add_u32 s41, s41, s50
    s_and_b32 s42, s48, 1
    s_lshl_b32 s42, s42, 2
    s_and_b32 s50, s49, 3
    s_add_u32 s42, s42, s50
    s_lshl_b32 s43, s48, 1
    s_lshr_b32 s50, s49, 4
    s_add_u32 s43, s43, s50
    s_and_b32 s44, s49, 15
    s_cmp_eq_u32 s42, 7
    s_cbranch_scc1 L_colsum
    v_lshrrev_b32 v11, 3, v1
    v_and_b32 v12, 7, v1
    v_lshrrev_b32 v13, 1, v11
    s_and_b32 s56, s40, 1
    s_lshl_b32 s48, s56, 2
    v_xor_b32 v13, s48, v13
    v_xor_b32 v13, v12, v13
    v_mul_u32_u24 v2, 896, v11
    v_lshl_add_u32 v2, v13, 4, v2
    s_lshl_b32 s49, s41, 3
    s_add_u32 s49, s49, s40
    s_mul_i32 s49, s49, 7168
    v_lshlrev_b32 v13, 1, v11
    v_and_b32 v13, 4, v13
    v_xor_b32 v12, v12, v13
    v_mul_u32_u24 v3, 2688, v11
    v_lshl_add_u32 v3, v12, 4, v3
    s_mul_i32 s50, s40, 21504
    s_lshl_b32 s48, s42, 7
    s_add_u32 s50, s50, s48
    s_lshl_b32 s51, s40, 10
    v_cmp_gt_u32 vcc, 42, v0
    v_mul_u32_u24 v11, 86, v0
    v_lshrrev_b32 v11, 8, v11
    v_mul_u32_u24 v12, 3, v11
    v_sub_u32 v12, v0, v12
    v_mul_u32_u24 v11, 2688, v11
    v_mul_u32_u24 v12, 896, v12
    v_add_u32 v11, v11, v12
    v_mov_b32 v12, 0x40000000
    v_cndmask_b32 v231, v12, v11, vcc
    s_mul_i32 s54, s41, 37632
    s_add_u32 s54, s54, s48
    s_waitcnt lgkmcnt(0)
    buffer_load_dword v241, v231, s[8:11], s54 offen
    s_add_u32 s52, s49, 28672
    s_add_u32 m0, s51, 98304
    s_nop 0
    buffer_load_dwordx4 v2, s[4:7], s49 offen offset:0 lds
    s_add_u32 m0, s51, 102400
    s_nop 0
    buffer_load_dwordx4 v2, s[4:7], s52 offen offset:0 lds
    s_add_u32 m0, s51, 0
    s_add_u32 s63, s50, 0
    buffer_load_dwordx4 v3, s[8:11], s63 offen offset:0 lds
    s_add_u32 m0, s51, 7296
    s_nop 0
    buffer_load_dwordx4 v3, s[8:11], s63 offen offset:896 lds
    s_add_u32 m0, s51, 14592
    s_nop 0
    buffer_load_dwordx4 v3, s[8:11], s63 offen offset:1792 lds
    s_add_u32 m0, s51, 4096
    s_add_u32 s63, s50, 86016
    buffer_load_dwordx4 v3, s[8:11], s63 offen offset:0 lds
    s_add_u32 m0, s51, 11392
    s_nop 0
    buffer_load_dwordx4 v3, s[8:11], s63 offen offset:896 lds
    s_add_u32 m0, s51, 18688
    s_nop 0
    buffer_load_dwordx4 v3, s[8:11], s63 offen offset:1792 lds
    s_add_u32 m0, s51, 106368
    s_nop 0
    buffer_load_dwordx4 v2, s[4:7], s49 offen offset:128 lds
    s_add_u32 m0, s51, 110464
    s_nop 0
    buffer_load_dwordx4 v2, s[4:7], s52 offen offset:128 lds
    s_add_u32 m0, s51, 24576
    s_add_u32 s63, s50, 172032
    buffer_load_dwordx4 v3, s[8:11], s63 offen offset:0 lds
    s_add_u32 m0, s51, 31872
    s_nop 0
    buffer_load_dwordx4 v3, s[8:11], s63 offen offset:896 lds
    s_add_u32 m0, s51, 39168
    s_nop 0
    buffer_load_dwordx4 v3, s[8:11], s63 offen offset:1792 lds
    s_add_u32 m0, s51, 28672
    s_add_u32 s63, s50, 258048
    buffer_load_dwordx4 v3, s[8:11], s63 offen offset:0 lds
    s_add_u32 m0, s51, 35968
    s_nop 0
    buffer_load_dwordx4 v3, s[8:11], s63 offen offset:896 lds
    s_add_u32 m0, s51, 43264
    s_nop 0
    buffer_load_dwordx4 v3, s[8:11], s63 offen offset:1792 lds
    s_load_dword s46, s[36:37], 0
    s_add_u32 m0, s51, 114432
    s_nop 0
    buffer_load_dwordx4 v2, s[4:7], s49 offen offset:256 lds
    v_lshrrev_b32 v8, 5, v1
    v_and_b32 v9, 31, v1
    s_lshr_b32 s55, s40, 1
    s_lshl_b32 s57, s55, 12
    s_add_u32 s57, s57, 98304
    v_lshlrev_b32 v10, 7, v9
    v_add_u32 v10, s57, v10
    v_bfe_u32 v11, v9, 1, 3
    v_xor_b32 v11, v8, v11
    v_xor_b32 v12, 0, v11
    v_lshl_add_u32 v172, v12, 4, v10
    v_xor_b32 v12, 2, v11
    v_lshl_add_u32 v173, v12, 4, v10
    v_xor_b32 v12, 4, v11
    v_lshl_add_u32 v174, v12, 4, v10
    v_xor_b32 v12, 6, v11
    v_lshl_add_u32 v175, v12, 4, v10
    s_add_u32 m0, s51, 118528
    s_nop 0
    buffer_load_dwordx4 v2, s[4:7], s52 offen offset:256 lds
    v_bfe_u32 v10, v1, 2, 2
    v_and_b32 v11, 3, v1
    v_bfe_u32 v12, v1, 4, 1
    v_lshl_add_u32 v13, v8, 3, v10
    v_lshlrev_b32 v13, 7, v13
    v_lshrrev_b32 v10, 1, v10
    v_xor_b32 v10, s56, v10
    v_lshl_add_u32 v13, v10, 6, v13
    v_lshl_add_u32 v14, v12, 2, v11
    v_lshl_add_u32 v7, v14, 3, v13
    v_and_b32 v15, 1, v14
    v_lshrrev_b32 v14, 1, v14
    v_lshl_add_u32 v14, v15, 2, v14
    v_lshl_add_u32 v6, v14, 3, v13
    s_lshl_b32 s58, s42, 1
    s_add_u32 s58, s58, s56
    s_add_u32 m0, s51, 49152
    s_add_u32 s63, s50, 344064
    buffer_load_dwordx4 v3, s[8:11], s63 offen offset:0 lds
    s_lshl_b32 s59, s41, 1
    s_add_u32 s59, s59, s55
    s_lshl_b32 s57, s59, 9
    s_add_u32 s57, s57, 196608
    v_lshl_add_u32 v237, v9, 4, s57
    s_lshl_b32 s57, s58, 8
    s_add_u32 s57, s57, 40960
    v_lshl_add_u32 v239, v9, 3, s57
    v_add_u32 v239, 7168, v239
    v_lshrrev_b32 v10, 2, v9
    v_and_b32 v11, 1, v10
    v_lshrrev_b32 v10, 1, v10
    v_lshl_add_u32 v10, v11, 2, v10
    v_and_b32 v11, 3, v9
    v_lshl_add_u32 v10, v10, 2, v11
    v_lshl_add_u32 v238, v10, 3, s57
    s_lshl_b32 s59, s59, 12
    s_add_u32 m0, s51, 56448
    s_nop 0
    buffer_load_dwordx4 v3, s[8:11], s63 offen offset:896 lds
    s_lshl_b32 s60, s58, 2
    v_lshl_add_u32 v10, v8, 1, s60
    v_lshlrev_b32 v15, 4, v9
    v_mov_b32 v234, 0x40000000
    v_mul_u32_u24 v11, 37, v10
    v_lshrrev_b32 v11, 8, v11
    v_mul_u32_u24 v12, 7, v11
    v_sub_u32 v12, v10, v12
    v_lshrrev_b32 v13, 2, v12
    v_and_b32 v14, 3, v12
    v_lshl_add_u32 v13, v11, 1, v13
    v_lshlrev_b32 v13, 18, v13
    v_lshl_add_u32 v13, v14, 9, v13
    v_add_u32 v232, v13, v15
    v_cmp_eq_u32 s[66:67], 3, v12
    v_add_u32 v13, 0x40000, v232
    s_add_u32 m0, s51, 63744
    s_nop 0
    buffer_load_dwordx4 v3, s[8:11], s63 offen offset:1792 lds
    v_cndmask_b32 v234, v234, v13, s[66:67]
    v_add_u32 v10, 1, v10
    v_mul_u32_u24 v11, 37, v10
    v_lshrrev_b32 v11, 8, v11
    v_mul_u32_u24 v12, 7, v11
    v_sub_u32 v12, v10, v12
    v_lshrrev_b32 v13, 2, v12
    v_and_b32 v14, 3, v12
    v_lshl_add_u32 v13, v11, 1, v13
    v_lshlrev_b32 v13, 18, v13
    v_lshl_add_u32 v13, v14, 9, v13
    v_add_u32 v233, v13, v15
    v_cmp_eq_u32 s[68:69], 3, v12
    v_add_u32 v13, 0x40000, v233
    s_nop 0
    v_cndmask_b32 v234, v234, v13, s[68:69]
    s_lshl_b32 s60, s58, 5
    v_add_u32 v10, s60, v9
    s_add_u32 m0, s51, 53248
    s_add_u32 s63, s50, 430080
    buffer_load_dwordx4 v3, s[8:11], s63 offen offset:0 lds
    v_mul_u32_u24 v11, 586, v10
    v_lshrrev_b32 v11, 14, v11
    v_mul_u32_u24 v12, 28, v11
    v_sub_u32 v12, v10, v12
    v_lshlrev_b32 v11, 18, v11
    v_lshl_add_u32 v11, v8, 9, v11
    v_lshl_add_u32 v235, v12, 4, v11
    v_subrev_u32 v13, 20, v12
    v_and_b32 v14, 3, v13
    v_lshrrev_b32 v10, 2, v13
    v_lshl_add_u32 v11, v10, 10, v11
    v_lshl_add_u32 v11, v14, 4, v11
    v_add_u32 v11, 448, v11
    v_mov_b32 v10, 0x40000000
    v_cmp_gt_u32 vcc, 8, v13
    s_nop 1
    v_cndmask_b32 v236, v10, v11, vcc
    s_add_u32 m0, s51, 60544
    s_nop 0
    buffer_load_dwordx4 v3, s[8:11], s63 offen offset:896 lds
    v_mov_b32 v10, 0x3f803f80
    v_cmp_eq_u32 vcc, 0, v14
    s_nop 1
    v_cndmask_b32 v248, 0, v10, vcc
    v_mov_b32 v249, v248
    v_mov_b32 v250, v248
    v_mov_b32 v251, v248
    s_add_u32 s60, s59, 5242880
    s_add_u32 s61, s59, 1048576
    s_lshl_b32 s57, s40, 7
    s_add_u32 s57, s57, 155648
    v_lshl_add_u32 v4, v9, 2, s57
    v_lshl_add_u32 v5, v8, 4, s57
    v_mov_b32 v252, 0x3f803f80
    v_mov_b32 v253, 0x3f803f80
    v_mov_b32 v254, 0x3f803f80
    v_mov_b32 v255, 0x3f803f80
    v_mov_b32 v243, 0x3f80
    s_add_u32 m0, s51, 67840
    s_nop 0
    buffer_load_dwordx4 v3, s[8:11], s63 offen offset:1792 lds
    v_mov_b32 v28, 0
    v_mov_b32 v29, 0
    v_mov_b32 v30, 0
    v_mov_b32 v31, 0
    v_mov_b32 v32, 0
    v_mov_b32 v33, 0
    v_mov_b32 v34, 0
    v_mov_b32 v35, 0
    v_mov_b32 v36, 0
    v_mov_b32 v37, 0
    v_mov_b32 v38, 0
    v_mov_b32 v39, 0
    v_mov_b32 v40, 0
    v_mov_b32 v41, 0
    v_mov_b32 v42, 0
    v_mov_b32 v43, 0
    s_waitcnt lgkmcnt(0)
    s_mul_i32 s45, s46, 0x9E3779B1
    s_add_u32 s45, s45, 0x7F4A7C15
    s_lshr_b32 s48, s45, 15
    s_xor_b32 s45, s45, s48
    s_waitcnt vmcnt(16)
    s_barrier
    ds_read_b128 v[120:123], v172 offset:0
    ds_read_b64_tr_b16 v[136:137], v6 offset:0
    ds_read_b64_tr_b16 v[138:139], v6 offset:512
    ds_read_b64_tr_b16 v[140:141], v6 offset:8192
    ds_read_b64_tr_b16 v[142:143], v6 offset:8704
    ds_read_b64_tr_b16 v[144:145], v7 offset:16384
    ds_read_b64_tr_b16 v[146:147], v7 offset:16896
    ds_read_b128 v[124:127], v173 offset:0
    ds_read_b64_tr_b16 v[148:149], v6 offset:2048
    ds_read_b64_tr_b16 v[150:151], v6 offset:2560
    ds_read_b64_tr_b16 v[152:153], v6 offset:10240
    ds_read_b64_tr_b16 v[154:155], v6 offset:10752
    ds_read_b64_tr_b16 v[156:157], v7 offset:18432
    ds_read_b64_tr_b16 v[158:159], v7 offset:18944
    s_waitcnt lgkmcnt(7)
    v_mfma_f32_32x32x16_bf16 v[104:119], v[120:123], v[144:147], 0
    ds_read_b128 v[128:131], v174 offset:0
    ds_read_b64_tr_b16 v[160:161], v6 offset:4096
    ds_read_b64_tr_b16 v[162:163], v6 offset:4608
    v_mfma_f32_32x32x16_bf16 v[88:103], v[140:143], v[120:123], 0
    s_add_u32 m0, s51, 122496
    ds_read_b64_tr_b16 v[164:165], v6 offset:12288
    ds_read_b64_tr_b16 v[166:167], v6 offset:12800
    buffer_load_dwordx4 v2, s[4:7], s49 offen offset:384 lds
    v_mfma_f32_32x32x16_bf16 v[72:87], v[136:139], v[120:123], 0
    s_add_u32 m0, s51, 126592
    ds_read_b64_tr_b16 v[168:169], v7 offset:20480
    ds_read_b64_tr_b16 v[170:171], v7 offset:20992
    buffer_load_dwordx4 v2, s[4:7], s52 offen offset:384 lds
    s_waitcnt lgkmcnt(7)
    v_mfma_f32_32x32x16_bf16 v[104:119], v[124:127], v[156:159], v[104:119]
    ds_read_b128 v[132:135], v175 offset:0
    ds_read_b64_tr_b16 v[136:137], v6 offset:6144
    ds_read_b64_tr_b16 v[138:139], v6 offset:6656
    v_mfma_f32_32x32x16_bf16 v[88:103], v[152:155], v[124:127], v[88:103]
    s_add_u32 m0, s51, 73728
    s_add_u32 s63, s50, 516096
    ds_read_b64_tr_b16 v[140:141], v6 offset:14336
    ds_read_b64_tr_b16 v[142:143], v6 offset:14848
    buffer_load_dwordx4 v3, s[8:11], s63 offen offset:0 lds
    v_mfma_f32_32x32x16_bf16 v[72:87], v[148:151], v[124:127], v[72:87]
    s_add_u32 m0, s51, 81024
    ds_read_b64_tr_b16 v[144:145], v7 offset:22528
    ds_read_b64_tr_b16 v[146:147], v7 offset:23040
    buffer_load_dwordx4 v3, s[8:11], s63 offen offset:896 lds
    s_waitcnt vmcnt(12)
    s_barrier
    s_waitcnt lgkmcnt(7)
    v_mfma_f32_32x32x16_bf16 v[104:119], v[128:131], v[168:171], v[104:119]
    ds_read_b128 v[120:123], v172 offset:8192
    ds_read_b64_tr_b16 v[148:149], v6 offset:24576
    ds_read_b64_tr_b16 v[150:151], v6 offset:25088
    v_mfma_f32_32x32x16_bf16 v[88:103], v[164:167], v[128:131], v[88:103]
    s_add_u32 m0, s51, 88320
    ds_read_b64_tr_b16 v[152:153], v6 offset:32768
    ds_read_b64_tr_b16 v[154:155], v6 offset:33280
    buffer_load_dwordx4 v3, s[8:11], s63 offen offset:1792 lds
    v_mfma_f32_32x32x16_bf16 v[72:87], v[160:163], v[128:131], v[72:87]
    s_add_u32 m0, s51, 77824
    s_add_u32 s63, s50, 602112
    ds_read_b64_tr_b16 v[156:157], v7 offset:40960
    ds_read_b64_tr_b16 v[158:159], v7 offset:41472
    buffer_load_dwordx4 v3, s[8:11], s63 offen offset:0 lds
    s_waitcnt lgkmcnt(7)
    v_mfma_f32_32x32x16_bf16 v[104:119], v[132:135], v[144:147], v[104:119]
    ds_read_b128 v[124:127], v173 offset:8192
    ds_read_b64_tr_b16 v[160:161], v6 offset:26624
    ds_read_b64_tr_b16 v[162:163], v6 offset:27136
    v_mfma_f32_32x32x16_bf16 v[88:103], v[140:143], v[132:135], v[88:103]
    s_add_u32 m0, s51, 85120
    ds_read_b64_tr_b16 v[164:165], v6 offset:34816
    ds_read_b64_tr_b16 v[166:167], v6 offset:35328
    buffer_load_dwordx4 v3, s[8:11], s63 offen offset:896 lds
    v_mfma_f32_32x32x16_bf16 v[72:87], v[136:139], v[132:135], v[72:87]
    s_add_u32 m0, s51, 92416
    ds_read_b64_tr_b16 v[168:169], v7 offset:43008
    ds_read_b64_tr_b16 v[170:171], v7 offset:43520
    buffer_load_dwordx4 v3, s[8:11], s63 offen offset:1792 lds
    s_waitcnt lgkmcnt(7)
    v_mfma_f32_32x32x16_bf16 v[104:119], v[120:123], v[156:159], v[104:119]
    ds_read_b128 v[128:131], v174 offset:8192
    ds_read_b64_tr_b16 v[136:137], v6 offset:28672
    ds_read_b64_tr_b16 v[138:139], v6 offset:29184
    v_mfma_f32_32x32x16_bf16 v[88:103], v[152:155], v[120:123], v[88:103]
    s_add_u32 m0, s51, 130560
    ds_read_b64_tr_b16 v[140:141], v6 offset:36864
    ds_read_b64_tr_b16 v[142:143], v6 offset:37376
    buffer_load_dwordx4 v2, s[4:7], s49 offen offset:512 lds
    v_mfma_f32_32x32x16_bf16 v[72:87], v[148:151], v[120:123], v[72:87]
    s_add_u32 m0, s51, 134656
    ds_read_b64_tr_b16 v[144:145], v7 offset:45056
    ds_read_b64_tr_b16 v[146:147], v7 offset:45568
    buffer_load_dwordx4 v2, s[4:7], s52 offen offset:512 lds
    s_waitcnt lgkmcnt(7)
    v_mfma_f32_32x32x16_bf16 v[104:119], v[124:127], v[168:171], v[104:119]
    ds_read_b128 v[132:135], v175 offset:8192
    ds_read_b64_tr_b16 v[148:149], v6 offset:30720
    ds_read_b64_tr_b16 v[150:151], v6 offset:31232
    v_mfma_f32_32x32x16_bf16 v[88:103], v[164:167], v[124:127], v[88:103]
    s_add_u32 m0, s51, 0
    s_add_u32 s63, s50, 688128
    ds_read_b64_tr_b16 v[152:153], v6 offset:38912
    ds_read_b64_tr_b16 v[154:155], v6 offset:39424
    buffer_load_dwordx4 v3, s[8:11], s63 offen offset:0 lds
    v_mfma_f32_32x32x16_bf16 v[72:87], v[160:163], v[124:127], v[72:87]
    s_add_u32 m0, s51, 7296
    ds_read_b64_tr_b16 v[156:157], v7 offset:47104
    ds_read_b64_tr_b16 v[158:159], v7 offset:47616
    buffer_load_dwordx4 v3, s[8:11], s63 offen offset:896 lds
    s_waitcnt vmcnt(12)
    s_barrier
    v_add_u32 v6, 0xc000, v6
    v_add_u32 v7, 0xc000, v7
    s_waitcnt lgkmcnt(7)
    v_mfma_f32_32x32x16_bf16 v[104:119], v[128:131], v[144:147], v[104:119]
    ds_read_b128 v[120:123], v172 offset:16384
    ds_read_b64_tr_b16 v[160:161], v6 offset:0
    ds_read_b64_tr_b16 v[162:163], v6 offset:512
    v_mfma_f32_32x32x16_bf16 v[88:103], v[140:143], v[128:131], v[88:103]
    s_add_u32 m0, s51, 14592
    ds_read_b64_tr_b16 v[164:165], v6 offset:8192
    ds_read_b64_tr_b16 v[166:167], v6 offset:8704
    buffer_load_dwordx4 v3, s[8:11], s63 offen offset:1792 lds
    v_mfma_f32_32x32x16_bf16 v[72:87], v[136:139], v[128:131], v[72:87]
    s_add_u32 m0, s51, 4096
    s_add_u32 s63, s50, 774144
    ds_read_b64_tr_b16 v[168:169], v7 offset:16384
    ds_read_b64_tr_b16 v[170:171], v7 offset:16896
    buffer_load_dwordx4 v3, s[8:11], s63 offen offset:0 lds
    s_waitcnt lgkmcnt(7)
    v_mfma_f32_32x32x16_bf16 v[104:119], v[132:135], v[156:159], v[104:119]
    ds_read_b128 v[124:127], v173 offset:16384
    ds_read_b64_tr_b16 v[136:137], v6 offset:2048
    ds_read_b64_tr_b16 v[138:139], v6 offset:2560
    v_mfma_f32_32x32x16_bf16 v[88:103], v[152:155], v[132:135], v[88:103]
    s_add_u32 m0, s51, 11392
    ds_read_b64_tr_b16 v[140:141], v6 offset:10240
    ds_read_b64_tr_b16 v[142:143], v6 offset:10752
    buffer_load_dwordx4 v3, s[8:11], s63 offen offset:896 lds
    v_mfma_f32_32x32x16_bf16 v[72:87], v[148:151], v[132:135], v[72:87]
    s_add_u32 m0, s51, 18688
    ds_read_b64_tr_b16 v[144:145], v7 offset:18432
    ds_read_b64_tr_b16 v[146:147], v7 offset:18944
    buffer_load_dwordx4 v3, s[8:11], s63 offen offset:1792 lds
    s_waitcnt lgkmcnt(7)
    v_mfma_f32_32x32x16_bf16 v[104:119], v[120:123], v[168:171], v[104:119]
    ds_read_b128 v[128:131], v174 offset:16384
    ds_read_b64_tr_b16 v[148:149], v6 offset:4096
    ds_read_b64_tr_b16 v[150:151], v6 offset:4608
    v_mfma_f32_32x32x16_bf16 v[88:103], v[164:167], v[120:123], v[88:103]
    s_add_u32 m0, s51, 138624
    ds_read_b64_tr_b16 v[152:153], v6 offset:12288
    ds_read_b64_tr_b16 v[154:155], v6 offset:12800
    buffer_load_dwordx4 v2, s[4:7], s49 offen offset:640 lds
    v_mfma_f32_32x32x16_bf16 v[72:87], v[160:163], v[120:123], v[72:87]
    s_add_u32 m0, s51, 142720
    ds_read_b64_tr_b16 v[156:157], v7 offset:20480
    ds_read_b64_tr_b16 v[158:159], v7 offset:20992
    buffer_load_dwordx4 v2, s[4:7], s52 offen offset:640 lds
    s_waitcnt lgkmcnt(7)
    v_mfma_f32_32x32x16_bf16 v[104:119], v[124:127], v[144:147], v[104:119]
    ds_read_b128 v[132:135], v175 offset:16384
    ds_read_b64_tr_b16 v[160:161], v6 offset:6144
    ds_read_b64_tr_b16 v[162:163], v6 offset:6656
    v_mfma_f32_32x32x16_bf16 v[88:103], v[140:143], v[124:127], v[88:103]
    s_add_u32 m0, s51, 24576
    s_add_u32 s63, s50, 860160
    ds_read_b64_tr_b16 v[164:165], v6 offset:14336
    ds_read_b64_tr_b16 v[166:167], v6 offset:14848
    buffer_load_dwordx4 v3, s[8:11], s63 offen offset:0 lds
    v_mfma_f32_32x32x16_bf16 v[72:87], v[136:139], v[124:127], v[72:87]
    s_add_u32 m0, s51, 31872
    ds_read_b64_tr_b16 v[168:169], v7 offset:22528
    ds_read_b64_tr_b16 v[170:171], v7 offset:23040
    buffer_load_dwordx4 v3, s[8:11], s63 offen offset:896 lds
    s_waitcnt vmcnt(12)
    s_barrier
    s_waitcnt lgkmcnt(7)
    v_mfma_f32_32x32x16_bf16 v[104:119], v[128:131], v[156:159], v[104:119]
    ds_read_b128 v[120:123], v172 offset:24576
    ds_read_b64_tr_b16 v[136:137], v6 offset:24576
    ds_read_b64_tr_b16 v[138:139], v6 offset:25088
    v_mfma_f32_32x32x16_bf16 v[88:103], v[152:155], v[128:131], v[88:103]
    s_add_u32 m0, s51, 39168
    ds_read_b64_tr_b16 v[140:141], v6 offset:32768
    ds_read_b64_tr_b16 v[142:143], v6 offset:33280
    buffer_load_dwordx4 v3, s[8:11], s63 offen offset:1792 lds
    v_mfma_f32_32x32x16_bf16 v[72:87], v[148:151], v[128:131], v[72:87]
    s_add_u32 m0, s51, 28672
    s_add_u32 s63, s50, 946176
    ds_read_b64_tr_b16 v[144:145], v7 offset:40960
    ds_read_b64_tr_b16 v[146:147], v7 offset:41472
    buffer_load_dwordx4 v3, s[8:11], s63 offen offset:0 lds
    s_waitcnt lgkmcnt(7)
    v_mfma_f32_32x32x16_bf16 v[104:119], v[132:135], v[168:171], v[104:119]
    ds_read_b128 v[124:127], v173 offset:24576
    ds_read_b64_tr_b16 v[148:149], v6 offset:26624
    ds_read_b64_tr_b16 v[150:151], v6 offset:27136
    v_mfma_f32_32x32x16_bf16 v[88:103], v[164:167], v[132:135], v[88:103]
    s_add_u32 m0, s51, 35968
    ds_read_b64_tr_b16 v[152:153], v6 offset:34816
    ds_read_b64_tr_b16 v[154:155], v6 offset:35328
    buffer_load_dwordx4 v3, s[8:11], s63 offen offset:896 lds
    v_mfma_f32_32x32x16_bf16 v[72:87], v[160:163], v[132:135], v[72:87]
    s_add_u32 m0, s51, 43264
    ds_read_b64_tr_b16 v[156:157], v7 offset:43008
    ds_read_b64_tr_b16 v[158:159], v7 offset:43520
    buffer_load_dwordx4 v3, s[8:11], s63 offen offset:1792 lds
    s_waitcnt lgkmcnt(7)
    v_mfma_f32_32x32x16_bf16 v[104:119], v[120:123], v[144:147], v[104:119]
    ds_read_b128 v[128:131], v174 offset:24576
    ds_read_b64_tr_b16 v[160:161], v6 offset:28672
    ds_read_b64_tr_b16 v[162:163], v6 offset:29184
    v_mfma_f32_32x32x16_bf16 v[88:103], v[140:143], v[120:123], v[88:103]
    s_add_u32 m0, s51, 146688
    ds_read_b64_tr_b16 v[164:165], v6 offset:36864
    ds_read_b64_tr_b16 v[166:167], v6 offset:37376
    buffer_load_dwordx4 v2, s[4:7], s49 offen offset:768 lds
    v_mfma_f32_32x32x16_bf16 v[72:87], v[136:139], v[120:123], v[72:87]
    s_add_u32 m0, s51, 150784
    ds_read_b64_tr_b16 v[168:169], v7 offset:45056
    ds_read_b64_tr_b16 v[170:171], v7 offset:45568
    buffer_load_dwordx4 v2, s[4:7], s52 offen offset:768 lds
    s_waitcnt lgkmcnt(7)
    v_mfma_f32_32x32x16_bf16 v[104:119], v[124:127], v[156:159], v[104:119]
    ds_read_b128 v[132:135], v175 offset:24576
    ds_read_b64_tr_b16 v[136:137], v6 offset:30720
    ds_read_b64_tr_b16 v[138:139], v6 offset:31232
    v_mfma_f32_32x32x16_bf16 v[88:103], v[152:155], v[124:127], v[88:103]
    s_add_u32 m0, s51, 49152
    s_add_u32 s63, s50, 1032192
    ds_read_b64_tr_b16 v[140:141], v6 offset:38912
    ds_read_b64_tr_b16 v[142:143], v6 offset:39424
    buffer_load_dwordx4 v3, s[8:11], s63 offen offset:0 lds
    v_mfma_f32_32x32x16_bf16 v[72:87], v[148:151], v[124:127], v[72:87]
    s_add_u32 m0, s51, 56448
    ds_read_b64_tr_b16 v[144:145], v7 offset:47104
    ds_read_b64_tr_b16 v[146:147], v7 offset:47616
    buffer_load_dwordx4 v3, s[8:11], s63 offen offset:896 lds
    s_waitcnt vmcnt(12)
    s_barrier
    v_add_u32 v6, 0xffff4000, v6
    v_add_u32 v7, 0xffff4000, v7
    s_waitcnt lgkmcnt(7)
    v_mfma_f32_32x32x16_bf16 v[104:119], v[128:131], v[168:171], v[104:119]
    ds_read_b128 v[120:123], v172 offset:32768
    ds_read_b64_tr_b16 v[148:149], v6 offset:0
    ds_read_b64_tr_b16 v[150:151], v6 offset:512
    v_mfma_f32_32x32x16_bf16 v[88:103], v[164:167], v[128:131], v[88:103]
    s_add_u32 m0, s51, 63744
    ds_read_b64_tr_b16 v[152:153], v6 offset:8192
    ds_read_b64_tr_b16 v[154:155], v6 offset:8704
    buffer_load_dwordx4 v3, s[8:11], s63 offen offset:1792 lds
    v_mfma_f32_32x32x16_bf16 v[72:87], v[160:163], v[128:131], v[72:87]
    s_add_u32 m0, s51, 53248
    s_add_u32 s63, s50, 1118208
    ds_read_b64_tr_b16 v[156:157], v7 offset:16384
    ds_read_b64_tr_b16 v[158:159], v7 offset:16896
    buffer_load_dwordx4 v3, s[8:11], s63 offen offset:0 lds
    s_waitcnt lgkmcnt(7)
    v_mfma_f32_32x32x16_bf16 v[104:119], v[132:135], v[144:147], v[104:119]
    ds_read_b128 v[124:127], v173 offset:32768
    ds_read_b64_tr_b16 v[160:161], v6 offset:2048
    ds_read_b64_tr_b16 v[162:163], v6 offset:2560
    v_mfma_f32_32x32x16_bf16 v[88:103], v[140:143], v[132:135], v[88:103]
    s_add_u32 m0, s51, 60544
    ds_read_b64_tr_b16 v[164:165], v6 offset:10240
    ds_read_b64_tr_b16 v[166:167], v6 offset:10752
    buffer_load_dwordx4 v3, s[8:11], s63 offen offset:896 lds
    v_mfma_f32_32x32x16_bf16 v[72:87], v[136:139], v[132:135], v[72:87]
    s_add_u32 m0, s51, 67840
    ds_read_b64_tr_b16 v[168:169], v7 offset:18432
    ds_read_b64_tr_b16 v[170:171], v7 offset:18944
    buffer_load_dwordx4 v3, s[8:11], s63 offen offset:1792 lds
    s_waitcnt lgkmcnt(7)
    v_mfma_f32_32x32x16_bf16 v[104:119], v[120:123], v[156:159], v[104:119]
    ds_read_b128 v[128:131], v174 offset:32768
    ds_read_b64_tr_b16 v[136:137], v6 offset:4096
    ds_read_b64_tr_b16 v[138:139], v6 offset:4608
    v_mfma_f32_32x32x16_bf16 v[88:103], v[152:155], v[120:123], v[88:103]
    ds_read_b64_tr_b16 v[140:141], v6 offset:12288
    ds_read_b64_tr_b16 v[142:143], v6 offset:12800
    v_mfma_f32_32x32x16_bf16 v[72:87], v[148:151], v[120:123], v[72:87]
    ds_read_b64_tr_b16 v[144:145], v7 offset:20480
    ds_read_b64_tr_b16 v[146:147], v7 offset:20992
    s_waitcnt lgkmcnt(7)
    v_mfma_f32_32x32x16_bf16 v[104:119], v[124:127], v[168:171], v[104:119]
    ds_read_b128 v[132:135], v175 offset:32768
    ds_read_b64_tr_b16 v[148:149], v6 offset:6144
    ds_read_b64_tr_b16 v[150:151], v6 offset:6656
    v_mfma_f32_32x32x16_bf16 v[88:103], v[164:167], v[124:127], v[88:103]
    ds_read_b64_tr_b16 v[152:153], v6 offset:14336
    ds_read_b64_tr_b16 v[154:155], v6 offset:14848
    v_mfma_f32_32x32x16_bf16 v[72:87], v[160:163], v[124:127], v[72:87]
    ds_read_b64_tr_b16 v[156:157], v7 offset:22528
    ds_read_b64_tr_b16 v[158:159], v7 offset:23040
    s_waitcnt vmcnt(8)
    s_barrier
    s_waitcnt lgkmcnt(7)
    v_mfma_f32_32x32x16_bf16 v[104:119], v[128:131], v[144:147], v[104:119]
    ds_read_b128 v[120:123], v172 offset:40960
    ds_read_b64_tr_b16 v[160:161], v6 offset:24576
    ds_read_b64_tr_b16 v[162:163], v6 offset:25088
    v_mfma_f32_32x32x16_bf16 v[88:103], v[140:143], v[128:131], v[88:103]
    ds_read_b64_tr_b16 v[164:165], v6 offset:32768
    ds_read_b64_tr_b16 v[166:167], v6 offset:33280
    buffer_load_dwordx4 v[16:19], v237, s[36:39], 0 offen sc1
    v_mfma_f32_32x32x16_bf16 v[72:87], v[136:139], v[128:131], v[72:87]
    ds_read_b64_tr_b16 v[168:169], v7 offset:40960
    ds_read_b64_tr_b16 v[170:171], v7 offset:41472
    buffer_load_dwordx2 v[20:21], v238, s[36:39], 0 offen sc1
    s_waitcnt lgkmcnt(7)
    v_mfma_f32_32x32x16_bf16 v[104:119], v[132:135], v[156:159], v[104:119]
    ds_read_b128 v[124:127], v173 offset:40960
    ds_read_b64_tr_b16 v[136:137], v6 offset:26624
    ds_read_b64_tr_b16 v[138:139], v6 offset:27136
    v_mfma_f32_32x32x16_bf16 v[88:103], v[152:155], v[132:135], v[88:103]
    ds_read_b64_tr_b16 v[140:141], v6 offset:34816
    ds_read_b64_tr_b16 v[142:143], v6 offset:35328
    buffer_load_dwordx2 v[22:23], v238, s[36:39], 0 offen offset:3584 sc1
    v_mfma_f32_32x32x16_bf16 v[72:87], v[148:151], v[132:135], v[72:87]
    ds_read_b64_tr_b16 v[144:145], v7 offset:43008
    ds_read_b64_tr_b16 v[146:147], v7 offset:43520
    buffer_load_dwordx2 v[24:25], v239, s[36:39], 0 offen sc1
    s_waitcnt lgkmcnt(7)
    v_mfma_f32_32x32x16_bf16 v[104:119], v[120:123], v[168:171], v[104:119]
    ds_read_b128 v[128:131], v174 offset:40960
    ds_read_b64_tr_b16 v[148:149], v6 offset:28672
    ds_read_b64_tr_b16 v[150:151], v6 offset:29184
    v_mfma_f32_32x32x16_bf16 v[88:103], v[164:167], v[120:123], v[88:103]
    ds_read_b64_tr_b16 v[152:153], v6 offset:36864
    ds_read_b64_tr_b16 v[154:155], v6 offset:37376
    v_mfma_f32_32x32x16_bf16 v[72:87], v[160:163], v[120:123], v[72:87]
    ds_read_b64_tr_b16 v[156:157], v7 offset:45056
    ds_read_b64_tr_b16 v[158:159], v7 offset:45568
    s_waitcnt lgkmcnt(7)
    v_mfma_f32_32x32x16_bf16 v[104:119], v[124:127], v[144:147], v[104:119]
    ds_read_b128 v[132:135], v175 offset:40960
    ds_read_b64_tr_b16 v[160:161], v6 offset:30720
    ds_read_b64_tr_b16 v[162:163], v6 offset:31232
    v_mfma_f32_32x32x16_bf16 v[88:103], v[140:143], v[124:127], v[88:103]
    ds_read_b64_tr_b16 v[164:165], v6 offset:38912
    ds_read_b64_tr_b16 v[166:167], v6 offset:39424
    v_mfma_f32_32x32x16_bf16 v[72:87], v[136:139], v[124:127], v[72:87]
    ds_read_b64_tr_b16 v[168:169], v7 offset:47104
    ds_read_b64_tr_b16 v[170:171], v7 offset:47616
    s_waitcnt vmcnt(4)
    s_barrier
    v_add_u32 v6, 0xc000, v6
    v_add_u32 v7, 0xc000, v7
    s_waitcnt lgkmcnt(7)
    v_mfma_f32_32x32x16_bf16 v[104:119], v[128:131], v[156:159], v[104:119]
    ds_read_b128 v[120:123], v172 offset:49152
    ds_read_b64_tr_b16 v[136:137], v6 offset:0
    ds_read_b64_tr_b16 v[138:139], v6 offset:512
    v_mfma_f32_32x32x16_bf16 v[88:103], v[152:155], v[128:131], v[88:103]
    ds_read_b64_tr_b16 v[140:141], v6 offset:8192
    ds_read_b64_tr_b16 v[142:143], v6 offset:8704
    v_mfma_f32_32x32x16_bf16 v[72:87], v[148:151], v[128:131], v[72:87]
    ds_read_b64_tr_b16 v[144:145], v7 offset:16384
    ds_read_b64_tr_b16 v[146:147], v7 offset:16896
    s_waitcnt lgkmcnt(7)
    v_mfma_f32_32x32x16_bf16 v[104:119], v[132:135], v[168:171], v[104:119]
    ds_read_b128 v[124:127], v173 offset:49152
    ds_read_b64_tr_b16 v[148:149], v6 offset:2048
    ds_read_b64_tr_b16 v[150:151], v6 offset:2560
    v_mfma_f32_32x32x16_bf16 v[88:103], v[164:167], v[132:135], v[88:103]
    ds_read_b64_tr_b16 v[152:153], v6 offset:10240
    ds_read_b64_tr_b16 v[154:155], v6 offset:10752
    v_mfma_f32_32x32x16_bf16 v[72:87], v[160:163], v[132:135], v[72:87]
    ds_read_b64_tr_b16 v[156:157], v7 offset:18432
    ds_read_b64_tr_b16 v[158:159], v7 offset:18944
    s_waitcnt lgkmcnt(7)
    v_mfma_f32_32x32x16_bf16 v[104:119], v[120:123], v[144:147], v[104:119]
    ds_read_b128 v[128:131], v174 offset:49152
    ds_read_b64_tr_b16 v[160:161], v6 offset:4096
    ds_read_b64_tr_b16 v[162:163], v6 offset:4608
    s_waitcnt vmcnt(3)
    v_xor_b32 v8, s45, v17
    v_xor_b32 v9, s45, v19
    s_waitcnt vmcnt(2)
    v_xor_b32 v10, s45, v21
    s_waitcnt vmcnt(1)
    v_xor_b32 v11, s45, v23
    v_mfma_f32_32x32x16_bf16 v[88:103], v[140:143], v[120:123], v[88:103]
    ds_read_b64_tr_b16 v[164:165], v6 offset:12288
    ds_read_b64_tr_b16 v[166:167], v6 offset:12800
    s_waitcnt vmcnt(0)
    v_xor_b32 v12, s45, v25
    v_or3_b32 v8, v8, v9, v10
    v_or3_b32 v8, v8, v11, v12
    v_cmp_ne_u32 vcc, 0, v8
    s_nop 1
    s_cbranch_vccz L_rsd_3
    s_mov_b32 s48, 0
L_rs_2:
    buffer_load_dwordx4 v[16:19], v237, s[36:39], 0 offen sc1
    buffer_load_dwordx2 v[20:21], v238, s[36:39], 0 offen sc1
    buffer_load_dwordx2 v[22:23], v238, s[36:39], 0 offen offset:3584 sc1
    buffer_load_dwordx2 v[24:25], v239, s[36:39], 0 offen sc1
    s_waitcnt vmcnt(0)
    v_xor_b32 v8, s45, v17
    v_xor_b32 v9, s45, v19
    v_xor_b32 v10, s45, v21
    v_xor_b32 v11, s45, v23
    v_xor_b32 v12, s45, v25
    v_or3_b32 v8, v8, v9, v10
    v_or3_b32 v8, v8, v11, v12
    v_cmp_ne_u32 vcc, 0, v8
    s_add_u32 s48, s48, 1
    s_cmp_gt_u32 s48, 0x80000
    s_cbranch_scc1 L_rsd_3
    s_cbranch_vccnz L_rs_2
L_rsd_3:
    v_mfma_f32_32x32x16_bf16 v[72:87], v[136:139], v[120:123], v[72:87]
    ds_read_b64_tr_b16 v[168:169], v7 offset:20480
    ds_read_b64_tr_b16 v[170:171], v7 offset:20992
    ds_write_b32 v4, v18
    buffer_store_dwordx4 v[248:251], v236, s[36:39], s60 offen offset:2048 sc1
    s_waitcnt lgkmcnt(8)
    v_mfma_f32_32x32x16_bf16 v[104:119], v[124:127], v[156:159], v[104:119]
    ds_read_b128 v[132:135], v175 offset:49152
    ds_read_b64_tr_b16 v[136:137], v6 offset:6144
    ds_read_b64_tr_b16 v[138:139], v6 offset:6656
    ds_read_b128 v[48:51], v5 offset:0
    ds_read_b128 v[52:55], v5 offset:32
    v_mfma_f32_32x32x16_bf16 v[88:103], v[152:155], v[124:127], v[88:103]
    ds_read_b64_tr_b16 v[140:141], v6 offset:14336
    ds_read_b64_tr_b16 v[142:143], v6 offset:14848
    ds_read_b128 v[56:59], v5 offset:64
    ds_read_b128 v[60:63], v5 offset:96
    v_mfma_f32_32x32x16_bf16 v[72:87], v[148:151], v[124:127], v[72:87]
    ds_read_b64_tr_b16 v[144:145], v7 offset:22528
    ds_read_b64_tr_b16 v[146:147], v7 offset:23040
    v_cvt_pk_bf16_f32 v9, -v16, -v16
    v_and_b32 v8, 0xffff0000, v9
    v_add_f32 v8, v16, v8
    v_cvt_pk_bf16_f32 v8, -v8, 0
    s_waitcnt lgkmcnt(12)
    v_mfma_f32_32x32x16_bf16 v[104:119], v[128:131], v[168:171], v[104:119]
    v_cndmask_b32 v28, v9, 0, s[64:65]
    v_cndmask_b32 v29, v8, 0, s[64:65]
    v_mul_f32 v16, 0x3e8b97f6, v18
    v_mfma_f32_32x32x16_bf16 v[88:103], v[164:167], v[128:131], v[88:103]
    v_cvt_pk_bf16_f32 v33, v20, 0
    v_lshlrev_b32 v8, 16, v33
    v_sub_f32 v8, v20, v8
    v_cvt_pk_bf16_f32 v32, v20, v8
    v_mfma_f32_32x32x16_bf16 v[72:87], v[160:163], v[128:131], v[72:87]
    v_cvt_pk_bf16_f32 v37, v22, 0
    v_lshlrev_b32 v8, 16, v37
    v_sub_f32 v8, v22, v8
    v_cvt_pk_bf16_f32 v36, v22, v8
    s_waitcnt lgkmcnt(0)
    v_mfma_f32_32x32x16_bf16 v[104:119], v[132:135], v[144:147], v[104:119]
    v_cvt_pk_bf16_f32 v41, v24, 0
    v_lshlrev_b32 v8, 16, v41
    v_sub_f32 v8, v24, v8
    v_cvt_pk_bf16_f32 v40, v24, v8
    v_mfma_f32_32x32x16_bf16 v[88:103], v[140:143], v[132:135], v[88:103]
    v_mfma_f32_32x32x16_bf16 v[72:87], v[136:139], v[132:135], v[72:87]
    v_mfma_f32_32x32x16_bf16 v[104:119], v[28:31], v[40:43], v[104:119]
    v_mfma_f32_32x32x16_bf16 v[88:103], v[36:39], v[28:31], v[88:103]
    v_mfma_f32_32x32x16_bf16 v[72:87], v[32:35], v[28:31], v[72:87]
    s_nop 9
    v_mul_f32 v104, v104, v48
    v_mul_f32 v105, v105, v49
    v_mul_f32 v106, v106, v50
    v_mul_f32 v107, v107, v51
    v_mul_f32 v108, v108, v52
    v_mul_f32 v109, v109, v53
    v_mul_f32 v110, v110, v54
    v_mul_f32 v111, v111, v55
    v_cvt_pk_bf16_f32 v144, v104, v105
    v_cvt_pk_bf16_f32 v145, v106, v107
    v_cvt_pk_bf16_f32 v146, v108, v109
    v_cvt_pk_bf16_f32 v147, v110, v111
    buffer_store_dwordx4 v[144:147], v235, s[36:39], s60 offen offset:2048 sc1
    v_mul_f32 v112, v112, v56
    v_mul_f32 v113, v113, v57
    v_mul_f32 v114, v114, v58
    v_mul_f32 v115, v115, v59
    v_mul_f32 v116, v116, v60
    v_mul_f32 v117, v117, v61
    v_mul_f32 v118, v118, v62
    v_mul_f32 v119, v119, v63
    v_cvt_pk_bf16_f32 v148, v112, v113
    v_cvt_pk_bf16_f32 v149, v114, v115
    v_cvt_pk_bf16_f32 v150, v116, v117
    v_cvt_pk_bf16_f32 v151, v118, v119
    buffer_store_dwordx4 v[148:151], v235, s[36:39], s60 offen offset:3072 sc1
    v_pk_mul_f32 v[88:89], v[88:89], v[18:19] op_sel_hi:[1,0]
    v_pk_mul_f32 v[90:91], v[90:91], v[18:19] op_sel_hi:[1,0]
    v_pk_mul_f32 v[92:93], v[92:93], v[18:19] op_sel_hi:[1,0]
    v_pk_mul_f32 v[94:95], v[94:95], v[18:19] op_sel_hi:[1,0]
    v_pk_mul_f32 v[96:97], v[96:97], v[18:19] op_sel_hi:[1,0]
    v_pk_mul_f32 v[98:99], v[98:99], v[18:19] op_sel_hi:[1,0]
    v_pk_mul_f32 v[100:101], v[100:101], v[18:19] op_sel_hi:[1,0]
    v_pk_mul_f32 v[102:103], v[102:103], v[18:19] op_sel_hi:[1,0]
    v_cvt_pk_bf16_f32 v132, v88, v89
    v_cvt_pk_bf16_f32 v133, v90, v91
    v_cvt_pk_bf16_f32 v134, v92, v93
    v_cvt_pk_bf16_f32 v135, v94, v95
    v_cvt_pk_bf16_f32 v136, v96, v97
    v_cvt_pk_bf16_f32 v137, v98, v99
    v_cvt_pk_bf16_f32 v138, v100, v101
    v_cvt_pk_bf16_f32 v139, v102, v103
    v_mov_b32 v140, v254
    v_mov_b32 v141, v243
    v_cndmask_b32 v142, v138, v134, s[66:67]
    v_cndmask_b32 v143, v139, v135, s[66:67]
    v_cndmask_b32 v134, v134, v140, s[66:67]
    v_cndmask_b32 v135, v135, v141, s[66:67]
    buffer_store_dwordx4 v[132:135], v232, s[36:39], s60 offen sc1
    v_cndmask_b32 v138, v138, v140, s[68:69]
    v_cndmask_b32 v139, v139, v141, s[68:69]
    buffer_store_dwordx4 v[136:139], v233, s[36:39], s60 offen sc1
    buffer_store_dwordx4 v[140:143], v234, s[36:39], s60 offen sc1
    v_pk_mul_f32 v[72:73], v[72:73], v[16:17] op_sel_hi:[1,0]
    v_pk_mul_f32 v[74:75], v[74:75], v[16:17] op_sel_hi:[1,0]
    v_pk_mul_f32 v[76:77], v[76:77], v[16:17] op_sel_hi:[1,0]
    v_pk_mul_f32 v[78:79], v[78:79], v[16:17] op_sel_hi:[1,0]
    v_pk_mul_f32 v[80:81], v[80:81], v[16:17] op_sel_hi:[1,0]
    v_pk_mul_f32 v[82:83], v[82:83], v[16:17] op_sel_hi:[1,0]
    v_pk_mul_f32 v[84:85], v[84:85], v[16:17] op_sel_hi:[1,0]
    v_pk_mul_f32 v[86:87], v[86:87], v[16:17] op_sel_hi:[1,0]
    v_cvt_pk_bf16_f32 v120, v72, v73
    v_cvt_pk_bf16_f32 v121, v74, v75
    v_cvt_pk_bf16_f32 v122, v76, v77
    v_cvt_pk_bf16_f32 v123, v78, v79
    v_cvt_pk_bf16_f32 v124, v80, v81
    v_cvt_pk_bf16_f32 v125, v82, v83
    v_cvt_pk_bf16_f32 v126, v84, v85
    v_cvt_pk_bf16_f32 v127, v86, v87
    v_mov_b32 v128, 0
    v_mov_b32 v129, 0
    v_cndmask_b32 v130, v126, v122, s[66:67]
    v_cndmask_b32 v131, v127, v123, s[66:67]
    v_cndmask_b32 v122, v122, v128, s[66:67]
    v_cndmask_b32 v123, v123, v129, s[66:67]
    buffer_store_dwordx4 v[120:123], v232, s[36:39], s61 offen sc1
    v_cndmask_b32 v126, v126, v128, s[68:69]
    v_cndmask_b32 v127, v127, v129, s[68:69]
    buffer_store_dwordx4 v[124:127], v233, s[36:39], s61 offen sc1
    buffer_store_dwordx4 v[128:131], v234, s[36:39], s61 offen sc1
    s_branch L_p1_sig
L_colsum:
    v_lshrrev_b32 v8, 2, v1
    v_and_b32 v9, 3, v1
    s_lshl_b32 s51, s41, 2
    s_add_u32 s51, s51, s40
    v_mul_u32_u24 v2, 896, v8
    v_lshl_add_u32 v2, v9, 4, v2
    s_mul_i32 s52, s51, 14336
    v_lshlrev_b32 v3, 4, v8
    v_mov_b32 v12, 0x40000000
    v_cmp_eq_u32 vcc, 0, v9
    s_nop 1
    v_cndmask_b32 v3, v12, v3, vcc
    v_lshrrev_b32 v8, 3, v1
    v_and_b32 v9, 7, v1
    v_and_b32 v10, 6, v8
    v_xor_b32 v9, v9, v10
    v_mul_u32_u24 v10, 3584, v8
    v_lshl_add_u32 v10, v9, 4, v10
    v_mul_u32_u24 v4, 2688, v8
    v_lshl_add_u32 v4, v9, 4, v4
    s_lshl_b32 s50, s40, 10
    v_lshlrev_b32 v11, 7, v1
    s_waitcnt lgkmcnt(0)
    s_load_dword s46, s[36:37], 0
    buffer_load_dwordx4 v[88:91], v2, s[4:7], s52 offen offset:0
    buffer_load_dwordx4 v[92:95], v2, s[4:7], s52 offen offset:64
    buffer_load_dwordx4 v[96:99], v2, s[4:7], s52 offen offset:128
    buffer_load_dwordx4 v[100:103], v2, s[4:7], s52 offen offset:192
    buffer_load_dwordx4 v[104:107], v2, s[4:7], s52 offen offset:256
    buffer_load_dwordx4 v[108:111], v2, s[4:7], s52 offen offset:320
    buffer_load_dwordx4 v[112:115], v2, s[4:7], s52 offen offset:384
    buffer_load_dwordx4 v[116:119], v2, s[4:7], s52 offen offset:448
    buffer_load_dwordx4 v[120:123], v2, s[4:7], s52 offen offset:512
    buffer_load_dwordx4 v[124:127], v2, s[4:7], s52 offen offset:576
    buffer_load_dwordx4 v[128:131], v2, s[4:7], s52 offen offset:640
    buffer_load_dwordx4 v[132:135], v2, s[4:7], s52 offen offset:704
    buffer_load_dwordx4 v[136:139], v2, s[4:7], s52 offen offset:768
    buffer_load_dwordx4 v[140:143], v2, s[4:7], s52 offen offset:832
    s_mul_i32 s49, s40, 21504
    s_lshl_b32 s53, s41, 7
    s_add_u32 s49, s49, s53
    s_cmp_ge_u32 s41, 21
    s_cselect_b32 s49, 0x40000000, s49
    s_add_u32 m0, s50, 57344
    s_nop 0
    buffer_load_dwordx4 v4, s[8:11], s49 offen lds
    s_add_u32 m0, s50, 61440
    s_add_u32 s49, s49, 86016
    buffer_load_dwordx4 v4, s[8:11], s49 offen lds
    s_add_u32 m0, s50, 65536
    s_add_u32 s49, s49, 86016
    buffer_load_dwordx4 v4, s[8:11], s49 offen lds
    s_add_u32 m0, s50, 69632
    s_add_u32 s49, s49, 86016
    buffer_load_dwordx4 v4, s[8:11], s49 offen lds
    s_add_u32 m0, s50, 73728
    s_add_u32 s49, s49, 86016
    buffer_load_dwordx4 v4, s[8:11], s49 offen lds
    s_add_u32 m0, s50, 77824
    s_add_u32 s49, s49, 86016
    buffer_load_dwordx4 v4, s[8:11], s49 offen lds
    s_add_u32 m0, s50, 81920
    s_add_u32 s49, s49, 86016
    buffer_load_dwordx4 v4, s[8:11], s49 offen lds
    s_add_u32 m0, s50, 86016
    s_add_u32 s49, s49, 86016
    buffer_load_dwordx4 v4, s[8:11], s49 offen lds
    s_add_u32 m0, s50, 90112
    s_add_u32 s49, s49, 86016
    buffer_load_dwordx4 v4, s[8:11], s49 offen lds
    s_add_u32 m0, s50, 94208
    s_add_u32 s49, s49, 86016
    buffer_load_dwordx4 v4, s[8:11], s49 offen lds
    s_add_u32 m0, s50, 98304
    s_add_u32 s49, s49, 86016
    buffer_load_dwordx4 v4, s[8:11], s49 offen lds
    s_add_u32 m0, s50, 102400
    s_add_u32 s49, s49, 86016
    buffer_load_dwordx4 v4, s[8:11], s49 offen lds
    s_add_u32 m0, s50, 106496
    s_add_u32 s49, s49, 86016
    buffer_load_dwordx4 v4, s[8:11], s49 offen lds
    s_add_u32 m0, s50, 110592
    s_add_u32 s49, s49, 86016
    buffer_load_dwordx4 v4, s[8:11], s49 offen lds
    v_and_b32 v240, 1, v0
    v_mul_u32_u24 v240, 225280, v240
    v_and_b32 v241, 2, v0
    v_lshl_add_u32 v240, v241, 6, v240
    s_lshl_b32 s54, s51, 8
    s_add_u32 s54, s54, 0x1000
    buffer_load_dword v241, v240, s[36:39], s54 offen
    s_waitcnt lgkmcnt(0)
    s_mul_i32 s45, s46, 0x9E3779B1
    s_add_u32 s45, s45, 0x7F4A7C15
    s_lshr_b32 s48, s45, 15
    s_xor_b32 s45, s45, s48
    v_mov_b32 v5, 0
    v_mov_b32 v6, 0
    v_mov_b32 v12, 0
    v_mov_b32 v13, 0
    v_mov_b32 v80, 0x3f803f80
    v_mov_b32 v81, 0x3f803f80
    v_mov_b32 v82, 0x3f803f80
    v_mov_b32 v83, 0x3f803f80
    s_mul_i32 s49, s40, 28672
    s_add_u32 s49, s49, s53
    s_cmp_ge_u32 s41, 28
    s_cselect_b32 s49, 0x40000000, s49
    s_waitcnt vmcnt(28)
    v_dot2c_f32_bf16 v5, v88, v80
    v_dot2c_f32_bf16 v12, v88, v88
    v_dot2c_f32_bf16 v6, v89, v80
    v_dot2c_f32_bf16 v13, v89, v89
    v_dot2c_f32_bf16 v5, v90, v80
    v_dot2c_f32_bf16 v12, v90, v90
    v_dot2c_f32_bf16 v6, v91, v80
    v_dot2c_f32_bf16 v13, v91, v91
    s_waitcnt vmcnt(27)
    v_dot2c_f32_bf16 v5, v92, v80
    v_dot2c_f32_bf16 v12, v92, v92
    v_dot2c_f32_bf16 v6, v93, v80
    v_dot2c_f32_bf16 v13, v93, v93
    v_dot2c_f32_bf16 v5, v94, v80
    v_dot2c_f32_bf16 v12, v94, v94
    v_dot2c_f32_bf16 v6, v95, v80
    v_dot2c_f32_bf16 v13, v95, v95
    s_waitcnt vmcnt(26)
    v_dot2c_f32_bf16 v5, v96, v80
    v_dot2c_f32_bf16 v12, v96, v96
    v_dot2c_f32_bf16 v6, v97, v80
    v_dot2c_f32_bf16 v13, v97, v97
    v_dot2c_f32_bf16 v5, v98, v80
    v_dot2c_f32_bf16 v12, v98, v98
    v_dot2c_f32_bf16 v6, v99, v80
    v_dot2c_f32_bf16 v13, v99, v99
    s_waitcnt vmcnt(25)
    v_dot2c_f32_bf16 v5, v100, v80
    v_dot2c_f32_bf16 v12, v100, v100
    v_dot2c_f32_bf16 v6, v101, v80
    v_dot2c_f32_bf16 v13, v101, v101
    v_dot2c_f32_bf16 v5, v102, v80
    v_dot2c_f32_bf16 v12, v102, v102
    v_dot2c_f32_bf16 v6, v103, v80
    v_dot2c_f32_bf16 v13, v103, v103
    s_waitcnt vmcnt(24)
    v_dot2c_f32_bf16 v5, v104, v80
    v_dot2c_f32_bf16 v12, v104, v104
    v_dot2c_f32_bf16 v6, v105, v80
    v_dot2c_f32_bf16 v13, v105, v105
    v_dot2c_f32_bf16 v5, v106, v80
    v_dot2c_f32_bf16 v12, v106, v106
    v_dot2c_f32_bf16 v6, v107, v80
    v_dot2c_f32_bf16 v13, v107, v107
    s_waitcnt vmcnt(23)
    v_dot2c_f32_bf16 v5, v108, v80
    v_dot2c_f32_bf16 v12, v108, v108
    v_dot2c_f32_bf16 v6, v109, v80
    v_dot2c_f32_bf16 v13, v109, v109
    v_dot2c_f32_bf16 v5, v110, v80
    v_dot2c_f32_bf16 v12, v110, v110
    v_dot2c_f32_bf16 v6, v111, v80
    v_dot2c_f32_bf16 v13, v111, v111
    s_waitcnt vmcnt(22)
    v_dot2c_f32_bf16 v5, v112, v80
    v_dot2c_f32_bf16 v12, v112, v112
    v_dot2c_f32_bf16 v6, v113, v80
    v_dot2c_f32_bf16 v13, v113, v113
    v_dot2c_f32_bf16 v5, v114, v80
    v_dot2c_f32_bf16 v12, v114, v114
    v_dot2c_f32_bf16 v6, v115, v80
    v_dot2c_f32_bf16 v13, v115, v115
    s_waitcnt vmcnt(21)
    v_dot2c_f32_bf16 v5, v116, v80
    v_dot2c_f32_bf16 v12, v116, v116
    v_dot2c_f32_bf16 v6, v117, v80
    v_dot2c_f32_bf16 v13, v117, v117
    v_dot2c_f32_bf16 v5, v118, v80
    v_dot2c_f32_bf16 v12, v118, v118
    v_dot2c_f32_bf16 v6, v119, v80
    v_dot2c_f32_bf16 v13, v119, v119
    s_waitcnt vmcnt(20)
    v_dot2c_f32_bf16 v5, v120, v80
    v_dot2c_f32_bf16 v12, v120, v120
    v_dot2c_f32_bf16 v6, v121, v80
    v_dot2c_f32_bf16 v13, v121, v121
    v_dot2c_f32_bf16 v5, v122, v80
    v_dot2c_f32_bf16 v12, v122, v122
    v_dot2c_f32_bf16 v6, v123, v80
    v_dot2c_f32_bf16 v13, v123, v123
    s_waitcnt vmcnt(19)
    v_dot2c_f32_bf16 v5, v124, v80
    v_dot2c_f32_bf16 v12, v124, v124
    v_dot2c_f32_bf16 v6, v125, v80
    v_dot2c_f32_bf16 v13, v125, v125
    v_dot2c_f32_bf16 v5, v126, v80
    v_dot2c_f32_bf16 v12, v126, v126
    v_dot2c_f32_bf16 v6, v127, v80
    v_dot2c_f32_bf16 v13, v127, v127
    s_waitcnt vmcnt(18)
    v_dot2c_f32_bf16 v5, v128, v80
    v_dot2c_f32_bf16 v12, v128, v128
    v_dot2c_f32_bf16 v6, v129, v80
    v_dot2c_f32_bf16 v13, v129, v129
    v_dot2c_f32_bf16 v5, v130, v80
    v_dot2c_f32_bf16 v12, v130, v130
    v_dot2c_f32_bf16 v6, v131, v80
    v_dot2c_f32_bf16 v13, v131, v131
    s_waitcnt vmcnt(17)
    v_dot2c_f32_bf16 v5, v132, v80
    v_dot2c_f32_bf16 v12, v132, v132
    v_dot2c_f32_bf16 v6, v133, v80
    v_dot2c_f32_bf16 v13, v133, v133
    v_dot2c_f32_bf16 v5, v134, v80
    v_dot2c_f32_bf16 v12, v134, v134
    v_dot2c_f32_bf16 v6, v135, v80
    v_dot2c_f32_bf16 v13, v135, v135
    s_waitcnt vmcnt(16)
    v_dot2c_f32_bf16 v5, v136, v80
    v_dot2c_f32_bf16 v12, v136, v136
    v_dot2c_f32_bf16 v6, v137, v80
    v_dot2c_f32_bf16 v13, v137, v137
    v_dot2c_f32_bf16 v5, v138, v80
    v_dot2c_f32_bf16 v12, v138, v138
    v_dot2c_f32_bf16 v6, v139, v80
    v_dot2c_f32_bf16 v13, v139, v139
    s_waitcnt vmcnt(15)
    v_dot2c_f32_bf16 v5, v140, v80
    v_dot2c_f32_bf16 v12, v140, v140
    v_dot2c_f32_bf16 v6, v141, v80
    v_dot2c_f32_bf16 v13, v141, v141
    v_dot2c_f32_bf16 v5, v142, v80
    v_dot2c_f32_bf16 v12, v142, v142
    v_dot2c_f32_bf16 v6, v143, v80
    v_dot2c_f32_bf16 v13, v143, v143
    s_nop 1
    v_add_f32 v5, v5, v6
    v_add_f32 v12, v12, v13
    s_nop 0
    v_add_f32_dpp v6, v5, v5 quad_perm:[1,0,3,2] row_mask:0xf bank_mask:0xf
    v_add_f32_dpp v13, v12, v12 quad_perm:[1,0,3,2] row_mask:0xf bank_mask:0xf
    s_nop 0
    v_add_f32_dpp v5, v6, v6 quad_perm:[2,3,0,1] row_mask:0xf bank_mask:0xf
    v_add_f32_dpp v12, v13, v13 quad_perm:[2,3,0,1] row_mask:0xf bank_mask:0xf
    v_mul_f32 v76, 0x3b124925, v5
    v_mul_f32 v12, 0x3b124925, v12
    v_fma_f32 v12, -v76, v76, v12
    v_max_f32 v12, 0, v12
    v_add_f32 v12, 0x3727c5ac, v12
    v_rsq_f32 v78, v12
    v_mov_b32 v77, s45
    v_mov_b32 v79, s45
    s_lshl_b32 s52, s51, 8
    s_add_u32 s52, s52, 196608
    buffer_store_dwordx4 v[76:79], v3, s[36:39], s52 offen sc1
    v_lshrrev_b32 v8, 4, v1
    v_bfe_u32 v9, v1, 2, 2
    v_and_b32 v12, 3, v1
    v_and_b32 v13, 1, v8
    v_lshrrev_b32 v14, 1, v9
    v_lshl_add_u32 v14, v13, 1, v14
    v_xor_b32 v14, s40, v14
    v_lshl_add_u32 v8, v8, 2, v9
    v_lshlrev_b32 v8, 7, v8
    v_lshl_add_u32 v8, v12, 3, v8
    v_lshl_add_u32 v8, v14, 5, v8
    v_add_u32 v7, 57344, v8
    v_and_b32 v12, 15, v1
    v_lshlrev_b32 v13, 3, v12
    v_lshlrev_b32 v12, 2, v12
    s_lshl_b32 s52, s51, 7
    s_add_u32 s52, s52, 40960
    s_cmp_ge_u32 s41, 21
    s_cselect_b32 s52, 0x40000000, s52
    s_waitcnt vmcnt(2)
    s_barrier
    ds_read_b64_tr_b16 v[16:17], v7 offset:0
    ds_read_b64_tr_b16 v[18:19], v7 offset:2048
    ds_read_b64_tr_b16 v[20:21], v7 offset:4096
    ds_read_b64_tr_b16 v[22:23], v7 offset:6144
    ds_read_b64_tr_b16 v[24:25], v7 offset:8192
    ds_read_b64_tr_b16 v[26:27], v7 offset:10240
    ds_read_b64_tr_b16 v[28:29], v7 offset:12288
    ds_read_b64_tr_b16 v[30:31], v7 offset:14336
    ds_read_b64_tr_b16 v[32:33], v7 offset:16384
    ds_read_b64_tr_b16 v[34:35], v7 offset:18432
    ds_read_b64_tr_b16 v[36:37], v7 offset:20480
    ds_read_b64_tr_b16 v[38:39], v7 offset:22528
    ds_read_b64_tr_b16 v[40:41], v7 offset:24576
    ds_read_b64_tr_b16 v[42:43], v7 offset:26624
    ds_read_b64_tr_b16 v[44:45], v7 offset:28672
    ds_read_b64_tr_b16 v[46:47], v7 offset:30720
    ds_read_b64_tr_b16 v[48:49], v7 offset:32768
    ds_read_b64_tr_b16 v[50:51], v7 offset:34816
    ds_read_b64_tr_b16 v[52:53], v7 offset:36864
    ds_read_b64_tr_b16 v[54:55], v7 offset:38912
    ds_read_b64_tr_b16 v[56:57], v7 offset:40960
    ds_read_b64_tr_b16 v[58:59], v7 offset:43008
    ds_read_b64_tr_b16 v[60:61], v7 offset:45056
    ds_read_b64_tr_b16 v[62:63], v7 offset:47104
    ds_read_b64_tr_b16 v[64:65], v7 offset:49152
    ds_read_b64_tr_b16 v[66:67], v7 offset:51200
    ds_read_b64_tr_b16 v[68:69], v7 offset:53248
    ds_read_b64_tr_b16 v[70:71], v7 offset:55296
    s_waitcnt lgkmcnt(15)
    v_mfma_f32_16x16x32_bf16 v[84:87], v[80:83], v[16:19], 0
    v_mfma_f32_16x16x32_bf16 v[84:87], v[80:83], v[20:23], v[84:87]
    v_mfma_f32_16x16x32_bf16 v[84:87], v[80:83], v[24:27], v[84:87]
    v_mfma_f32_16x16x32_bf16 v[84:87], v[80:83], v[28:31], v[84:87]
    v_mfma_f32_16x16x32_bf16 v[84:87], v[80:83], v[32:35], v[84:87]
    v_mfma_f32_16x16x32_bf16 v[84:87], v[80:83], v[36:39], v[84:87]
    s_waitcnt lgkmcnt(14)
    v_mfma_f32_16x16x32_bf16 v[84:87], v[80:83], v[40:43], v[84:87]
    s_waitcnt lgkmcnt(12)
    v_mfma_f32_16x16x32_bf16 v[84:87], v[80:83], v[44:47], v[84:87]
    s_waitcnt lgkmcnt(10)
    v_mfma_f32_16x16x32_bf16 v[84:87], v[80:83], v[48:51], v[84:87]
    s_waitcnt lgkmcnt(8)
    v_mfma_f32_16x16x32_bf16 v[84:87], v[80:83], v[52:55], v[84:87]
    s_waitcnt lgkmcnt(6)
    v_mfma_f32_16x16x32_bf16 v[84:87], v[80:83], v[56:59], v[84:87]
    s_waitcnt lgkmcnt(4)
    v_mfma_f32_16x16x32_bf16 v[84:87], v[80:83], v[60:63], v[84:87]
    s_waitcnt lgkmcnt(2)
    v_mfma_f32_16x16x32_bf16 v[84:87], v[80:83], v[64:67], v[84:87]
    s_waitcnt lgkmcnt(0)
    v_mfma_f32_16x16x32_bf16 v[84:87], v[80:83], v[68:71], v[84:87]
    s_nop 7
    v_mov_b32 v85, s45
    buffer_store_dwordx2 v[84:85], v13, s[36:39], s52 offen sc1
    s_add_u32 m0, s50, 0
    s_nop 0
    buffer_load_dwordx4 v10, s[16:19], s49 offen nt lds
    s_add_u32 m0, s50, 4096
    s_add_u32 s49, s49, 114688
    buffer_load_dwordx4 v10, s[16:19], s49 offen nt lds
    s_add_u32 m0, s50, 8192
    s_add_u32 s49, s49, 114688
    buffer_load_dwordx4 v10, s[16:19], s49 offen nt lds
    s_add_u32 m0, s50, 12288
    s_add_u32 s49, s49, 114688
    buffer_load_dwordx4 v10, s[16:19], s49 offen nt lds
    s_add_u32 m0, s50, 16384
    s_add_u32 s49, s49, 114688
    buffer_load_dwordx4 v10, s[16:19], s49 offen nt lds
    s_add_u32 m0, s50, 20480
    s_add_u32 s49, s49, 114688
    buffer_load_dwordx4 v10, s[16:19], s49 offen nt lds
    s_add_u32 m0, s50, 24576
    s_add_u32 s49, s49, 114688
    buffer_load_dwordx4 v10, s[16:19], s49 offen nt lds
    s_add_u32 m0, s50, 28672
    s_add_u32 s49, s49, 114688
    buffer_load_dwordx4 v10, s[16:19], s49 offen nt lds
    s_add_u32 m0, s50, 32768
    s_add_u32 s49, s49, 114688
    buffer_load_dwordx4 v10, s[16:19], s49 offen nt lds
    s_add_u32 m0, s50, 36864
    s_add_u32 s49, s49, 114688
    buffer_load_dwordx4 v10, s[16:19], s49 offen nt lds
    s_add_u32 m0, s50, 40960
    s_add_u32 s49, s49, 114688
    buffer_load_dwordx4 v10, s[16:19], s49 offen nt lds
    s_add_u32 m0, s50, 45056
    s_add_u32 s49, s49, 114688
    buffer_load_dwordx4 v10, s[16:19], s49 offen nt lds
    s_add_u32 m0, s50, 49152
    s_add_u32 s49, s49, 114688
    buffer_load_dwordx4 v10, s[16:19], s49 offen nt lds
    s_add_u32 m0, s50, 53248
    s_add_u32 s49, s49, 114688
    buffer_load_dwordx4 v10, s[16:19], s49 offen nt lds
    s_cmp_ge_u32 s41, 28
    s_cbranch_scc1 L_pack_done
    s_mul_i32 s52, s51, 37
    s_lshr_b32 s52, s52, 8
    s_mul_i32 s53, s52, 7
    s_sub_u32 s53, s51, s53
    s_cmp_eq_u32 s53, -1
    s_cselect_b32 s54, 1, 0
    s_sub_u32 s52, s52, s54
    s_mul_i32 s53, s52, 7
    s_sub_u32 s53, s51, s53
    s_mul_i32 s52, s52, 100352
    s_lshl_b32 s53, s53, 10
    s_add_u32 s52, s52, s53
    s_add_u32 s52, s52, 22020096
    v_lshlrev_b32 v9, 4, v1
    s_waitcnt vmcnt(0)
    s_barrier
    ds_read_b64_tr_b16 a[0:1], v8 offset:0
    ds_read_b64_tr_b16 a[2:3], v8 offset:2048
    ds_read_b64_tr_b16 a[4:5], v8 offset:4096
    ds_read_b64_tr_b16 a[6:7], v8 offset:6144
    ds_read_b64_tr_b16 a[16:17], v8 offset:8192
    ds_read_b64_tr_b16 a[18:19], v8 offset:10240
    ds_read_b64_tr_b16 a[20:21], v8 offset:12288
    ds_read_b64_tr_b16 a[22:23], v8 offset:14336
    ds_read_b64_tr_b16 a[32:33], v8 offset:16384
    ds_read_b64_tr_b16 a[34:35], v8 offset:18432
    ds_read_b64_tr_b16 a[36:37], v8 offset:20480
    ds_read_b64_tr_b16 a[38:39], v8 offset:22528
    ds_read_b64_tr_b16 a[48:49], v8 offset:24576
    ds_read_b64_tr_b16 a[50:51], v8 offset:26624
    ds_read_b64_tr_b16 a[52:53], v8 offset:28672
    ds_read_b64_tr_b16 a[54:55], v8 offset:30720
    ds_read_b64_tr_b16 a[64:65], v8 offset:32768
    ds_read_b64_tr_b16 a[66:67], v8 offset:34816
    ds_read_b64_tr_b16 a[68:69], v8 offset:36864
    ds_read_b64_tr_b16 a[70:71], v8 offset:38912
    ds_read_b64_tr_b16 a[80:81], v8 offset:40960
    ds_read_b64_tr_b16 a[82:83], v8 offset:43008
    ds_read_b64_tr_b16 a[84:85], v8 offset:45056
    ds_read_b64_tr_b16 a[86:87], v8 offset:47104
    ds_read_b64_tr_b16 a[96:97], v8 offset:49152
    ds_read_b64_tr_b16 a[98:99], v8 offset:51200
    ds_read_b64_tr_b16 a[100:101], v8 offset:53248
    ds_read_b64_tr_b16 a[102:103], v8 offset:55296
    s_waitcnt lgkmcnt(15)
    v_mfma_f32_16x16x32_bf16 v[72:75], v[80:83], a[0:3], 0
    v_mfma_f32_16x16x32_bf16 v[72:75], v[80:83], a[4:7], v[72:75]
    v_mfma_f32_16x16x32_bf16 v[72:75], v[80:83], a[16:19], v[72:75]
    v_mfma_f32_16x16x32_bf16 v[72:75], v[80:83], a[20:23], v[72:75]
    v_mfma_f32_16x16x32_bf16 v[72:75], v[80:83], a[32:35], v[72:75]
    v_mfma_f32_16x16x32_bf16 v[72:75], v[80:83], a[36:39], v[72:75]
    s_waitcnt lgkmcnt(14)
    v_mfma_f32_16x16x32_bf16 v[72:75], v[80:83], a[48:51], v[72:75]
    s_waitcnt lgkmcnt(12)
    v_mfma_f32_16x16x32_bf16 v[72:75], v[80:83], a[52:55], v[72:75]
    s_waitcnt lgkmcnt(10)
    v_mfma_f32_16x16x32_bf16 v[72:75], v[80:83], a[64:67], v[72:75]
    s_waitcnt lgkmcnt(8)
    v_mfma_f32_16x16x32_bf16 v[72:75], v[80:83], a[68:71], v[72:75]
    s_waitcnt lgkmcnt(6)
    v_mfma_f32_16x16x32_bf16 v[72:75], v[80:83], a[80:83], v[72:75]
    s_waitcnt lgkmcnt(4)
    v_mfma_f32_16x16x32_bf16 v[72:75], v[80:83], a[84:87], v[72:75]
    s_waitcnt lgkmcnt(2)
    v_mfma_f32_16x16x32_bf16 v[72:75], v[80:83], a[96:99], v[72:75]
    s_waitcnt lgkmcnt(0)
    v_mfma_f32_16x16x32_bf16 v[72:75], v[80:83], a[100:103], v[72:75]
    s_mov_b32 s71, s52
    s_lshl_b32 s52, s51, 6
    s_add_u32 s52, s52, 32768
    s_nop 4
    buffer_store_dword v72, v12, s[36:39], s52 offen sc1
L_pack_done:
    s_barrier
    s_branch L_p1_out
L_p1_sig:
    s_lshl_b32 s49, s42, 9
    s_lshr_b32 s50, s41, 3
    s_lshl_b32 s50, s50, 7
    s_add_u32 s49, s49, s50
    s_and_b32 s50, s41, 7
    s_lshl_b32 s50, s50, 2
    s_add_u32 s49, s49, s50
    s_add_u32 s49, s49, 4096
    s_waitcnt vmcnt(0)
    s_barrier
    s_cmp_lg_u32 s40, 0
    s_cbranch_scc1 L_sig_4
    v_mov_b32 v242, s45
    v_mov_b32 v243, 0
    s_mov_b64 exec, 1
    buffer_store_dword v242, v243, s[36:39], s49 offen sc1
    s_mov_b64 exec, -1
L_sig_4:
L_p1_out:
    v_lshlrev_b32 v2, 4, v1
    s_mul_i32 s68, s42, 100352
    s_add_u32 s68, s68, 22020096
    s_lshl_b32 s69, s40, 10
    s_lshl_b32 s47, s41, 2
    s_add_u32 s47, s47, s40
    s_and_b32 s70, s41, 3
    v_lshrrev_b32 v224, 3, v1
    v_and_b32 v225, 7, v1
    v_and_b32 v255, 6, v224
    v_xor_b32 v225, v225, v255
    v_mul_u32_u24 v255, 896, v224
    v_lshl_add_u32 v255, v225, 4, v255
    v_and_b32 v227, 15, v1
    v_lshrrev_b32 v228, 4, v1
    v_mul_u32_u24 v227, 896, v227
    v_lshl_add_u32 v227, v228, 3, v227
    s_mul_i32 s62, s47, 14336
    s_min_u32 s55, s42, 6
    s_lshl_b32 s55, s55, 7
    s_add_u32 s62, s62, s55
    buffer_load_dwordx2 v[240:241], v227, s[4:7], s62 offen offset:0
    s_mul_i32 s49, s43, 28
    s_lshr_b32 s50, s49, 6
    s_add_u32 s49, s49, 27
    s_lshr_b32 s51, s49, 6
    s_lshl_b32 s50, s50, 9
    s_lshl_b32 s51, s51, 9
    s_lshl_b32 s52, s44, 1
    s_lshr_b32 s53, s40, 1
    s_add_u32 s52, s52, s53
    s_lshr_b32 s53, s52, 3
    s_lshl_b32 s53, s53, 7
    s_and_b32 s52, s52, 7
    s_lshl_b32 s52, s52, 2
    s_add_u32 s52, s52, s53
    s_lshl_b32 s53, s40, 7
    v_and_b32 v8, 7, v1
    v_lshl_add_u32 v8, v8, 2, s53
    v_mov_b32 v9, s52
    v_cmp_gt_u32 vcc, 16, v1
    s_nop 1
    v_cndmask_b32 v8, v9, v8, vcc
    v_mov_b32 v9, s50
    v_mov_b32 v10, s51
    v_and_b32 v11, 8, v1
    v_cmp_eq_u32 vcc, 0, v11
    s_nop 1
    v_cndmask_b32 v9, v10, v9, vcc
    v_add_u32 v8, v8, v9
    v_add_u32 v3, 4096, v8
    v_min_u32 v9, 55, v1
    v_lshrrev_b32 v253, 2, v9
    v_and_b32 v9, 3, v9
    v_lshlrev_b32 v253, 7, v253
    v_lshl_add_u32 v253, v9, 3, v253
    v_add_u32 v253, 20480, v253
    s_lshl_b32 s54, s43, 18
    s_lshl_b32 s55, s40, 16
    s_add_u32 s50, s54, s55
    s_add_u32 s50, s50, 5242880
    s_lshl_b32 s55, s44, 2
    s_add_u32 s55, s55, s40
    s_lshl_b32 s55, s55, 12
    s_add_u32 s54, s54, s55
    s_add_u32 s54, s54, 1048576
    s_mov_b32 s53, 0
    s_mul_i32 s57, s40, 12288
    s_add_u32 s57, s57, 114688
    buffer_load_dwordx2 v[242:243], v227, s[4:7], s62 offen offset:32
    v_add_u32 v5, s57, v2
    s_add_u32 s55, s40, 1
    s_and_b32 s55, s55, 3
    s_mul_i32 s56, s55, 12288
    s_add_u32 s56, s56, 114688
    v_add_u32 v8, s56, v2
    s_add_u32 s55, s40, 2
    s_and_b32 s55, s55, 3
    s_mul_i32 s56, s55, 12288
    s_add_u32 s56, s56, 114688
    v_add_u32 v9, s56, v2
    s_add_u32 s55, s40, 3
    s_and_b32 s55, s55, 3
    s_mul_i32 s56, s55, 12288
    s_add_u32 s56, s56, 114688
    v_add_u32 v10, s56, v2
    v_lshrrev_b32 v224, 3, v1
    v_and_b32 v225, 7, v1
    v_lshrrev_b32 v226, 1, v224
    v_xor_b32 v225, v225, v226
    v_lshlrev_b32 v224, 12, v224
    v_lshl_add_u32 v12, v225, 4, v224
    v_xor_b32 v13, 64, v12
    v_add_u32 v13, 0x8000, v13
    v_and_b32 v224, 15, v1
    v_lshrrev_b32 v225, 4, v1
    v_lshrrev_b32 v226, 1, v224
    v_xor_b32 v225, v225, v226
    v_lshrrev_b32 v226, 3, v224
    v_and_b32 v224, 7, v224
    v_lshlrev_b32 v226, 12, v226
    v_lshl_add_u32 v226, v224, 7, v226
    v_lshl_add_u32 v226, v225, 4, v226
    s_and_b32 s49, s70, 1
    s_lshl_b32 s49, s49, 6
    v_xor_b32 v226, s49, v226
    v_add_u32 v14, s57, v226
    v_xor_b32 v226, 64, v226
    v_add_u32 v15, s57, v226
    s_lshr_b32 s55, s2, 3
    s_lshl_b32 s55, s55, 2
    s_add_u32 s55, s55, s40
    v_lshlrev_b32 v224, 7, v1
    s_mul_i32 s56, s55, 6272
    v_min_u32 v225, 1536, v224
    buffer_load_dwordx2 v[244:245], v227, s[4:7], s62 offen offset:64
    v_add_u32 v248, s56, v225
    v_add_u32 v249, 22020096, v248
    v_and_b32 v224, 1, v1
    v_bfe_u32 v225, v1, 1, 2
    v_bfe_u32 v226, v1, 3, 2
    v_lshlrev_b32 v224, 7, v224
    v_lshl_add_u32 v224, v225, 10, v224
    v_lshl_add_u32 v224, v226, 12, v224
    s_lshr_b32 s55, s42, 2
    s_add_u32 s55, s55, s40
    s_add_u32 s55, s55, 3
    s_and_b32 s55, s55, 3
    s_lshl_b32 s55, s55, 2
    s_and_b32 s56, s42, 3
    s_add_u32 s55, s55, s56
    s_lshl_b32 s55, s55, 14
    s_lshl_b32 s56, s41, 18
    s_add_u32 s55, s55, s56
    s_lshl_b32 s56, s40, 8
    s_add_u32 s55, s55, s56
    v_add_u32 v250, s55, v224
    s_mul_i32 s63, s40, 14336
    s_add_u32 s63, s63, 57344
    s_sub_u32 s55, s63, s57
    v_add_u32 v251, s55, v14
    v_add_u32 v252, s55, v15
    v_mov_b32 v48, 0
    v_mov_b32 v49, 0
    v_mov_b32 v50, 0
    v_mov_b32 v51, 0
    v_mov_b32 v52, 0
    v_mov_b32 v53, 0
    v_mov_b32 v54, 0
    v_mov_b32 v55, 0
    v_mov_b32 v56, 0
    v_mov_b32 v57, 0
    v_mov_b32 v58, 0
    v_mov_b32 v59, 0
    v_mov_b32 v60, 0
    v_mov_b32 v61, 0
    v_mov_b32 v62, 0
    v_mov_b32 v63, 0
    v_mov_b32 v64, 0
    v_mov_b32 v65, 0
    v_mov_b32 v66, 0
    buffer_load_dwordx2 v[246:247], v227, s[4:7], s62 offen offset:96
    v_mov_b32 v67, 0
    v_mov_b32 v68, 0
    v_mov_b32 v69, 0
    v_mov_b32 v70, 0
    v_mov_b32 v71, 0
    v_mov_b32 v72, 0
    v_mov_b32 v73, 0
    v_mov_b32 v74, 0
    v_mov_b32 v75, 0
    v_mov_b32 v76, 0
    v_mov_b32 v77, 0
    v_mov_b32 v78, 0
    v_mov_b32 v79, 0
    v_mov_b32 v80, 0
    v_mov_b32 v81, 0
    v_mov_b32 v82, 0
    v_mov_b32 v83, 0
    v_mov_b32 v84, 0
    v_mov_b32 v85, 0
    v_mov_b32 v86, 0
    v_mov_b32 v87, 0
    v_mov_b32 v88, 0
    v_mov_b32 v89, 0
    v_mov_b32 v90, 0
    v_mov_b32 v91, 0
    v_mov_b32 v92, 0
    v_mov_b32 v93, 0
    v_mov_b32 v94, 0
    v_mov_b32 v95, 0
    v_mov_b32 v96, 0
    v_mov_b32 v97, 0
    v_mov_b32 v98, 0
    v_mov_b32 v99, 0
    v_mov_b32 v100, 0
    v_mov_b32 v101, 0
    v_mov_b32 v102, 0
    v_mov_b32 v103, 0
    v_mov_b32 v104, 0
    v_mov_b32 v105, 0
    v_mov_b32 v106, 0
    v_mov_b32 v107, 0
    v_mov_b32 v108, 0
    v_mov_b32 v109, 0
    v_mov_b32 v110, 0
    v_mov_b32 v111, 0
    buffer_load_dword v4, v3, s[36:39], 0 offen sc1
    s_mov_b32 s48, 0
    s_mov_b32 s51, 0
    s_branch L_pollc_6
L_poll_5:
    s_cmp_lg_u32 s51, 0
    s_cbranch_scc1 L_pollo_8
    s_mov_b32 s51, 1
    s_cmp_le_u32 s71, 1
    s_cbranch_scc1 L_ps_9
    s_add_u32 s62, s71, 0
    buffer_store_dwordx4 a[0:3], v2, s[36:39], s62 offen sc1
    s_add_u32 s62, s71, 7168
    buffer_store_dwordx4 a[4:7], v2, s[36:39], s62 offen sc1
    s_add_u32 s62, s71, 14336
    buffer_store_dwordx4 a[16:19], v2, s[36:39], s62 offen sc1
    s_add_u32 s62, s71, 21504
    buffer_store_dwordx4 a[20:23], v2, s[36:39], s62 offen sc1
    s_add_u32 s62, s71, 28672
    buffer_store_dwordx4 a[32:35], v2, s[36:39], s62 offen sc1
    s_add_u32 s62, s71, 35840
    buffer_store_dwordx4 a[36:39], v2, s[36:39], s62 offen sc1
    s_add_u32 s62, s71, 43008
    buffer_store_dwordx4 a[48:51], v2, s[36:39], s62 offen sc1
    s_add_u32 s62, s71, 50176
    buffer_store_dwordx4 a[52:55], v2, s[36:39], s62 offen sc1
    s_add_u32 s62, s71, 57344
    buffer_store_dwordx4 a[64:67], v2, s[36:39], s62 offen sc1
    s_add_u32 s62, s71, 64512
    buffer_store_dwordx4 a[68:71], v2, s[36:39], s62 offen sc1
    s_add_u32 s62, s71, 71680
    buffer_store_dwordx4 a[80:83], v2, s[36:39], s62 offen sc1
    s_add_u32 s62, s71, 78848
    buffer_store_dwordx4 a[84:87], v2, s[36:39], s62 offen sc1
    s_add_u32 s62, s71, 86016
    buffer_store_dwordx4 a[96:99], v2, s[36:39], s62 offen sc1
    s_add_u32 s62, s71, 93184
    buffer_store_dwordx4 a[100:103], v2, s[36:39], s62 offen sc1
L_ps_9:
    s_min_u32 s71, s71, 1
L_pollo_8:
    buffer_load_dword v4, v3, s[36:39], 0 offen sc1
L_pollc_6:
    s_add_u32 s48, s48, 1
    s_cmp_gt_u32 s48, 0x80000
    s_waitcnt vmcnt(0)
    s_cbranch_scc1 L_polld_7
    v_cmp_ne_u32 vcc, s45, v4
    s_nop 1
    s_cbranch_vccnz L_poll_5
L_polld_7:
    buffer_load_dwordx4 v[40:43], v2, s[36:39], s54 offen offset:0 sc1
    buffer_load_dwordx4 v[44:47], v2, s[36:39], s54 offen offset:1024 sc1
    s_mov_b32 s52, s50
    buffer_load_dwordx4 v[160:163], v2, s[36:39], s52 offen offset:0 sc1
    buffer_load_dwordx4 v[164:167], v2, s[36:39], s52 offen offset:1024 sc1
    buffer_load_dwordx4 v[168:171], v2, s[36:39], s52 offen offset:2048 sc1
    buffer_load_dwordx4 v[172:175], v2, s[36:39], s52 offen offset:3072 sc1
    s_add_u32 s52, s52, 4096
    buffer_load_dwordx4 v[176:179], v2, s[36:39], s52 offen offset:0 sc1
    buffer_load_dwordx4 v[180:183], v2, s[36:39], s52 offen offset:1024 sc1
    s_cmp_le_u32 s71, 1
    s_cbranch_scc1 L_ps_11
    s_add_u32 s62, s71, 0
    buffer_store_dwordx4 a[0:3], v2, s[36:39], s62 offen sc1
    s_add_u32 s62, s71, 7168
    buffer_store_dwordx4 a[4:7], v2, s[36:39], s62 offen sc1
    s_add_u32 s62, s71, 14336
    buffer_store_dwordx4 a[16:19], v2, s[36:39], s62 offen sc1
    s_add_u32 s62, s71, 21504
    buffer_store_dwordx4 a[20:23], v2, s[36:39], s62 offen sc1
    s_add_u32 s62, s71, 28672
    buffer_store_dwordx4 a[32:35], v2, s[36:39], s62 offen sc1
    s_add_u32 s62, s71, 35840
    buffer_store_dwordx4 a[36:39], v2, s[36:39], s62 offen sc1
    s_add_u32 s62, s71, 43008
    buffer_store_dwordx4 a[48:51], v2, s[36:39], s62 offen sc1
    s_add_u32 s62, s71, 50176
    buffer_store_dwordx4 a[52:55], v2, s[36:39], s62 offen sc1
    s_add_u32 s62, s71, 57344
    buffer_store_dwordx4 a[64:67], v2, s[36:39], s62 offen sc1
    s_add_u32 s62, s71, 64512
    buffer_store_dwordx4 a[68:71], v2, s[36:39], s62 offen sc1
    s_add_u32 s62, s71, 71680
    buffer_store_dwordx4 a[80:83], v2, s[36:39], s62 offen sc1
    s_add_u32 s62, s71, 78848
    buffer_store_dwordx4 a[84:87], v2, s[36:39], s62 offen sc1
    s_add_u32 s62, s71, 86016
    buffer_store_dwordx4 a[96:99], v2, s[36:39], s62 offen sc1
    s_add_u32 s62, s71, 93184
    buffer_store_dwordx4 a[100:103], v2, s[36:39], s62 offen sc1
    s_waitcnt vmcnt(18)
    s_branch L_pe_12
L_ps_11:
    s_waitcnt vmcnt(4)
L_pe_12:
    v_mfma_f32_32x32x16_bf16 v[112:127], v[160:163], v[40:43], 0
    v_mfma_f32_32x32x16_bf16 v[112:127], v[164:167], v[44:47], v[112:127]
    buffer_load_dwordx4 v[184:187], v2, s[36:39], s52 offen offset:2048 sc1
    buffer_load_dwordx4 v[188:191], v2, s[36:39], s52 offen offset:3072 sc1
    s_add_u32 s52, s52, 4096
    s_nop 8
    v_max3_f32 v224, v112, v113, v114
    v_max3_f32 v225, v115, v116, v117
    v_max3_f32 v224, v224, v118, v119
    v_max3_f32 v225, v225, v120, v121
    v_max3_f32 v224, v224, v122, v123
    v_max3_f32 v225, v225, v124, v125
    v_max3_f32 v224, v224, v126, v127
    v_max_f32 v224, v224, v225
    v_mov_b32 v225, v224
    s_nop 1
    v_permlane32_swap_b32 v224, v225
    v_max_f32 v224, v224, v225
    v_cvt_pk_bf16_f32 v224, -v224, 0
    s_mov_b64 exec, s[64:65]
    s_bitcmp1_b32 s43, 0
    s_cbranch_scc1 L_odd_13
    v_mov_b32 v46, v224
    s_branch L_pd_14
L_odd_13:
    v_mov_b32 v44, v224
L_pd_14:
    s_mov_b64 exec, -1
    ds_write_b128 v5, v[40:43]
    ds_write_b128 v5, v[44:47] offset:1024
    s_waitcnt lgkmcnt(0)
    s_barrier
    ds_read_b128 v[16:19], v8 offset:0
    ds_read_b128 v[20:23], v8 offset:1024
    ds_read_b128 v[24:27], v9 offset:0
    ds_read_b128 v[28:31], v9 offset:1024
    ds_read_b128 v[32:35], v10 offset:0
    ds_read_b128 v[36:39], v10 offset:1024
L_att_main:
    buffer_load_dwordx4 v[192:195], v2, s[36:39], s52 offen offset:0 sc1
    buffer_load_dwordx4 v[196:199], v2, s[36:39], s52 offen offset:1024 sc1
    s_waitcnt lgkmcnt(5)
    v_mfma_f32_32x32x16_bf16 v[112:127], v[160:163], v[16:19], 0
    s_waitcnt lgkmcnt(4)
    v_mfma_f32_32x32x16_bf16 v[112:127], v[164:167], v[20:23], v[112:127]
    buffer_load_dwordx4 v[200:203], v2, s[36:39], s52 offen offset:2048 sc1
    buffer_load_dwordx4 v[204:207], v2, s[36:39], s52 offen offset:3072 sc1
    s_add_u32 s52, s52, 4096
    s_cmp_le_u32 s71, 1
    s_cbranch_scc1 L_ps_15
L_ps_15:
    s_waitcnt lgkmcnt(0)
    s_barrier
    v_mfma_f32_32x32x16_bf16 v[128:143], v[160:163], v[24:27], 0
    s_nop 3
    v_exp_f32 v112, v112
    v_exp_f32 v113, v113
    v_exp_f32 v114, v114
    v_exp_f32 v115, v115
    v_cvt_pk_bf16_f32 v144, v112, v113
    v_cvt_pk_bf16_f32 v145, v114, v115
    v_mfma_f32_32x32x16_bf16 v[128:143], v[164:167], v[28:31], v[128:143]
    buffer_load_dwordx4 v[208:211], v2, s[36:39], s52 offen offset:0 sc1
    v_exp_f32 v116, v116
    v_exp_f32 v117, v117
    v_exp_f32 v118, v118
    v_exp_f32 v119, v119
    v_cvt_pk_bf16_f32 v146, v116, v117
    v_cvt_pk_bf16_f32 v147, v118, v119
    buffer_load_dwordx4 v[212:215], v2, s[36:39], s52 offen offset:1024 sc1
    v_exp_f32 v120, v120
    v_exp_f32 v121, v121
    v_exp_f32 v122, v122
    v_exp_f32 v123, v123
    v_cvt_pk_bf16_f32 v148, v120, v121
    v_cvt_pk_bf16_f32 v149, v122, v123
    buffer_load_dwordx4 v[216:219], v2, s[36:39], s52 offen offset:2048 sc1
    v_exp_f32 v124, v124
    v_exp_f32 v125, v125
    v_exp_f32 v126, v126
    v_exp_f32 v127, v127
    v_cvt_pk_bf16_f32 v150, v124, v125
    v_cvt_pk_bf16_f32 v151, v126, v127
    v_mfma_f32_32x32x16_bf16 v[112:127], v[160:163], v[32:35], 0
    v_exp_f32 v128, v128
    v_exp_f32 v129, v129
    v_exp_f32 v130, v130
    v_exp_f32 v131, v131
    v_cvt_pk_bf16_f32 v152, v128, v129
    v_cvt_pk_bf16_f32 v153, v130, v131
    v_mfma_f32_32x32x16_bf16 v[112:127], v[164:167], v[36:39], v[112:127]
    buffer_load_dwordx4 v[220:223], v2, s[36:39], s52 offen offset:3072 sc1
    s_add_u32 s52, s52, 4096
    v_exp_f32 v132, v132
    v_exp_f32 v133, v133
    v_exp_f32 v134, v134
    v_exp_f32 v135, v135
    v_cvt_pk_bf16_f32 v154, v132, v133
    v_cvt_pk_bf16_f32 v155, v134, v135
    s_waitcnt vmcnt(13)
    v_mfma_f32_32x32x16_bf16 v[48:63], v[168:171], v[144:147], v[48:63]
    buffer_load_dwordx4 a[8:11], v2, s[36:39], s52 offen offset:0 sc1
    v_exp_f32 v136, v136
    v_exp_f32 v137, v137
    v_exp_f32 v138, v138
    v_exp_f32 v139, v139
    v_cvt_pk_bf16_f32 v156, v136, v137
    v_cvt_pk_bf16_f32 v157, v138, v139
    s_waitcnt vmcnt(13)
    v_mfma_f32_32x32x16_bf16 v[48:63], v[172:175], v[148:151], v[48:63]
    buffer_load_dwordx4 a[12:15], v2, s[36:39], s52 offen offset:1024 sc1
    v_exp_f32 v140, v140
    v_exp_f32 v141, v141
    v_exp_f32 v142, v142
    v_exp_f32 v143, v143
    v_cvt_pk_bf16_f32 v158, v140, v141
    v_cvt_pk_bf16_f32 v159, v142, v143
    v_mfma_f32_32x32x16_bf16 v[128:143], v[160:163], v[40:43], 0
    v_exp_f32 v112, v112
    v_exp_f32 v113, v113
    v_exp_f32 v114, v114
    v_exp_f32 v115, v115
    v_cvt_pk_bf16_f32 v144, v112, v113
    v_cvt_pk_bf16_f32 v145, v114, v115
    v_mfma_f32_32x32x16_bf16 v[128:143], v[164:167], v[44:47], v[128:143]
    buffer_load_dwordx4 a[24:27], v2, s[36:39], s52 offen offset:2048 sc1
    v_exp_f32 v116, v116
    v_exp_f32 v117, v117
    v_exp_f32 v118, v118
    v_exp_f32 v119, v119
    v_cvt_pk_bf16_f32 v146, v116, v117
    v_cvt_pk_bf16_f32 v147, v118, v119
    v_mfma_f32_32x32x16_bf16 v[64:79], v[168:171], v[152:155], v[64:79]
    buffer_load_dwordx4 a[28:31], v2, s[36:39], s52 offen offset:3072 sc1
    s_add_u32 s52, s52, 4096
    v_exp_f32 v120, v120
    v_exp_f32 v121, v121
    v_exp_f32 v122, v122
    v_exp_f32 v123, v123
    v_cvt_pk_bf16_f32 v148, v120, v121
    v_cvt_pk_bf16_f32 v149, v122, v123
    v_mfma_f32_32x32x16_bf16 v[64:79], v[172:175], v[156:159], v[64:79]
    buffer_load_dwordx4 a[40:43], v2, s[36:39], s52 offen offset:0 sc1
    v_exp_f32 v124, v124
    v_exp_f32 v125, v125
    v_exp_f32 v126, v126
    v_exp_f32 v127, v127
    v_cvt_pk_bf16_f32 v150, v124, v125
    v_cvt_pk_bf16_f32 v151, v126, v127
    s_waitcnt vmcnt(13)
    v_mfma_f32_32x32x16_bf16 v[112:127], v[176:179], v[16:19], 0
    v_exp_f32 v128, v128
    v_exp_f32 v129, v129
    v_exp_f32 v130, v130
    v_exp_f32 v131, v131
    v_cvt_pk_bf16_f32 v152, v128, v129
    v_cvt_pk_bf16_f32 v153, v130, v131
    v_mfma_f32_32x32x16_bf16 v[112:127], v[180:183], v[20:23], v[112:127]
    buffer_load_dwordx4 a[44:47], v2, s[36:39], s52 offen offset:1024 sc1
    v_exp_f32 v132, v132
    v_exp_f32 v133, v133
    v_exp_f32 v134, v134
    v_exp_f32 v135, v135
    v_cvt_pk_bf16_f32 v154, v132, v133
    v_cvt_pk_bf16_f32 v155, v134, v135
    v_mfma_f32_32x32x16_bf16 v[80:95], v[168:171], v[144:147], v[80:95]
    buffer_load_dwordx4 a[56:59], v2, s[36:39], s52 offen offset:2048 sc1
    v_exp_f32 v136, v136
    v_exp_f32 v137, v137
    v_exp_f32 v138, v138
    v_exp_f32 v139, v139
    v_cvt_pk_bf16_f32 v156, v136, v137
    v_cvt_pk_bf16_f32 v157, v138, v139
    v_mfma_f32_32x32x16_bf16 v[80:95], v[172:175], v[148:151], v[80:95]
    buffer_load_dwordx4 a[60:63], v2, s[36:39], s52 offen offset:3072 sc1
    s_add_u32 s52, s52, 4096
    v_exp_f32 v140, v140
    v_exp_f32 v141, v141
    v_exp_f32 v142, v142
    v_exp_f32 v143, v143
    v_cvt_pk_bf16_f32 v158, v140, v141
    v_cvt_pk_bf16_f32 v159, v142, v143
    v_mfma_f32_32x32x16_bf16 v[128:143], v[176:179], v[24:27], 0
    v_exp_f32 v112, v112
    v_exp_f32 v113, v113
    v_exp_f32 v114, v114
    v_exp_f32 v115, v115
    v_cvt_pk_bf16_f32 v144, v112, v113
    v_cvt_pk_bf16_f32 v145, v114, v115
    v_mfma_f32_32x32x16_bf16 v[128:143], v[180:183], v[28:31], v[128:143]
    buffer_load_dwordx4 a[72:75], v2, s[36:39], s52 offen offset:0 sc1
    v_exp_f32 v116, v116
    v_exp_f32 v117, v117
    v_exp_f32 v118, v118
    v_exp_f32 v119, v119
    v_cvt_pk_bf16_f32 v146, v116, v117
    v_cvt_pk_bf16_f32 v147, v118, v119
    v_mfma_f32_32x32x16_bf16 v[96:111], v[168:171], v[152:155], v[96:111]
    buffer_load_dwordx4 a[76:79], v2, s[36:39], s52 offen offset:1024 sc1
    v_exp_f32 v120, v120
    v_exp_f32 v121, v121
    v_exp_f32 v122, v122
    v_exp_f32 v123, v123
    v_cvt_pk_bf16_f32 v148, v120, v121
    v_cvt_pk_bf16_f32 v149, v122, v123
    v_mfma_f32_32x32x16_bf16 v[96:111], v[172:175], v[156:159], v[96:111]
    buffer_load_dwordx4 a[88:91], v2, s[36:39], s52 offen offset:2048 sc1
    v_exp_f32 v124, v124
    v_exp_f32 v125, v125
    v_exp_f32 v126, v126
    v_exp_f32 v127, v127
    v_cvt_pk_bf16_f32 v150, v124, v125
    v_cvt_pk_bf16_f32 v151, v126, v127
    v_mfma_f32_32x32x16_bf16 v[112:127], v[176:179], v[32:35], 0
    v_exp_f32 v128, v128
    v_exp_f32 v129, v129
    v_exp_f32 v130, v130
    v_exp_f32 v131, v131
    v_cvt_pk_bf16_f32 v152, v128, v129
    v_cvt_pk_bf16_f32 v153, v130, v131
    v_mfma_f32_32x32x16_bf16 v[112:127], v[180:183], v[36:39], v[112:127]
    buffer_load_dwordx4 a[92:95], v2, s[36:39], s52 offen offset:3072 sc1
    s_add_u32 s52, s52, 4096
    v_exp_f32 v132, v132
    v_exp_f32 v133, v133
    v_exp_f32 v134, v134
    v_exp_f32 v135, v135
    v_cvt_pk_bf16_f32 v154, v132, v133
    v_cvt_pk_bf16_f32 v155, v134, v135
    v_mfma_f32_32x32x16_bf16 v[48:63], v[184:187], v[144:147], v[48:63]
    buffer_load_dwordx4 a[104:107], v2, s[36:39], s52 offen offset:0 sc1
    v_exp_f32 v136, v136
    v_exp_f32 v137, v137
    v_exp_f32 v138, v138
    v_exp_f32 v139, v139
    v_cvt_pk_bf16_f32 v156, v136, v137
    v_cvt_pk_bf16_f32 v157, v138, v139
    v_mfma_f32_32x32x16_bf16 v[48:63], v[188:191], v[148:151], v[48:63]
    buffer_load_dwordx4 a[108:111], v2, s[36:39], s52 offen offset:1024 sc1
    v_exp_f32 v140, v140
    v_exp_f32 v141, v141
    v_exp_f32 v142, v142
    v_exp_f32 v143, v143
    v_cvt_pk_bf16_f32 v158, v140, v141
    v_cvt_pk_bf16_f32 v159, v142, v143
    v_mfma_f32_32x32x16_bf16 v[128:143], v[176:179], v[40:43], 0
    v_exp_f32 v112, v112
    v_exp_f32 v113, v113
    v_exp_f32 v114, v114
    v_exp_f32 v115, v115
    v_cvt_pk_bf16_f32 v144, v112, v113
    v_cvt_pk_bf16_f32 v145, v114, v115
    v_mfma_f32_32x32x16_bf16 v[128:143], v[180:183], v[44:47], v[128:143]
    buffer_load_dwordx4 a[120:123], v2, s[36:39], s52 offen offset:2048 sc1
    v_exp_f32 v116, v116
    v_exp_f32 v117, v117
    v_exp_f32 v118, v118
    v_exp_f32 v119, v119
    v_cvt_pk_bf16_f32 v146, v116, v117
    v_cvt_pk_bf16_f32 v147, v118, v119
    v_mfma_f32_32x32x16_bf16 v[64:79], v[184:187], v[152:155], v[64:79]
    buffer_load_dwordx4 a[124:127], v2, s[36:39], s52 offen offset:3072 sc1
    s_add_u32 s52, s52, 4096
    v_exp_f32 v120, v120
    v_exp_f32 v121, v121
    v_exp_f32 v122, v122
    v_exp_f32 v123, v123
    v_cvt_pk_bf16_f32 v148, v120, v121
    v_cvt_pk_bf16_f32 v149, v122, v123
    v_mfma_f32_32x32x16_bf16 v[64:79], v[188:191], v[156:159], v[64:79]
    buffer_load_dwordx4 a[136:139], v2, s[36:39], s52 offen offset:0 sc1
    v_exp_f32 v124, v124
    v_exp_f32 v125, v125
    v_exp_f32 v126, v126
    v_exp_f32 v127, v127
    v_cvt_pk_bf16_f32 v150, v124, v125
    v_cvt_pk_bf16_f32 v151, v126, v127
    s_waitcnt vmcnt(21)
    v_mfma_f32_32x32x16_bf16 v[112:127], v[192:195], v[16:19], 0
    v_exp_f32 v128, v128
    v_exp_f32 v129, v129
    v_exp_f32 v130, v130
    v_exp_f32 v131, v131
    v_cvt_pk_bf16_f32 v152, v128, v129
    v_cvt_pk_bf16_f32 v153, v130, v131
    v_mfma_f32_32x32x16_bf16 v[112:127], v[196:199], v[20:23], v[112:127]
    buffer_load_dwordx4 a[140:143], v2, s[36:39], s52 offen offset:1024 sc1
    v_exp_f32 v132, v132
    v_exp_f32 v133, v133
    v_exp_f32 v134, v134
    v_exp_f32 v135, v135
    v_cvt_pk_bf16_f32 v154, v132, v133
    v_cvt_pk_bf16_f32 v155, v134, v135
    v_mfma_f32_32x32x16_bf16 v[80:95], v[184:187], v[144:147], v[80:95]
    buffer_load_dwordx4 a[152:155], v2, s[36:39], s52 offen offset:2048 sc1
    v_exp_f32 v136, v136
    v_exp_f32 v137, v137
    v_exp_f32 v138, v138
    v_exp_f32 v139, v139
    v_cvt_pk_bf16_f32 v156, v136, v137
    v_cvt_pk_bf16_f32 v157, v138, v139
    v_mfma_f32_32x32x16_bf16 v[80:95], v[188:191], v[148:151], v[80:95]
    buffer_load_dwordx4 a[156:159], v2, s[36:39], s52 offen offset:3072 sc1
    s_add_u32 s52, s52, 4096
    v_exp_f32 v140, v140
    v_exp_f32 v141, v141
    v_exp_f32 v142, v142
    v_exp_f32 v143, v143
    v_cvt_pk_bf16_f32 v158, v140, v141
    v_cvt_pk_bf16_f32 v159, v142, v143
    v_mfma_f32_32x32x16_bf16 v[128:143], v[192:195], v[24:27], 0
    buffer_load_dwordx4 a[168:171], v2, s[36:39], s52 offen offset:0 sc1
    v_exp_f32 v112, v112
    v_exp_f32 v113, v113
    v_exp_f32 v114, v114
    v_exp_f32 v115, v115
    v_cvt_pk_bf16_f32 v144, v112, v113
    v_cvt_pk_bf16_f32 v145, v114, v115
    v_mfma_f32_32x32x16_bf16 v[128:143], v[196:199], v[28:31], v[128:143]
    buffer_load_dwordx4 a[172:175], v2, s[36:39], s52 offen offset:1024 sc1
    v_exp_f32 v116, v116
    v_exp_f32 v117, v117
    v_exp_f32 v118, v118
    v_exp_f32 v119, v119
    v_cvt_pk_bf16_f32 v146, v116, v117
    v_cvt_pk_bf16_f32 v147, v118, v119
    v_mfma_f32_32x32x16_bf16 v[96:111], v[184:187], v[152:155], v[96:111]
    buffer_load_dwordx4 a[184:187], v2, s[36:39], s52 offen offset:2048 sc1
    v_exp_f32 v120, v120
    v_exp_f32 v121, v121
    v_exp_f32 v122, v122
    v_exp_f32 v123, v123
    v_cvt_pk_bf16_f32 v148, v120, v121
    v_cvt_pk_bf16_f32 v149, v122, v123
    v_mfma_f32_32x32x16_bf16 v[96:111], v[188:191], v[156:159], v[96:111]
    s_cmp_eq_u32 s71, 0
    s_cbranch_scc1 L_pf_17
    s_lshr_b32 s62, s47, 3
    s_lshl_b32 s62, s62, 7
    s_and_b32 s55, s47, 7
    s_lshl_b32 s55, s55, 2
    s_add_u32 s62, s62, s55
    s_add_u32 s62, s62, 20480
    v_mov_b32 v227, s45
    v_mov_b32 v228, 0
    s_mov_b32 s71, 0
    s_waitcnt vmcnt(27)
    s_mov_b64 exec, 1
    buffer_store_dword v227, v228, s[36:39], s62 offen sc1
    s_mov_b64 exec, -1
L_pf_17:
    v_exp_f32 v124, v124
    v_exp_f32 v125, v125
    v_exp_f32 v126, v126
    v_exp_f32 v127, v127
    v_cvt_pk_bf16_f32 v150, v124, v125
    v_cvt_pk_bf16_f32 v151, v126, v127
    v_mfma_f32_32x32x16_bf16 v[112:127], v[192:195], v[32:35], 0
    v_exp_f32 v128, v128
    v_exp_f32 v129, v129
    v_exp_f32 v130, v130
    v_exp_f32 v131, v131
    v_cvt_pk_bf16_f32 v152, v128, v129
    v_cvt_pk_bf16_f32 v153, v130, v131
    v_mfma_f32_32x32x16_bf16 v[112:127], v[196:199], v[36:39], v[112:127]
    buffer_load_dwordx4 a[188:191], v2, s[36:39], s52 offen offset:3072 sc1
    s_add_u32 s52, s52, 4096
    v_exp_f32 v132, v132
    v_exp_f32 v133, v133
    v_exp_f32 v134, v134
    v_exp_f32 v135, v135
    v_cvt_pk_bf16_f32 v154, v132, v133
    v_cvt_pk_bf16_f32 v155, v134, v135
    v_mfma_f32_32x32x16_bf16 v[48:63], v[200:203], v[144:147], v[48:63]
    buffer_load_dwordx4 a[200:203], v2, s[36:39], s52 offen offset:0 sc1
    v_exp_f32 v136, v136
    v_exp_f32 v137, v137
    v_exp_f32 v138, v138
    v_exp_f32 v139, v139
    v_cvt_pk_bf16_f32 v156, v136, v137
    v_cvt_pk_bf16_f32 v157, v138, v139
    v_mfma_f32_32x32x16_bf16 v[48:63], v[204:207], v[148:151], v[48:63]
    buffer_load_dwordx4 a[204:207], v2, s[36:39], s52 offen offset:1024 sc1
    v_exp_f32 v140, v140
    v_exp_f32 v141, v141
    v_exp_f32 v142, v142
    v_exp_f32 v143, v143
    v_cvt_pk_bf16_f32 v158, v140, v141
    v_cvt_pk_bf16_f32 v159, v142, v143
    v_mfma_f32_32x32x16_bf16 v[128:143], v[192:195], v[40:43], 0
    v_exp_f32 v112, v112
    v_exp_f32 v113, v113
    v_exp_f32 v114, v114
    v_exp_f32 v115, v115
    v_cvt_pk_bf16_f32 v144, v112, v113
    v_cvt_pk_bf16_f32 v145, v114, v115
    v_mfma_f32_32x32x16_bf16 v[128:143], v[196:199], v[44:47], v[128:143]
    buffer_load_dwordx4 a[216:219], v2, s[36:39], s52 offen offset:2048 sc1
    v_exp_f32 v116, v116
    v_exp_f32 v117, v117
    v_exp_f32 v118, v118
    v_exp_f32 v119, v119
    v_cvt_pk_bf16_f32 v146, v116, v117
    v_cvt_pk_bf16_f32 v147, v118, v119
    v_mfma_f32_32x32x16_bf16 v[64:79], v[200:203], v[152:155], v[64:79]
    buffer_load_dwordx4 a[220:223], v2, s[36:39], s52 offen offset:3072 sc1
    s_add_u32 s52, s52, 4096
    v_exp_f32 v120, v120
    v_exp_f32 v121, v121
    v_exp_f32 v122, v122
    v_exp_f32 v123, v123
    v_cvt_pk_bf16_f32 v148, v120, v121
    v_cvt_pk_bf16_f32 v149, v122, v123
    v_mfma_f32_32x32x16_bf16 v[64:79], v[204:207], v[156:159], v[64:79]
    buffer_load_dwordx4 a[232:235], v2, s[36:39], s52 offen offset:0 sc1
    v_exp_f32 v124, v124
    v_exp_f32 v125, v125
    v_exp_f32 v126, v126
    v_exp_f32 v127, v127
    v_cvt_pk_bf16_f32 v150, v124, v125
    v_cvt_pk_bf16_f32 v151, v126, v127
    s_waitcnt vmcnt(29)
    v_mfma_f32_32x32x16_bf16 v[112:127], v[208:211], v[16:19], 0
    v_exp_f32 v128, v128
    v_exp_f32 v129, v129
    v_exp_f32 v130, v130
    v_exp_f32 v131, v131
    v_cvt_pk_bf16_f32 v152, v128, v129
    v_cvt_pk_bf16_f32 v153, v130, v131
    v_mfma_f32_32x32x16_bf16 v[112:127], v[212:215], v[20:23], v[112:127]
    buffer_load_dwordx4 a[236:239], v2, s[36:39], s52 offen offset:1024 sc1
    v_exp_f32 v132, v132
    v_exp_f32 v133, v133
    v_exp_f32 v134, v134
    v_exp_f32 v135, v135
    v_cvt_pk_bf16_f32 v154, v132, v133
    v_cvt_pk_bf16_f32 v155, v134, v135
    v_mfma_f32_32x32x16_bf16 v[80:95], v[200:203], v[144:147], v[80:95]
    buffer_load_dwordx4 a[248:251], v2, s[36:39], s52 offen offset:2048 sc1
    v_exp_f32 v136, v136
    v_exp_f32 v137, v137
    v_exp_f32 v138, v138
    v_exp_f32 v139, v139
    v_cvt_pk_bf16_f32 v156, v136, v137
    v_cvt_pk_bf16_f32 v157, v138, v139
    v_mfma_f32_32x32x16_bf16 v[80:95], v[204:207], v[148:151], v[80:95]
    buffer_load_dwordx4 a[252:255], v2, s[36:39], s52 offen offset:3072 sc1
    s_add_u32 s52, s52, 4096
    v_exp_f32 v140, v140
    v_exp_f32 v141, v141
    v_exp_f32 v142, v142
    v_exp_f32 v143, v143
    v_cvt_pk_bf16_f32 v158, v140, v141
    v_cvt_pk_bf16_f32 v159, v142, v143
    v_mfma_f32_32x32x16_bf16 v[128:143], v[208:211], v[24:27], 0
    v_exp_f32 v112, v112
    v_exp_f32 v113, v113
    v_exp_f32 v114, v114
    v_exp_f32 v115, v115
    v_cvt_pk_bf16_f32 v144, v112, v113
    v_cvt_pk_bf16_f32 v145, v114, v115
    v_mfma_f32_32x32x16_bf16 v[128:143], v[212:215], v[28:31], v[128:143]
    buffer_load_dwordx4 v[160:163], v2, s[36:39], s52 offen offset:0 sc1
    v_exp_f32 v116, v116
    v_exp_f32 v117, v117
    v_exp_f32 v118, v118
    v_exp_f32 v119, v119
    v_cvt_pk_bf16_f32 v146, v116, v117
    v_cvt_pk_bf16_f32 v147, v118, v119
    v_mfma_f32_32x32x16_bf16 v[96:111], v[200:203], v[152:155], v[96:111]
    buffer_load_dwordx4 v[164:167], v2, s[36:39], s52 offen offset:1024 sc1
    v_exp_f32 v120, v120
    v_exp_f32 v121, v121
    v_exp_f32 v122, v122
    v_exp_f32 v123, v123
    v_cvt_pk_bf16_f32 v148, v120, v121
    v_cvt_pk_bf16_f32 v149, v122, v123
    v_mfma_f32_32x32x16_bf16 v[96:111], v[204:207], v[156:159], v[96:111]
    buffer_load_dwordx4 v[168:171], v2, s[36:39], s52 offen offset:2048 sc1
    v_exp_f32 v124, v124
    v_exp_f32 v125, v125
    v_exp_f32 v126, v126
    v_exp_f32 v127, v127
    v_cvt_pk_bf16_f32 v150, v124, v125
    v_cvt_pk_bf16_f32 v151, v126, v127
    v_mfma_f32_32x32x16_bf16 v[112:127], v[208:211], v[32:35], 0
    v_exp_f32 v128, v128
    v_exp_f32 v129, v129
    v_exp_f32 v130, v130
    v_exp_f32 v131, v131
    v_cvt_pk_bf16_f32 v152, v128, v129
    v_cvt_pk_bf16_f32 v153, v130, v131
    v_mfma_f32_32x32x16_bf16 v[112:127], v[212:215], v[36:39], v[112:127]
    buffer_load_dwordx4 v[172:175], v2, s[36:39], s52 offen offset:3072 sc1
    s_add_u32 s52, s52, 4096
    v_exp_f32 v132, v132
    v_exp_f32 v133, v133
    v_exp_f32 v134, v134
    v_exp_f32 v135, v135
    v_cvt_pk_bf16_f32 v154, v132, v133
    v_cvt_pk_bf16_f32 v155, v134, v135
    v_mfma_f32_32x32x16_bf16 v[48:63], v[216:219], v[144:147], v[48:63]
    buffer_load_dwordx4 v[176:179], v2, s[36:39], s52 offen offset:0 sc1
    v_exp_f32 v136, v136
    v_exp_f32 v137, v137
    v_exp_f32 v138, v138
    v_exp_f32 v139, v139
    v_cvt_pk_bf16_f32 v156, v136, v137
    v_cvt_pk_bf16_f32 v157, v138, v139
    v_mfma_f32_32x32x16_bf16 v[48:63], v[220:223], v[148:151], v[48:63]
    buffer_load_dwordx4 v[180:183], v2, s[36:39], s52 offen offset:1024 sc1
    v_exp_f32 v140, v140
    v_exp_f32 v141, v141
    v_exp_f32 v142, v142
    v_exp_f32 v143, v143
    v_cvt_pk_bf16_f32 v158, v140, v141
    v_cvt_pk_bf16_f32 v159, v142, v143
    v_mfma_f32_32x32x16_bf16 v[128:143], v[208:211], v[40:43], 0
    v_exp_f32 v112, v112
    v_exp_f32 v113, v113
    v_exp_f32 v114, v114
    v_exp_f32 v115, v115
    v_cvt_pk_bf16_f32 v144, v112, v113
    v_cvt_pk_bf16_f32 v145, v114, v115
    v_mfma_f32_32x32x16_bf16 v[128:143], v[212:215], v[44:47], v[128:143]
    buffer_load_dwordx4 v[184:187], v2, s[36:39], s52 offen offset:2048 sc1
    v_exp_f32 v116, v116
    v_exp_f32 v117, v117
    v_exp_f32 v118, v118
    v_exp_f32 v119, v119
    v_cvt_pk_bf16_f32 v146, v116, v117
    v_cvt_pk_bf16_f32 v147, v118, v119
    v_mfma_f32_32x32x16_bf16 v[64:79], v[216:219], v[152:155], v[64:79]
    buffer_load_dwordx4 v[188:191], v2, s[36:39], s52 offen offset:3072 sc1
    s_add_u32 s52, s52, 4096
    v_exp_f32 v120, v120
    v_exp_f32 v121, v121
    v_exp_f32 v122, v122
    v_exp_f32 v123, v123
    v_cvt_pk_bf16_f32 v148, v120, v121
    v_cvt_pk_bf16_f32 v149, v122, v123
    v_mfma_f32_32x32x16_bf16 v[64:79], v[220:223], v[156:159], v[64:79]
    buffer_load_dwordx4 v[192:195], v2, s[36:39], s52 offen offset:0 sc1
    v_exp_f32 v124, v124
    v_exp_f32 v125, v125
    v_exp_f32 v126, v126
    v_exp_f32 v127, v127
    v_cvt_pk_bf16_f32 v150, v124, v125
    v_cvt_pk_bf16_f32 v151, v126, v127
    s_waitcnt vmcnt(37)
    v_mfma_f32_32x32x16_bf16 v[112:127], a[8:11], v[16:19], 0
    v_exp_f32 v128, v128
    v_exp_f32 v129, v129
    v_exp_f32 v130, v130
    v_exp_f32 v131, v131
    v_cvt_pk_bf16_f32 v152, v128, v129
    v_cvt_pk_bf16_f32 v153, v130, v131
    v_mfma_f32_32x32x16_bf16 v[112:127], a[12:15], v[20:23], v[112:127]
    buffer_load_dwordx4 v[196:199], v2, s[36:39], s52 offen offset:1024 sc1
    v_exp_f32 v132, v132
    v_exp_f32 v133, v133
    v_exp_f32 v134, v134
    v_exp_f32 v135, v135
    v_cvt_pk_bf16_f32 v154, v132, v133
    v_cvt_pk_bf16_f32 v155, v134, v135
    v_mfma_f32_32x32x16_bf16 v[80:95], v[216:219], v[144:147], v[80:95]
    buffer_load_dwordx4 v[200:203], v2, s[36:39], s52 offen offset:2048 sc1
    v_exp_f32 v136, v136
    v_exp_f32 v137, v137
    v_exp_f32 v138, v138
    v_exp_f32 v139, v139
    v_cvt_pk_bf16_f32 v156, v136, v137
    v_cvt_pk_bf16_f32 v157, v138, v139
    v_mfma_f32_32x32x16_bf16 v[80:95], v[220:223], v[148:151], v[80:95]
    buffer_load_dwordx4 v[204:207], v2, s[36:39], s52 offen offset:3072 sc1
    s_add_u32 s52, s52, 4096
    v_exp_f32 v140, v140
    v_exp_f32 v141, v141
    v_exp_f32 v142, v142
    v_exp_f32 v143, v143
    v_cvt_pk_bf16_f32 v158, v140, v141
    v_cvt_pk_bf16_f32 v159, v142, v143
    v_mfma_f32_32x32x16_bf16 v[128:143], a[8:11], v[24:27], 0
    v_exp_f32 v112, v112
    v_exp_f32 v113, v113
    v_exp_f32 v114, v114
    v_exp_f32 v115, v115
    v_cvt_pk_bf16_f32 v144, v112, v113
    v_cvt_pk_bf16_f32 v145, v114, v115
    v_mfma_f32_32x32x16_bf16 v[128:143], a[12:15], v[28:31], v[128:143]
    v_exp_f32 v116, v116
    v_exp_f32 v117, v117
    v_exp_f32 v118, v118
    v_exp_f32 v119, v119
    v_cvt_pk_bf16_f32 v146, v116, v117
    v_cvt_pk_bf16_f32 v147, v118, v119
    v_mfma_f32_32x32x16_bf16 v[96:111], v[216:219], v[152:155], v[96:111]
    v_exp_f32 v120, v120
    v_exp_f32 v121, v121
    v_exp_f32 v122, v122
    v_exp_f32 v123, v123
    v_cvt_pk_bf16_f32 v148, v120, v121
    v_cvt_pk_bf16_f32 v149, v122, v123
    v_mfma_f32_32x32x16_bf16 v[96:111], v[220:223], v[156:159], v[96:111]
    v_exp_f32 v124, v124
    v_exp_f32 v125, v125
    v_exp_f32 v126, v126
    v_exp_f32 v127, v127
    v_cvt_pk_bf16_f32 v150, v124, v125
    v_cvt_pk_bf16_f32 v151, v126, v127
    v_mfma_f32_32x32x16_bf16 v[112:127], a[8:11], v[32:35], 0
    v_exp_f32 v128, v128
    v_exp_f32 v129, v129
    v_exp_f32 v130, v130
    v_exp_f32 v131, v131
    v_cvt_pk_bf16_f32 v152, v128, v129
    v_cvt_pk_bf16_f32 v153, v130, v131
    v_mfma_f32_32x32x16_bf16 v[112:127], a[12:15], v[36:39], v[112:127]
    buffer_load_dwordx4 v[208:211], v2, s[36:39], s52 offen offset:0 sc1
    v_exp_f32 v132, v132
    v_exp_f32 v133, v133
    v_exp_f32 v134, v134
    v_exp_f32 v135, v135
    v_cvt_pk_bf16_f32 v154, v132, v133
    v_cvt_pk_bf16_f32 v155, v134, v135
    v_mfma_f32_32x32x16_bf16 v[48:63], a[24:27], v[144:147], v[48:63]
    buffer_load_dwordx4 v[212:215], v2, s[36:39], s52 offen offset:1024 sc1
    v_exp_f32 v136, v136
    v_exp_f32 v137, v137
    v_exp_f32 v138, v138
    v_exp_f32 v139, v139
    v_cvt_pk_bf16_f32 v156, v136, v137
    v_cvt_pk_bf16_f32 v157, v138, v139
    v_mfma_f32_32x32x16_bf16 v[48:63], a[28:31], v[148:151], v[48:63]
    buffer_load_dwordx4 v[216:219], v2, s[36:39], s52 offen offset:2048 sc1
    v_exp_f32 v140, v140
    v_exp_f32 v141, v141
    v_exp_f32 v142, v142
    v_exp_f32 v143, v143
    v_cvt_pk_bf16_f32 v158, v140, v141
    v_cvt_pk_bf16_f32 v159, v142, v143
    v_mfma_f32_32x32x16_bf16 v[128:143], a[8:11], v[40:43], 0
    v_exp_f32 v112, v112
    v_exp_f32 v113, v113
    v_exp_f32 v114, v114
    v_exp_f32 v115, v115
    v_cvt_pk_bf16_f32 v144, v112, v113
    v_cvt_pk_bf16_f32 v145, v114, v115
    v_mfma_f32_32x32x16_bf16 v[128:143], a[12:15], v[44:47], v[128:143]
    buffer_load_dwordx4 v[220:223], v2, s[36:39], s52 offen offset:3072 sc1
    s_add_u32 s52, s52, 4096
    v_exp_f32 v116, v116
    v_exp_f32 v117, v117
    v_exp_f32 v118, v118
    v_exp_f32 v119, v119
    v_cvt_pk_bf16_f32 v146, v116, v117
    v_cvt_pk_bf16_f32 v147, v118, v119
    v_mfma_f32_32x32x16_bf16 v[64:79], a[24:27], v[152:155], v[64:79]
    v_exp_f32 v120, v120
    v_exp_f32 v121, v121
    v_exp_f32 v122, v122
    v_exp_f32 v123, v123
    v_cvt_pk_bf16_f32 v148, v120, v121
    v_cvt_pk_bf16_f32 v149, v122, v123
    v_mfma_f32_32x32x16_bf16 v[64:79], a[28:31], v[156:159], v[64:79]
    v_exp_f32 v124, v124
    v_exp_f32 v125, v125
    v_exp_f32 v126, v126
    v_exp_f32 v127, v127
    v_cvt_pk_bf16_f32 v150, v124, v125
    v_cvt_pk_bf16_f32 v151, v126, v127
    s_waitcnt vmcnt(40)
    v_mfma_f32_32x32x16_bf16 v[112:127], a[40:43], v[16:19], 0
    v_exp_f32 v128, v128
    v_exp_f32 v129, v129
    v_exp_f32 v130, v130
    v_exp_f32 v131, v131
    v_cvt_pk_bf16_f32 v152, v128, v129
    v_cvt_pk_bf16_f32 v153, v130, v131
    v_mfma_f32_32x32x16_bf16 v[112:127], a[44:47], v[20:23], v[112:127]
    s_add_u32 s58, s40, 1
    s_and_b32 s58, s58, 3
    s_lshl_b32 s58, s58, 8
    s_add_u32 s58, s58, s40
    s_lshl_b32 s58, s58, 8
    s_lshl_b32 s59, s41, 18
    s_add_u32 s58, s58, s59
    s_and_b32 s59, s70, 2
    s_lshl_b32 s59, s59, 6
    s_add_u32 s58, s58, s59
    s_add_u32 m0, s63, 0
    s_nop 0
    buffer_load_dwordx4 v12, s[20:23], s58 offen offset:0 nt lds
    v_exp_f32 v132, v132
    v_exp_f32 v133, v133
    v_exp_f32 v134, v134
    v_exp_f32 v135, v135
    v_cvt_pk_bf16_f32 v154, v132, v133
    v_cvt_pk_bf16_f32 v155, v134, v135
    v_mfma_f32_32x32x16_bf16 v[80:95], a[24:27], v[144:147], v[80:95]
    buffer_load_dwordx4 v12, s[20:23], s58 offen offset:1024 nt lds
    v_exp_f32 v136, v136
    v_exp_f32 v137, v137
    v_exp_f32 v138, v138
    v_exp_f32 v139, v139
    v_cvt_pk_bf16_f32 v156, v136, v137
    v_cvt_pk_bf16_f32 v157, v138, v139
    v_mfma_f32_32x32x16_bf16 v[80:95], a[28:31], v[148:151], v[80:95]
    v_exp_f32 v140, v140
    v_exp_f32 v141, v141
    v_exp_f32 v142, v142
    v_exp_f32 v143, v143
    v_cvt_pk_bf16_f32 v158, v140, v141
    v_cvt_pk_bf16_f32 v159, v142, v143
    v_mfma_f32_32x32x16_bf16 v[128:143], a[40:43], v[24:27], 0
    v_exp_f32 v112, v112
    v_exp_f32 v113, v113
    v_exp_f32 v114, v114
    v_exp_f32 v115, v115
    v_cvt_pk_bf16_f32 v144, v112, v113
    v_cvt_pk_bf16_f32 v145, v114, v115
    v_mfma_f32_32x32x16_bf16 v[128:143], a[44:47], v[28:31], v[128:143]
    buffer_load_dwordx4 v12, s[20:23], s58 offen offset:2048 nt lds
    v_exp_f32 v116, v116
    v_exp_f32 v117, v117
    v_exp_f32 v118, v118
    v_exp_f32 v119, v119
    v_cvt_pk_bf16_f32 v146, v116, v117
    v_cvt_pk_bf16_f32 v147, v118, v119
    v_mfma_f32_32x32x16_bf16 v[96:111], a[24:27], v[152:155], v[96:111]
    buffer_load_dwordx4 v12, s[20:23], s58 offen offset:3072 nt lds
    v_exp_f32 v120, v120
    v_exp_f32 v121, v121
    v_exp_f32 v122, v122
    v_exp_f32 v123, v123
    v_cvt_pk_bf16_f32 v148, v120, v121
    v_cvt_pk_bf16_f32 v149, v122, v123
    v_mfma_f32_32x32x16_bf16 v[96:111], a[28:31], v[156:159], v[96:111]
    v_exp_f32 v124, v124
    v_exp_f32 v125, v125
    v_exp_f32 v126, v126
    v_exp_f32 v127, v127
    v_cvt_pk_bf16_f32 v150, v124, v125
    v_cvt_pk_bf16_f32 v151, v126, v127
    v_mfma_f32_32x32x16_bf16 v[112:127], a[40:43], v[32:35], 0
    v_exp_f32 v128, v128
    v_exp_f32 v129, v129
    v_exp_f32 v130, v130
    v_exp_f32 v131, v131
    v_cvt_pk_bf16_f32 v152, v128, v129
    v_cvt_pk_bf16_f32 v153, v130, v131
    v_mfma_f32_32x32x16_bf16 v[112:127], a[44:47], v[36:39], v[112:127]
    s_add_u32 m0, s63, 4096
    s_nop 0
    buffer_load_dwordx4 v13, s[20:23], s58 offen offset:0 nt lds
    v_exp_f32 v132, v132
    v_exp_f32 v133, v133
    v_exp_f32 v134, v134
    v_exp_f32 v135, v135
    v_cvt_pk_bf16_f32 v154, v132, v133
    v_cvt_pk_bf16_f32 v155, v134, v135
    v_mfma_f32_32x32x16_bf16 v[48:63], a[56:59], v[144:147], v[48:63]
    buffer_load_dwordx4 v13, s[20:23], s58 offen offset:1024 nt lds
    v_exp_f32 v136, v136
    v_exp_f32 v137, v137
    v_exp_f32 v138, v138
    v_exp_f32 v139, v139
    v_cvt_pk_bf16_f32 v156, v136, v137
    v_cvt_pk_bf16_f32 v157, v138, v139
    v_mfma_f32_32x32x16_bf16 v[48:63], a[60:63], v[148:151], v[48:63]
    v_exp_f32 v140, v140
    v_exp_f32 v141, v141
    v_exp_f32 v142, v142
    v_exp_f32 v143, v143
    v_cvt_pk_bf16_f32 v158, v140, v141
    v_cvt_pk_bf16_f32 v159, v142, v143
    v_mfma_f32_32x32x16_bf16 v[128:143], a[40:43], v[40:43], 0
    v_exp_f32 v112, v112
    v_exp_f32 v113, v113
    v_exp_f32 v114, v114
    v_exp_f32 v115, v115
    v_cvt_pk_bf16_f32 v144, v112, v113
    v_cvt_pk_bf16_f32 v145, v114, v115
    v_mfma_f32_32x32x16_bf16 v[128:143], a[44:47], v[44:47], v[128:143]
    buffer_load_dwordx4 v13, s[20:23], s58 offen offset:2048 nt lds
    v_exp_f32 v116, v116
    v_exp_f32 v117, v117
    v_exp_f32 v118, v118
    v_exp_f32 v119, v119
    v_cvt_pk_bf16_f32 v146, v116, v117
    v_cvt_pk_bf16_f32 v147, v118, v119
    v_mfma_f32_32x32x16_bf16 v[64:79], a[56:59], v[152:155], v[64:79]
    buffer_load_dwordx4 v13, s[20:23], s58 offen offset:3072 nt lds
    v_exp_f32 v120, v120
    v_exp_f32 v121, v121
    v_exp_f32 v122, v122
    v_exp_f32 v123, v123
    v_cvt_pk_bf16_f32 v148, v120, v121
    v_cvt_pk_bf16_f32 v149, v122, v123
    v_mfma_f32_32x32x16_bf16 v[64:79], a[60:63], v[156:159], v[64:79]
    v_exp_f32 v124, v124
    v_exp_f32 v125, v125
    v_exp_f32 v126, v126
    v_exp_f32 v127, v127
    v_cvt_pk_bf16_f32 v150, v124, v125
    v_cvt_pk_bf16_f32 v151, v126, v127
    s_waitcnt vmcnt(44)
    v_mfma_f32_32x32x16_bf16 v[112:127], a[72:75], v[16:19], 0
    v_exp_f32 v128, v128
    v_exp_f32 v129, v129
    v_exp_f32 v130, v130
    v_exp_f32 v131, v131
    v_cvt_pk_bf16_f32 v152, v128, v129
    v_cvt_pk_bf16_f32 v153, v130, v131
    v_mfma_f32_32x32x16_bf16 v[112:127], a[76:79], v[20:23], v[112:127]
    s_add_u32 s58, s40, 1
    s_and_b32 s58, s58, 3
    s_lshl_b32 s58, s58, 8
    s_add_u32 s58, s58, s40
    s_lshl_b32 s58, s58, 8
    s_lshl_b32 s59, s41, 18
    s_add_u32 s58, s58, s59
    s_and_b32 s59, s70, 2
    s_lshl_b32 s59, s59, 6
    s_add_u32 s58, s58, s59
    s_xor_b32 s58, s58, 128
    s_add_u32 m0, s57, 0
    s_nop 0
    buffer_load_dwordx4 v12, s[20:23], s58 offen offset:0 nt lds
    v_exp_f32 v132, v132
    v_exp_f32 v133, v133
    v_exp_f32 v134, v134
    v_exp_f32 v135, v135
    v_cvt_pk_bf16_f32 v154, v132, v133
    v_cvt_pk_bf16_f32 v155, v134, v135
    v_mfma_f32_32x32x16_bf16 v[80:95], a[56:59], v[144:147], v[80:95]
    buffer_load_dwordx4 v12, s[20:23], s58 offen offset:1024 nt lds
    v_exp_f32 v136, v136
    v_exp_f32 v137, v137
    v_exp_f32 v138, v138
    v_exp_f32 v139, v139
    v_cvt_pk_bf16_f32 v156, v136, v137
    v_cvt_pk_bf16_f32 v157, v138, v139
    v_mfma_f32_32x32x16_bf16 v[80:95], a[60:63], v[148:151], v[80:95]
    v_exp_f32 v140, v140
    v_exp_f32 v141, v141
    v_exp_f32 v142, v142
    v_exp_f32 v143, v143
    v_cvt_pk_bf16_f32 v158, v140, v141
    v_cvt_pk_bf16_f32 v159, v142, v143
    v_mfma_f32_32x32x16_bf16 v[128:143], a[72:75], v[24:27], 0
    v_exp_f32 v112, v112
    v_exp_f32 v113, v113
    v_exp_f32 v114, v114
    v_exp_f32 v115, v115
    v_cvt_pk_bf16_f32 v144, v112, v113
    v_cvt_pk_bf16_f32 v145, v114, v115
    v_mfma_f32_32x32x16_bf16 v[128:143], a[76:79], v[28:31], v[128:143]
    buffer_load_dwordx4 v12, s[20:23], s58 offen offset:2048 nt lds
    v_exp_f32 v116, v116
    v_exp_f32 v117, v117
    v_exp_f32 v118, v118
    v_exp_f32 v119, v119
    v_cvt_pk_bf16_f32 v146, v116, v117
    v_cvt_pk_bf16_f32 v147, v118, v119
    v_mfma_f32_32x32x16_bf16 v[96:111], a[56:59], v[152:155], v[96:111]
    buffer_load_dwordx4 v12, s[20:23], s58 offen offset:3072 nt lds
    v_exp_f32 v120, v120
    v_exp_f32 v121, v121
    v_exp_f32 v122, v122
    v_exp_f32 v123, v123
    v_cvt_pk_bf16_f32 v148, v120, v121
    v_cvt_pk_bf16_f32 v149, v122, v123
    v_mfma_f32_32x32x16_bf16 v[96:111], a[60:63], v[156:159], v[96:111]
    v_exp_f32 v124, v124
    v_exp_f32 v125, v125
    v_exp_f32 v126, v126
    v_exp_f32 v127, v127
    v_cvt_pk_bf16_f32 v150, v124, v125
    v_cvt_pk_bf16_f32 v151, v126, v127
    v_mfma_f32_32x32x16_bf16 v[112:127], a[72:75], v[32:35], 0
    v_exp_f32 v128, v128
    v_exp_f32 v129, v129
    v_exp_f32 v130, v130
    v_exp_f32 v131, v131
    v_cvt_pk_bf16_f32 v152, v128, v129
    v_cvt_pk_bf16_f32 v153, v130, v131
    v_mfma_f32_32x32x16_bf16 v[112:127], a[76:79], v[36:39], v[112:127]
    s_add_u32 m0, s57, 4096
    s_nop 0
    buffer_load_dwordx4 v13, s[20:23], s58 offen offset:0 nt lds
    v_exp_f32 v132, v132
    v_exp_f32 v133, v133
    v_exp_f32 v134, v134
    v_exp_f32 v135, v135
    v_cvt_pk_bf16_f32 v154, v132, v133
    v_cvt_pk_bf16_f32 v155, v134, v135
    v_mfma_f32_32x32x16_bf16 v[48:63], a[88:91], v[144:147], v[48:63]
    buffer_load_dwordx4 v13, s[20:23], s58 offen offset:1024 nt lds
    v_exp_f32 v136, v136
    v_exp_f32 v137, v137
    v_exp_f32 v138, v138
    v_exp_f32 v139, v139
    v_cvt_pk_bf16_f32 v156, v136, v137
    v_cvt_pk_bf16_f32 v157, v138, v139
    v_mfma_f32_32x32x16_bf16 v[48:63], a[92:95], v[148:151], v[48:63]
    v_exp_f32 v140, v140
    v_exp_f32 v141, v141
    v_exp_f32 v142, v142
    v_exp_f32 v143, v143
    v_cvt_pk_bf16_f32 v158, v140, v141
    v_cvt_pk_bf16_f32 v159, v142, v143
    v_mfma_f32_32x32x16_bf16 v[128:143], a[72:75], v[40:43], 0
    v_exp_f32 v112, v112
    v_exp_f32 v113, v113
    v_exp_f32 v114, v114
    v_exp_f32 v115, v115
    v_cvt_pk_bf16_f32 v144, v112, v113
    v_cvt_pk_bf16_f32 v145, v114, v115
    v_mfma_f32_32x32x16_bf16 v[128:143], a[76:79], v[44:47], v[128:143]
    buffer_load_dwordx4 v13, s[20:23], s58 offen offset:2048 nt lds
    v_exp_f32 v116, v116
    v_exp_f32 v117, v117
    v_exp_f32 v118, v118
    v_exp_f32 v119, v119
    v_cvt_pk_bf16_f32 v146, v116, v117
    v_cvt_pk_bf16_f32 v147, v118, v119
    v_mfma_f32_32x32x16_bf16 v[64:79], a[88:91], v[152:155], v[64:79]
    buffer_load_dwordx4 v13, s[20:23], s58 offen offset:3072 nt lds
    v_exp_f32 v120, v120
    v_exp_f32 v121, v121
    v_exp_f32 v122, v122
    v_exp_f32 v123, v123
    v_cvt_pk_bf16_f32 v148, v120, v121
    v_cvt_pk_bf16_f32 v149, v122, v123
    v_mfma_f32_32x32x16_bf16 v[64:79], a[92:95], v[156:159], v[64:79]
    v_exp_f32 v124, v124
    v_exp_f32 v125, v125
    v_exp_f32 v126, v126
    v_exp_f32 v127, v127
    v_cvt_pk_bf16_f32 v150, v124, v125
    v_cvt_pk_bf16_f32 v151, v126, v127
    s_waitcnt vmcnt(48)
    v_mfma_f32_32x32x16_bf16 v[112:127], a[104:107], v[16:19], 0
    v_exp_f32 v128, v128
    v_exp_f32 v129, v129
    v_exp_f32 v130, v130
    v_exp_f32 v131, v131
    v_cvt_pk_bf16_f32 v152, v128, v129
    v_cvt_pk_bf16_f32 v153, v130, v131
    v_mfma_f32_32x32x16_bf16 v[112:127], a[108:111], v[20:23], v[112:127]
    s_mul_i32 s60, s40, 7168
    s_min_u32 s61, s42, 6
    s_lshl_b32 s61, s61, 7
    s_add_u32 s60, s60, s61
    s_add_u32 m0, s69, 0
    s_nop 0
    buffer_load_dwordx4 v255, s[12:15], s60 offen lds
    v_exp_f32 v132, v132
    v_exp_f32 v133, v133
    v_exp_f32 v134, v134
    v_exp_f32 v135, v135
    v_cvt_pk_bf16_f32 v154, v132, v133
    v_cvt_pk_bf16_f32 v155, v134, v135
    v_mfma_f32_32x32x16_bf16 v[80:95], a[88:91], v[144:147], v[80:95]
    s_add_u32 m0, s69, 4096
    s_add_u32 s60, s60, 28672
    buffer_load_dwordx4 v255, s[12:15], s60 offen lds
    v_exp_f32 v136, v136
    v_exp_f32 v137, v137
    v_exp_f32 v138, v138
    v_exp_f32 v139, v139
    v_cvt_pk_bf16_f32 v156, v136, v137
    v_cvt_pk_bf16_f32 v157, v138, v139
    v_mfma_f32_32x32x16_bf16 v[80:95], a[92:95], v[148:151], v[80:95]
    v_exp_f32 v140, v140
    v_exp_f32 v141, v141
    v_exp_f32 v142, v142
    v_exp_f32 v143, v143
    v_cvt_pk_bf16_f32 v158, v140, v141
    v_cvt_pk_bf16_f32 v159, v142, v143
    v_mfma_f32_32x32x16_bf16 v[128:143], a[104:107], v[24:27], 0
    v_exp_f32 v112, v112
    v_exp_f32 v113, v113
    v_exp_f32 v114, v114
    v_exp_f32 v115, v115
    v_cvt_pk_bf16_f32 v144, v112, v113
    v_cvt_pk_bf16_f32 v145, v114, v115
    v_mfma_f32_32x32x16_bf16 v[128:143], a[108:111], v[28:31], v[128:143]
    s_add_u32 m0, s69, 8192
    s_add_u32 s60, s60, 28672
    buffer_load_dwordx4 v255, s[12:15], s60 offen lds
    v_exp_f32 v116, v116
    v_exp_f32 v117, v117
    v_exp_f32 v118, v118
    v_exp_f32 v119, v119
    v_cvt_pk_bf16_f32 v146, v116, v117
    v_cvt_pk_bf16_f32 v147, v118, v119
    v_mfma_f32_32x32x16_bf16 v[96:111], a[88:91], v[152:155], v[96:111]
    s_add_u32 m0, s69, 12288
    s_add_u32 s60, s60, 28672
    buffer_load_dwordx4 v255, s[12:15], s60 offen lds
    v_exp_f32 v120, v120
    v_exp_f32 v121, v121
    v_exp_f32 v122, v122
    v_exp_f32 v123, v123
    v_cvt_pk_bf16_f32 v148, v120, v121
    v_cvt_pk_bf16_f32 v149, v122, v123
    v_mfma_f32_32x32x16_bf16 v[96:111], a[92:95], v[156:159], v[96:111]
    v_exp_f32 v124, v124
    v_exp_f32 v125, v125
    v_exp_f32 v126, v126
    v_exp_f32 v127, v127
    v_cvt_pk_bf16_f32 v150, v124, v125
    v_cvt_pk_bf16_f32 v151, v126, v127
    v_mfma_f32_32x32x16_bf16 v[112:127], a[104:107], v[32:35], 0
    v_exp_f32 v128, v128
    v_exp_f32 v129, v129
    v_exp_f32 v130, v130
    v_exp_f32 v131, v131
    v_cvt_pk_bf16_f32 v152, v128, v129
    v_cvt_pk_bf16_f32 v153, v130, v131
    v_mfma_f32_32x32x16_bf16 v[112:127], a[108:111], v[36:39], v[112:127]
    s_add_u32 m0, s69, 16384
    s_add_u32 s60, s60, 28672
    buffer_load_dwordx4 v255, s[12:15], s60 offen lds
    v_exp_f32 v132, v132
    v_exp_f32 v133, v133
    v_exp_f32 v134, v134
    v_exp_f32 v135, v135
    v_cvt_pk_bf16_f32 v154, v132, v133
    v_cvt_pk_bf16_f32 v155, v134, v135
    v_mfma_f32_32x32x16_bf16 v[48:63], a[120:123], v[144:147], v[48:63]
    s_add_u32 m0, s69, 20480
    s_add_u32 s60, s60, 28672
    buffer_load_dwordx4 v255, s[12:15], s60 offen lds
    v_exp_f32 v136, v136
    v_exp_f32 v137, v137
    v_exp_f32 v138, v138
    v_exp_f32 v139, v139
    v_cvt_pk_bf16_f32 v156, v136, v137
    v_cvt_pk_bf16_f32 v157, v138, v139
    v_mfma_f32_32x32x16_bf16 v[48:63], a[124:127], v[148:151], v[48:63]
    v_exp_f32 v140, v140
    v_exp_f32 v141, v141
    v_exp_f32 v142, v142
    v_exp_f32 v143, v143
    v_cvt_pk_bf16_f32 v158, v140, v141
    v_cvt_pk_bf16_f32 v159, v142, v143
    v_mfma_f32_32x32x16_bf16 v[128:143], a[104:107], v[40:43], 0
    v_exp_f32 v112, v112
    v_exp_f32 v113, v113
    v_exp_f32 v114, v114
    v_exp_f32 v115, v115
    v_cvt_pk_bf16_f32 v144, v112, v113
    v_cvt_pk_bf16_f32 v145, v114, v115
    v_mfma_f32_32x32x16_bf16 v[128:143], a[108:111], v[44:47], v[128:143]
    s_add_u32 m0, s69, 24576
    s_add_u32 s60, s60, 28672
    buffer_load_dwordx4 v255, s[12:15], s60 offen lds
    v_exp_f32 v116, v116
    v_exp_f32 v117, v117
    v_exp_f32 v118, v118
    v_exp_f32 v119, v119
    v_cvt_pk_bf16_f32 v146, v116, v117
    v_cvt_pk_bf16_f32 v147, v118, v119
    v_mfma_f32_32x32x16_bf16 v[64:79], a[120:123], v[152:155], v[64:79]
    s_add_u32 m0, s69, 28672
    s_add_u32 s60, s60, 28672
    buffer_load_dwordx4 v255, s[12:15], s60 offen lds
    v_exp_f32 v120, v120
    v_exp_f32 v121, v121
    v_exp_f32 v122, v122
    v_exp_f32 v123, v123
    v_cvt_pk_bf16_f32 v148, v120, v121
    v_cvt_pk_bf16_f32 v149, v122, v123
    v_mfma_f32_32x32x16_bf16 v[64:79], a[124:127], v[156:159], v[64:79]
    v_exp_f32 v124, v124
    v_exp_f32 v125, v125
    v_exp_f32 v126, v126
    v_exp_f32 v127, v127
    v_cvt_pk_bf16_f32 v150, v124, v125
    v_cvt_pk_bf16_f32 v151, v126, v127
    s_waitcnt vmcnt(52)
    v_mfma_f32_32x32x16_bf16 v[112:127], a[136:139], v[16:19], 0
    v_exp_f32 v128, v128
    v_exp_f32 v129, v129
    v_exp_f32 v130, v130
    v_exp_f32 v131, v131
    v_cvt_pk_bf16_f32 v152, v128, v129
    v_cvt_pk_bf16_f32 v153, v130, v131
    v_mfma_f32_32x32x16_bf16 v[112:127], a[140:143], v[20:23], v[112:127]
    s_add_u32 m0, s69, 32768
    s_add_u32 s60, s60, 28672
    buffer_load_dwordx4 v255, s[12:15], s60 offen lds
    v_exp_f32 v132, v132
    v_exp_f32 v133, v133
    v_exp_f32 v134, v134
    v_exp_f32 v135, v135
    v_cvt_pk_bf16_f32 v154, v132, v133
    v_cvt_pk_bf16_f32 v155, v134, v135
    v_mfma_f32_32x32x16_bf16 v[80:95], a[120:123], v[144:147], v[80:95]
    s_add_u32 m0, s69, 36864
    s_add_u32 s60, s60, 28672
    buffer_load_dwordx4 v255, s[12:15], s60 offen lds
    v_exp_f32 v136, v136
    v_exp_f32 v137, v137
    v_exp_f32 v138, v138
    v_exp_f32 v139, v139
    v_cvt_pk_bf16_f32 v156, v136, v137
    v_cvt_pk_bf16_f32 v157, v138, v139
    v_mfma_f32_32x32x16_bf16 v[80:95], a[124:127], v[148:151], v[80:95]
    v_exp_f32 v140, v140
    v_exp_f32 v141, v141
    v_exp_f32 v142, v142
    v_exp_f32 v143, v143
    v_cvt_pk_bf16_f32 v158, v140, v141
    v_cvt_pk_bf16_f32 v159, v142, v143
    v_mfma_f32_32x32x16_bf16 v[128:143], a[136:139], v[24:27], 0
    v_exp_f32 v112, v112
    v_exp_f32 v113, v113
    v_exp_f32 v114, v114
    v_exp_f32 v115, v115
    v_cvt_pk_bf16_f32 v144, v112, v113
    v_cvt_pk_bf16_f32 v145, v114, v115
    v_mfma_f32_32x32x16_bf16 v[128:143], a[140:143], v[28:31], v[128:143]
    s_add_u32 m0, s69, 40960
    s_add_u32 s60, s60, 28672
    buffer_load_dwordx4 v255, s[12:15], s60 offen lds
    v_exp_f32 v116, v116
    v_exp_f32 v117, v117
    v_exp_f32 v118, v118
    v_exp_f32 v119, v119
    v_cvt_pk_bf16_f32 v146, v116, v117
    v_cvt_pk_bf16_f32 v147, v118, v119
    v_mfma_f32_32x32x16_bf16 v[96:111], a[120:123], v[152:155], v[96:111]
    s_add_u32 m0, s69, 45056
    s_add_u32 s60, s60, 28672
    buffer_load_dwordx4 v255, s[12:15], s60 offen lds
    v_exp_f32 v120, v120
    v_exp_f32 v121, v121
    v_exp_f32 v122, v122
    v_exp_f32 v123, v123
    v_cvt_pk_bf16_f32 v148, v120, v121
    v_cvt_pk_bf16_f32 v149, v122, v123
    v_mfma_f32_32x32x16_bf16 v[96:111], a[124:127], v[156:159], v[96:111]
    v_exp_f32 v124, v124
    v_exp_f32 v125, v125
    v_exp_f32 v126, v126
    v_exp_f32 v127, v127
    v_cvt_pk_bf16_f32 v150, v124, v125
    v_cvt_pk_bf16_f32 v151, v126, v127
    v_mfma_f32_32x32x16_bf16 v[112:127], a[136:139], v[32:35], 0
    s_waitcnt vmcnt(20)
    ds_read_b128 a[0:3], v251 offset:0
    ds_read_b128 a[16:19], v252 offset:0
    v_exp_f32 v128, v128
    v_exp_f32 v129, v129
    v_exp_f32 v130, v130
    v_exp_f32 v131, v131
    v_cvt_pk_bf16_f32 v152, v128, v129
    v_cvt_pk_bf16_f32 v153, v130, v131
    v_mfma_f32_32x32x16_bf16 v[112:127], a[140:143], v[36:39], v[112:127]
    ds_read_b128 a[64:67], v251 offset:1024
    ds_read_b128 a[80:83], v252 offset:1024
    v_exp_f32 v132, v132
    v_exp_f32 v133, v133
    v_exp_f32 v134, v134
    v_exp_f32 v135, v135
    v_cvt_pk_bf16_f32 v154, v132, v133
    v_cvt_pk_bf16_f32 v155, v134, v135
    v_mfma_f32_32x32x16_bf16 v[48:63], a[152:155], v[144:147], v[48:63]
    s_add_u32 m0, s69, 49152
    s_add_u32 s60, s60, 28672
    buffer_load_dwordx4 v255, s[12:15], s60 offen lds
    v_exp_f32 v136, v136
    v_exp_f32 v137, v137
    v_exp_f32 v138, v138
    v_exp_f32 v139, v139
    v_cvt_pk_bf16_f32 v156, v136, v137
    v_cvt_pk_bf16_f32 v157, v138, v139
    v_mfma_f32_32x32x16_bf16 v[48:63], a[156:159], v[148:151], v[48:63]
    s_add_u32 m0, s69, 53248
    s_add_u32 s60, s60, 28672
    buffer_load_dwordx4 v255, s[12:15], s60 offen lds
    v_exp_f32 v140, v140
    v_exp_f32 v141, v141
    v_exp_f32 v142, v142
    v_exp_f32 v143, v143
    v_cvt_pk_bf16_f32 v158, v140, v141
    v_cvt_pk_bf16_f32 v159, v142, v143
    v_mfma_f32_32x32x16_bf16 v[128:143], a[136:139], v[40:43], 0
    v_exp_f32 v112, v112
    v_exp_f32 v113, v113
    v_exp_f32 v114, v114
    v_exp_f32 v115, v115
    v_cvt_pk_bf16_f32 v144, v112, v113
    v_cvt_pk_bf16_f32 v145, v114, v115
    v_mfma_f32_32x32x16_bf16 v[128:143], a[140:143], v[44:47], v[128:143]
    ds_read_b128 a[128:131], v251 offset:2048
    ds_read_b128 a[144:147], v252 offset:2048
    v_exp_f32 v116, v116
    v_exp_f32 v117, v117
    v_exp_f32 v118, v118
    v_exp_f32 v119, v119
    v_cvt_pk_bf16_f32 v146, v116, v117
    v_cvt_pk_bf16_f32 v147, v118, v119
    v_mfma_f32_32x32x16_bf16 v[64:79], a[152:155], v[152:155], v[64:79]
    ds_read_b128 a[192:195], v251 offset:3072
    ds_read_b128 a[208:211], v252 offset:3072
    v_exp_f32 v120, v120
    v_exp_f32 v121, v121
    v_exp_f32 v122, v122
    v_exp_f32 v123, v123
    v_cvt_pk_bf16_f32 v148, v120, v121
    v_cvt_pk_bf16_f32 v149, v122, v123
    v_mfma_f32_32x32x16_bf16 v[64:79], a[156:159], v[156:159], v[64:79]
    buffer_load_dwordx2 v[236:237], v253, s[36:39], 0 offen sc1
    v_exp_f32 v124, v124
    v_exp_f32 v125, v125
    v_exp_f32 v126, v126
    v_exp_f32 v127, v127
    v_cvt_pk_bf16_f32 v150, v124, v125
    v_cvt_pk_bf16_f32 v151, v126, v127
    v_mfma_f32_32x32x16_bf16 v[112:127], a[168:171], v[16:19], 0
    v_exp_f32 v128, v128
    v_exp_f32 v129, v129
    v_exp_f32 v130, v130
    v_exp_f32 v131, v131
    v_cvt_pk_bf16_f32 v152, v128, v129
    v_cvt_pk_bf16_f32 v153, v130, v131
    v_mfma_f32_32x32x16_bf16 v[112:127], a[172:175], v[20:23], v[112:127]
    s_waitcnt lgkmcnt(0)
    v_exp_f32 v132, v132
    v_exp_f32 v133, v133
    v_exp_f32 v134, v134
    v_exp_f32 v135, v135
    v_cvt_pk_bf16_f32 v154, v132, v133
    v_cvt_pk_bf16_f32 v155, v134, v135
    v_mfma_f32_32x32x16_bf16 v[80:95], a[152:155], v[144:147], v[80:95]
    v_exp_f32 v136, v136
    v_exp_f32 v137, v137
    v_exp_f32 v138, v138
    v_exp_f32 v139, v139
    v_cvt_pk_bf16_f32 v156, v136, v137
    v_cvt_pk_bf16_f32 v157, v138, v139
    v_mfma_f32_32x32x16_bf16 v[80:95], a[156:159], v[148:151], v[80:95]
    v_exp_f32 v140, v140
    v_exp_f32 v141, v141
    v_exp_f32 v142, v142
    v_exp_f32 v143, v143
    v_cvt_pk_bf16_f32 v158, v140, v141
    v_cvt_pk_bf16_f32 v159, v142, v143
    v_mfma_f32_32x32x16_bf16 v[128:143], a[168:171], v[24:27], 0
    v_exp_f32 v112, v112
    v_exp_f32 v113, v113
    v_exp_f32 v114, v114
    v_exp_f32 v115, v115
    v_cvt_pk_bf16_f32 v144, v112, v113
    v_cvt_pk_bf16_f32 v145, v114, v115
    v_mfma_f32_32x32x16_bf16 v[128:143], a[172:175], v[28:31], v[128:143]
    s_add_u32 s58, s40, 2
    s_and_b32 s58, s58, 3
    s_lshl_b32 s58, s58, 8
    s_add_u32 s58, s58, s40
    s_lshl_b32 s58, s58, 8
    s_lshl_b32 s59, s41, 18
    s_add_u32 s58, s58, s59
    s_and_b32 s59, s70, 2
    s_lshl_b32 s59, s59, 6
    s_add_u32 s58, s58, s59
    s_add_u32 m0, s63, 0
    s_nop 0
    buffer_load_dwordx4 v12, s[20:23], s58 offen offset:0 nt lds
    v_exp_f32 v116, v116
    v_exp_f32 v117, v117
    v_exp_f32 v118, v118
    v_exp_f32 v119, v119
    v_cvt_pk_bf16_f32 v146, v116, v117
    v_cvt_pk_bf16_f32 v147, v118, v119
    v_mfma_f32_32x32x16_bf16 v[96:111], a[152:155], v[152:155], v[96:111]
    buffer_load_dwordx4 v12, s[20:23], s58 offen offset:1024 nt lds
    v_exp_f32 v120, v120
    v_exp_f32 v121, v121
    v_exp_f32 v122, v122
    v_exp_f32 v123, v123
    v_cvt_pk_bf16_f32 v148, v120, v121
    v_cvt_pk_bf16_f32 v149, v122, v123
    v_mfma_f32_32x32x16_bf16 v[96:111], a[156:159], v[156:159], v[96:111]
    v_exp_f32 v124, v124
    v_exp_f32 v125, v125
    v_exp_f32 v126, v126
    v_exp_f32 v127, v127
    v_cvt_pk_bf16_f32 v150, v124, v125
    v_cvt_pk_bf16_f32 v151, v126, v127
    v_mfma_f32_32x32x16_bf16 v[112:127], a[168:171], v[32:35], 0
    s_waitcnt vmcnt(17)
    ds_read_b128 a[32:35], v14 offset:0
    ds_read_b128 a[48:51], v15 offset:0
    v_exp_f32 v128, v128
    v_exp_f32 v129, v129
    v_exp_f32 v130, v130
    v_exp_f32 v131, v131
    v_cvt_pk_bf16_f32 v152, v128, v129
    v_cvt_pk_bf16_f32 v153, v130, v131
    v_mfma_f32_32x32x16_bf16 v[112:127], a[172:175], v[36:39], v[112:127]
    ds_read_b128 a[96:99], v14 offset:1024
    ds_read_b128 a[112:115], v15 offset:1024
    v_exp_f32 v132, v132
    v_exp_f32 v133, v133
    v_exp_f32 v134, v134
    v_exp_f32 v135, v135
    v_cvt_pk_bf16_f32 v154, v132, v133
    v_cvt_pk_bf16_f32 v155, v134, v135
    v_mfma_f32_32x32x16_bf16 v[48:63], a[184:187], v[144:147], v[48:63]
    buffer_load_dwordx4 v12, s[20:23], s58 offen offset:2048 nt lds
    v_exp_f32 v136, v136
    v_exp_f32 v137, v137
    v_exp_f32 v138, v138
    v_exp_f32 v139, v139
    v_cvt_pk_bf16_f32 v156, v136, v137
    v_cvt_pk_bf16_f32 v157, v138, v139
    v_mfma_f32_32x32x16_bf16 v[48:63], a[188:191], v[148:151], v[48:63]
    buffer_load_dwordx4 v12, s[20:23], s58 offen offset:3072 nt lds
    v_exp_f32 v140, v140
    v_exp_f32 v141, v141
    v_exp_f32 v142, v142
    v_exp_f32 v143, v143
    v_cvt_pk_bf16_f32 v158, v140, v141
    v_cvt_pk_bf16_f32 v159, v142, v143
    v_mfma_f32_32x32x16_bf16 v[128:143], a[168:171], v[40:43], 0
    ds_read_b128 a[160:163], v14 offset:2048
    ds_read_b128 a[176:179], v15 offset:2048
    v_exp_f32 v112, v112
    v_exp_f32 v113, v113
    v_exp_f32 v114, v114
    v_exp_f32 v115, v115
    v_cvt_pk_bf16_f32 v144, v112, v113
    v_cvt_pk_bf16_f32 v145, v114, v115
    v_mfma_f32_32x32x16_bf16 v[128:143], a[172:175], v[44:47], v[128:143]
    ds_read_b128 a[224:227], v14 offset:3072
    ds_read_b128 a[240:243], v15 offset:3072
    v_exp_f32 v116, v116
    v_exp_f32 v117, v117
    v_exp_f32 v118, v118
    v_exp_f32 v119, v119
    v_cvt_pk_bf16_f32 v146, v116, v117
    v_cvt_pk_bf16_f32 v147, v118, v119
    v_mfma_f32_32x32x16_bf16 v[64:79], a[184:187], v[152:155], v[64:79]
    s_add_u32 m0, s63, 4096
    s_nop 0
    buffer_load_dwordx4 v13, s[20:23], s58 offen offset:0 nt lds
    v_exp_f32 v120, v120
    v_exp_f32 v121, v121
    v_exp_f32 v122, v122
    v_exp_f32 v123, v123
    v_cvt_pk_bf16_f32 v148, v120, v121
    v_cvt_pk_bf16_f32 v149, v122, v123
    v_mfma_f32_32x32x16_bf16 v[64:79], a[188:191], v[156:159], v[64:79]
    buffer_load_dwordx4 v13, s[20:23], s58 offen offset:1024 nt lds
    v_exp_f32 v124, v124
    v_exp_f32 v125, v125
    v_exp_f32 v126, v126
    v_exp_f32 v127, v127
    v_cvt_pk_bf16_f32 v150, v124, v125
    v_cvt_pk_bf16_f32 v151, v126, v127
    v_mfma_f32_32x32x16_bf16 v[112:127], a[200:203], v[16:19], 0
    v_exp_f32 v128, v128
    v_exp_f32 v129, v129
    v_exp_f32 v130, v130
    v_exp_f32 v131, v131
    v_cvt_pk_bf16_f32 v152, v128, v129
    v_cvt_pk_bf16_f32 v153, v130, v131
    v_mfma_f32_32x32x16_bf16 v[112:127], a[204:207], v[20:23], v[112:127]
    s_waitcnt lgkmcnt(0)
    v_exp_f32 v132, v132
    v_exp_f32 v133, v133
    v_exp_f32 v134, v134
    v_exp_f32 v135, v135
    v_cvt_pk_bf16_f32 v154, v132, v133
    v_cvt_pk_bf16_f32 v155, v134, v135
    v_mfma_f32_32x32x16_bf16 v[80:95], a[184:187], v[144:147], v[80:95]
    buffer_load_dwordx4 v13, s[20:23], s58 offen offset:2048 nt lds
    v_exp_f32 v136, v136
    v_exp_f32 v137, v137
    v_exp_f32 v138, v138
    v_exp_f32 v139, v139
    v_cvt_pk_bf16_f32 v156, v136, v137
    v_cvt_pk_bf16_f32 v157, v138, v139
    v_mfma_f32_32x32x16_bf16 v[80:95], a[188:191], v[148:151], v[80:95]
    buffer_load_dwordx4 v13, s[20:23], s58 offen offset:3072 nt lds
    v_exp_f32 v140, v140
    v_exp_f32 v141, v141
    v_exp_f32 v142, v142
    v_exp_f32 v143, v143
    v_cvt_pk_bf16_f32 v158, v140, v141
    v_cvt_pk_bf16_f32 v159, v142, v143
    v_mfma_f32_32x32x16_bf16 v[128:143], a[200:203], v[24:27], 0
    v_exp_f32 v112, v112
    v_exp_f32 v113, v113
    v_exp_f32 v114, v114
    v_exp_f32 v115, v115
    v_cvt_pk_bf16_f32 v144, v112, v113
    v_cvt_pk_bf16_f32 v145, v114, v115
    v_mfma_f32_32x32x16_bf16 v[128:143], a[204:207], v[28:31], v[128:143]
    s_add_u32 s58, s40, 2
    s_and_b32 s58, s58, 3
    s_lshl_b32 s58, s58, 8
    s_add_u32 s58, s58, s40
    s_lshl_b32 s58, s58, 8
    s_lshl_b32 s59, s41, 18
    s_add_u32 s58, s58, s59
    s_and_b32 s59, s70, 2
    s_lshl_b32 s59, s59, 6
    s_add_u32 s58, s58, s59
    s_xor_b32 s58, s58, 128
    s_add_u32 m0, s57, 0
    s_nop 0
    buffer_load_dwordx4 v12, s[20:23], s58 offen offset:0 nt lds
    v_exp_f32 v116, v116
    v_exp_f32 v117, v117
    v_exp_f32 v118, v118
    v_exp_f32 v119, v119
    v_cvt_pk_bf16_f32 v146, v116, v117
    v_cvt_pk_bf16_f32 v147, v118, v119
    v_mfma_f32_32x32x16_bf16 v[96:111], a[184:187], v[152:155], v[96:111]
    buffer_load_dwordx4 v12, s[20:23], s58 offen offset:1024 nt lds
    v_exp_f32 v120, v120
    v_exp_f32 v121, v121
    v_exp_f32 v122, v122
    v_exp_f32 v123, v123
    v_cvt_pk_bf16_f32 v148, v120, v121
    v_cvt_pk_bf16_f32 v149, v122, v123
    v_mfma_f32_32x32x16_bf16 v[96:111], a[188:191], v[156:159], v[96:111]
    v_exp_f32 v124, v124
    v_exp_f32 v125, v125
    v_exp_f32 v126, v126
    v_exp_f32 v127, v127
    v_cvt_pk_bf16_f32 v150, v124, v125
    v_cvt_pk_bf16_f32 v151, v126, v127
    v_mfma_f32_32x32x16_bf16 v[112:127], a[200:203], v[32:35], 0
    v_exp_f32 v128, v128
    v_exp_f32 v129, v129
    v_exp_f32 v130, v130
    v_exp_f32 v131, v131
    v_cvt_pk_bf16_f32 v152, v128, v129
    v_cvt_pk_bf16_f32 v153, v130, v131
    v_mfma_f32_32x32x16_bf16 v[112:127], a[204:207], v[36:39], v[112:127]
    buffer_load_dwordx4 v12, s[20:23], s58 offen offset:2048 nt lds
    v_exp_f32 v132, v132
    v_exp_f32 v133, v133
    v_exp_f32 v134, v134
    v_exp_f32 v135, v135
    v_cvt_pk_bf16_f32 v154, v132, v133
    v_cvt_pk_bf16_f32 v155, v134, v135
    v_mfma_f32_32x32x16_bf16 v[48:63], a[216:219], v[144:147], v[48:63]
    buffer_load_dwordx4 v12, s[20:23], s58 offen offset:3072 nt lds
    v_exp_f32 v136, v136
    v_exp_f32 v137, v137
    v_exp_f32 v138, v138
    v_exp_f32 v139, v139
    v_cvt_pk_bf16_f32 v156, v136, v137
    v_cvt_pk_bf16_f32 v157, v138, v139
    v_mfma_f32_32x32x16_bf16 v[48:63], a[220:223], v[148:151], v[48:63]
    v_exp_f32 v140, v140
    v_exp_f32 v141, v141
    v_exp_f32 v142, v142
    v_exp_f32 v143, v143
    v_cvt_pk_bf16_f32 v158, v140, v141
    v_cvt_pk_bf16_f32 v159, v142, v143
    v_mfma_f32_32x32x16_bf16 v[128:143], a[200:203], v[40:43], 0
    v_exp_f32 v112, v112
    v_exp_f32 v113, v113
    v_exp_f32 v114, v114
    v_exp_f32 v115, v115
    v_cvt_pk_bf16_f32 v144, v112, v113
    v_cvt_pk_bf16_f32 v145, v114, v115
    v_mfma_f32_32x32x16_bf16 v[128:143], a[204:207], v[44:47], v[128:143]
    s_add_u32 m0, s57, 4096
    s_nop 0
    buffer_load_dwordx4 v13, s[20:23], s58 offen offset:0 nt lds
    v_exp_f32 v116, v116
    v_exp_f32 v117, v117
    v_exp_f32 v118, v118
    v_exp_f32 v119, v119
    v_cvt_pk_bf16_f32 v146, v116, v117
    v_cvt_pk_bf16_f32 v147, v118, v119
    v_mfma_f32_32x32x16_bf16 v[64:79], a[216:219], v[152:155], v[64:79]
    buffer_load_dwordx4 v13, s[20:23], s58 offen offset:1024 nt lds
    v_exp_f32 v120, v120
    v_exp_f32 v121, v121
    v_exp_f32 v122, v122
    v_exp_f32 v123, v123
    v_cvt_pk_bf16_f32 v148, v120, v121
    v_cvt_pk_bf16_f32 v149, v122, v123
    v_mfma_f32_32x32x16_bf16 v[64:79], a[220:223], v[156:159], v[64:79]
    v_exp_f32 v124, v124
    v_exp_f32 v125, v125
    v_exp_f32 v126, v126
    v_exp_f32 v127, v127
    v_cvt_pk_bf16_f32 v150, v124, v125
    v_cvt_pk_bf16_f32 v151, v126, v127
    v_mfma_f32_32x32x16_bf16 v[112:127], a[232:235], v[16:19], 0
    v_exp_f32 v128, v128
    v_exp_f32 v129, v129
    v_exp_f32 v130, v130
    v_exp_f32 v131, v131
    v_cvt_pk_bf16_f32 v152, v128, v129
    v_cvt_pk_bf16_f32 v153, v130, v131
    v_mfma_f32_32x32x16_bf16 v[112:127], a[236:239], v[20:23], v[112:127]
    buffer_load_dwordx4 v13, s[20:23], s58 offen offset:2048 nt lds
    v_exp_f32 v132, v132
    v_exp_f32 v133, v133
    v_exp_f32 v134, v134
    v_exp_f32 v135, v135
    v_cvt_pk_bf16_f32 v154, v132, v133
    v_cvt_pk_bf16_f32 v155, v134, v135
    v_mfma_f32_32x32x16_bf16 v[80:95], a[216:219], v[144:147], v[80:95]
    buffer_load_dwordx4 v13, s[20:23], s58 offen offset:3072 nt lds
    v_exp_f32 v136, v136
    v_exp_f32 v137, v137
    v_exp_f32 v138, v138
    v_exp_f32 v139, v139
    v_cvt_pk_bf16_f32 v156, v136, v137
    v_cvt_pk_bf16_f32 v157, v138, v139
    v_mfma_f32_32x32x16_bf16 v[80:95], a[220:223], v[148:151], v[80:95]
    v_exp_f32 v140, v140
    v_exp_f32 v141, v141
    v_exp_f32 v142, v142
    v_exp_f32 v143, v143
    v_cvt_pk_bf16_f32 v158, v140, v141
    v_cvt_pk_bf16_f32 v159, v142, v143
    v_mfma_f32_32x32x16_bf16 v[128:143], a[232:235], v[24:27], 0
    v_exp_f32 v112, v112
    v_exp_f32 v113, v113
    v_exp_f32 v114, v114
    v_exp_f32 v115, v115
    v_cvt_pk_bf16_f32 v144, v112, v113
    v_cvt_pk_bf16_f32 v145, v114, v115
    v_mfma_f32_32x32x16_bf16 v[128:143], a[236:239], v[28:31], v[128:143]
    buffer_load_dword v4, v250, s[20:23], 0 offen
    v_exp_f32 v116, v116
    v_exp_f32 v117, v117
    v_exp_f32 v118, v118
    v_exp_f32 v119, v119
    v_cvt_pk_bf16_f32 v146, v116, v117
    v_cvt_pk_bf16_f32 v147, v118, v119
    v_mfma_f32_32x32x16_bf16 v[96:111], a[216:219], v[152:155], v[96:111]
    v_exp_f32 v120, v120
    v_exp_f32 v121, v121
    v_exp_f32 v122, v122
    v_exp_f32 v123, v123
    v_cvt_pk_bf16_f32 v148, v120, v121
    v_cvt_pk_bf16_f32 v149, v122, v123
    v_mfma_f32_32x32x16_bf16 v[96:111], a[220:223], v[156:159], v[96:111]
    v_exp_f32 v124, v124
    v_exp_f32 v125, v125
    v_exp_f32 v126, v126
    v_exp_f32 v127, v127
    v_cvt_pk_bf16_f32 v150, v124, v125
    v_cvt_pk_bf16_f32 v151, v126, v127
    v_mfma_f32_32x32x16_bf16 v[112:127], a[232:235], v[32:35], 0
    v_exp_f32 v128, v128
    v_exp_f32 v129, v129
    v_exp_f32 v130, v130
    v_exp_f32 v131, v131
    v_cvt_pk_bf16_f32 v152, v128, v129
    v_cvt_pk_bf16_f32 v153, v130, v131
    v_mfma_f32_32x32x16_bf16 v[112:127], a[236:239], v[36:39], v[112:127]
    s_lshl_b32 s62, s2, 2
    s_add_u32 s62, s62, s40
    s_mul_i32 s62, s62, 896
    v_and_b32 v227, 7, v1
    v_lshlrev_b32 v227, 7, v227
    buffer_load_dword v4, v227, s[28:31], s62 offen
    v_exp_f32 v132, v132
    v_exp_f32 v133, v133
    v_exp_f32 v134, v134
    v_exp_f32 v135, v135
    v_cvt_pk_bf16_f32 v154, v132, v133
    v_cvt_pk_bf16_f32 v155, v134, v135
    v_mfma_f32_32x32x16_bf16 v[48:63], a[248:251], v[144:147], v[48:63]
    v_exp_f32 v136, v136
    v_exp_f32 v137, v137
    v_exp_f32 v138, v138
    v_exp_f32 v139, v139
    v_cvt_pk_bf16_f32 v156, v136, v137
    v_cvt_pk_bf16_f32 v157, v138, v139
    v_mfma_f32_32x32x16_bf16 v[48:63], a[252:255], v[148:151], v[48:63]
    v_exp_f32 v140, v140
    v_exp_f32 v141, v141
    v_exp_f32 v142, v142
    v_exp_f32 v143, v143
    v_cvt_pk_bf16_f32 v158, v140, v141
    v_cvt_pk_bf16_f32 v159, v142, v143
    v_mfma_f32_32x32x16_bf16 v[128:143], a[232:235], v[40:43], 0
    v_exp_f32 v112, v112
    v_exp_f32 v113, v113
    v_exp_f32 v114, v114
    v_exp_f32 v115, v115
    v_cvt_pk_bf16_f32 v144, v112, v113
    v_cvt_pk_bf16_f32 v145, v114, v115
    v_mfma_f32_32x32x16_bf16 v[128:143], a[236:239], v[44:47], v[128:143]
    s_lshl_b32 s62, s47, 5
    v_mov_b32 v227, 0
    buffer_load_dword v4, v227, s[24:27], s62 offen
    v_exp_f32 v116, v116
    v_exp_f32 v117, v117
    v_exp_f32 v118, v118
    v_exp_f32 v119, v119
    v_cvt_pk_bf16_f32 v146, v116, v117
    v_cvt_pk_bf16_f32 v147, v118, v119
    v_mfma_f32_32x32x16_bf16 v[64:79], a[248:251], v[152:155], v[64:79]
    v_exp_f32 v120, v120
    v_exp_f32 v121, v121
    v_exp_f32 v122, v122
    v_exp_f32 v123, v123
    v_cvt_pk_bf16_f32 v148, v120, v121
    v_cvt_pk_bf16_f32 v149, v122, v123
    v_mfma_f32_32x32x16_bf16 v[64:79], a[252:255], v[156:159], v[64:79]
    v_exp_f32 v124, v124
    v_exp_f32 v125, v125
    v_exp_f32 v126, v126
    v_exp_f32 v127, v127
    v_cvt_pk_bf16_f32 v150, v124, v125
    v_cvt_pk_bf16_f32 v151, v126, v127
    v_mfma_f32_32x32x16_bf16 v[112:127], v[160:163], v[16:19], 0
    v_exp_f32 v128, v128
    v_exp_f32 v129, v129
    v_exp_f32 v130, v130
    v_exp_f32 v131, v131
    v_cvt_pk_bf16_f32 v152, v128, v129
    v_cvt_pk_bf16_f32 v153, v130, v131
    v_mfma_f32_32x32x16_bf16 v[112:127], v[164:167], v[20:23], v[112:127]
    v_exp_f32 v132, v132
    v_exp_f32 v133, v133
    v_exp_f32 v134, v134
    v_exp_f32 v135, v135
    v_cvt_pk_bf16_f32 v154, v132, v133
    v_cvt_pk_bf16_f32 v155, v134, v135
    v_mfma_f32_32x32x16_bf16 v[80:95], a[248:251], v[144:147], v[80:95]
    v_exp_f32 v136, v136
    v_exp_f32 v137, v137
    v_exp_f32 v138, v138
    v_exp_f32 v139, v139
    v_cvt_pk_bf16_f32 v156, v136, v137
    v_cvt_pk_bf16_f32 v157, v138, v139
    v_mfma_f32_32x32x16_bf16 v[80:95], a[252:255], v[148:151], v[80:95]
    v_exp_f32 v140, v140
    v_exp_f32 v141, v141
    v_exp_f32 v142, v142
    v_exp_f32 v143, v143
    v_cvt_pk_bf16_f32 v158, v140, v141
    v_cvt_pk_bf16_f32 v159, v142, v143
    v_mfma_f32_32x32x16_bf16 v[128:143], v[160:163], v[24:27], 0
    v_exp_f32 v112, v112
    v_exp_f32 v113, v113
    v_exp_f32 v114, v114
    v_exp_f32 v115, v115
    v_cvt_pk_bf16_f32 v144, v112, v113
    v_cvt_pk_bf16_f32 v145, v114, v115
    v_mfma_f32_32x32x16_bf16 v[128:143], v[164:167], v[28:31], v[128:143]
    v_exp_f32 v116, v116
    v_exp_f32 v117, v117
    v_exp_f32 v118, v118
    v_exp_f32 v119, v119
    v_cvt_pk_bf16_f32 v146, v116, v117
    v_cvt_pk_bf16_f32 v147, v118, v119
    v_mfma_f32_32x32x16_bf16 v[96:111], a[248:251], v[152:155], v[96:111]
    v_exp_f32 v120, v120
    v_exp_f32 v121, v121
    v_exp_f32 v122, v122
    v_exp_f32 v123, v123
    v_cvt_pk_bf16_f32 v148, v120, v121
    v_cvt_pk_bf16_f32 v149, v122, v123
    v_mfma_f32_32x32x16_bf16 v[96:111], a[252:255], v[156:159], v[96:111]
    v_exp_f32 v124, v124
    v_exp_f32 v125, v125
    v_exp_f32 v126, v126
    v_exp_f32 v127, v127
    v_cvt_pk_bf16_f32 v150, v124, v125
    v_cvt_pk_bf16_f32 v151, v126, v127
    v_mfma_f32_32x32x16_bf16 v[112:127], v[160:163], v[32:35], 0
    v_exp_f32 v128, v128
    v_exp_f32 v129, v129
    v_exp_f32 v130, v130
    v_exp_f32 v131, v131
    v_cvt_pk_bf16_f32 v152, v128, v129
    v_cvt_pk_bf16_f32 v153, v130, v131
    v_mfma_f32_32x32x16_bf16 v[112:127], v[164:167], v[36:39], v[112:127]
    v_exp_f32 v132, v132
    v_exp_f32 v133, v133
    v_exp_f32 v134, v134
    v_exp_f32 v135, v135
    v_cvt_pk_bf16_f32 v154, v132, v133
    v_cvt_pk_bf16_f32 v155, v134, v135
    v_mfma_f32_32x32x16_bf16 v[48:63], v[168:171], v[144:147], v[48:63]
    v_exp_f32 v136, v136
    v_exp_f32 v137, v137
    v_exp_f32 v138, v138
    v_exp_f32 v139, v139
    v_cvt_pk_bf16_f32 v156, v136, v137
    v_cvt_pk_bf16_f32 v157, v138, v139
    v_mfma_f32_32x32x16_bf16 v[48:63], v[172:175], v[148:151], v[48:63]
    v_exp_f32 v140, v140
    v_exp_f32 v141, v141
    v_exp_f32 v142, v142
    v_exp_f32 v143, v143
    v_cvt_pk_bf16_f32 v158, v140, v141
    v_cvt_pk_bf16_f32 v159, v142, v143
    v_mfma_f32_32x32x16_bf16 v[128:143], v[160:163], v[40:43], 0
    v_exp_f32 v112, v112
    v_exp_f32 v113, v113
    v_exp_f32 v114, v114
    v_exp_f32 v115, v115
    v_cvt_pk_bf16_f32 v144, v112, v113
    v_cvt_pk_bf16_f32 v145, v114, v115
    v_mfma_f32_32x32x16_bf16 v[128:143], v[164:167], v[44:47], v[128:143]
    s_waitcnt vmcnt(11)
    ds_read_b128 a[4:7], v251 offset:0
    ds_read_b128 a[20:23], v252 offset:0
    v_exp_f32 v116, v116
    v_exp_f32 v117, v117
    v_exp_f32 v118, v118
    v_exp_f32 v119, v119
    v_cvt_pk_bf16_f32 v146, v116, v117
    v_cvt_pk_bf16_f32 v147, v118, v119
    v_mfma_f32_32x32x16_bf16 v[64:79], v[168:171], v[152:155], v[64:79]
    ds_read_b128 a[68:71], v251 offset:1024
    ds_read_b128 a[84:87], v252 offset:1024
    v_exp_f32 v120, v120
    v_exp_f32 v121, v121
    v_exp_f32 v122, v122
    v_exp_f32 v123, v123
    v_cvt_pk_bf16_f32 v148, v120, v121
    v_cvt_pk_bf16_f32 v149, v122, v123
    v_mfma_f32_32x32x16_bf16 v[64:79], v[172:175], v[156:159], v[64:79]
    v_exp_f32 v124, v124
    v_exp_f32 v125, v125
    v_exp_f32 v126, v126
    v_exp_f32 v127, v127
    v_cvt_pk_bf16_f32 v150, v124, v125
    v_cvt_pk_bf16_f32 v151, v126, v127
    v_mfma_f32_32x32x16_bf16 v[112:127], v[176:179], v[16:19], 0
    v_exp_f32 v128, v128
    v_exp_f32 v129, v129
    v_exp_f32 v130, v130
    v_exp_f32 v131, v131
    v_cvt_pk_bf16_f32 v152, v128, v129
    v_cvt_pk_bf16_f32 v153, v130, v131
    v_mfma_f32_32x32x16_bf16 v[112:127], v[180:183], v[20:23], v[112:127]
    ds_read_b128 a[132:135], v251 offset:2048
    ds_read_b128 a[148:151], v252 offset:2048
    v_exp_f32 v132, v132
    v_exp_f32 v133, v133
    v_exp_f32 v134, v134
    v_exp_f32 v135, v135
    v_cvt_pk_bf16_f32 v154, v132, v133
    v_cvt_pk_bf16_f32 v155, v134, v135
    v_mfma_f32_32x32x16_bf16 v[80:95], v[168:171], v[144:147], v[80:95]
    ds_read_b128 a[196:199], v251 offset:3072
    ds_read_b128 a[212:215], v252 offset:3072
    v_exp_f32 v136, v136
    v_exp_f32 v137, v137
    v_exp_f32 v138, v138
    v_exp_f32 v139, v139
    v_cvt_pk_bf16_f32 v156, v136, v137
    v_cvt_pk_bf16_f32 v157, v138, v139
    v_mfma_f32_32x32x16_bf16 v[80:95], v[172:175], v[148:151], v[80:95]
    v_exp_f32 v140, v140
    v_exp_f32 v141, v141
    v_exp_f32 v142, v142
    v_exp_f32 v143, v143
    v_cvt_pk_bf16_f32 v158, v140, v141
    v_cvt_pk_bf16_f32 v159, v142, v143
    v_mfma_f32_32x32x16_bf16 v[128:143], v[176:179], v[24:27], 0
    v_exp_f32 v112, v112
    v_exp_f32 v113, v113
    v_exp_f32 v114, v114
    v_exp_f32 v115, v115
    v_cvt_pk_bf16_f32 v144, v112, v113
    v_cvt_pk_bf16_f32 v145, v114, v115
    v_mfma_f32_32x32x16_bf16 v[128:143], v[180:183], v[28:31], v[128:143]
    s_waitcnt lgkmcnt(0)
    v_exp_f32 v116, v116
    v_exp_f32 v117, v117
    v_exp_f32 v118, v118
    v_exp_f32 v119, v119
    v_cvt_pk_bf16_f32 v146, v116, v117
    v_cvt_pk_bf16_f32 v147, v118, v119
    v_mfma_f32_32x32x16_bf16 v[96:111], v[168:171], v[152:155], v[96:111]
    v_cmp_ne_u32 vcc, s45, v236
    v_cmp_ne_u32 s[66:67], s45, v237
    s_nop 1
    s_or_b64 vcc, vcc, s[66:67]
    s_cbranch_vccz L_hf_18
    s_mov_b32 s48, 0
L_hp_19:
    buffer_load_dwordx2 v[236:237], v253, s[36:39], 0 offen sc1
    s_add_u32 s48, s48, 1
    s_cmp_gt_u32 s48, 0x80000
    s_waitcnt vmcnt(0)
    s_cbranch_scc1 L_hf_18
    v_cmp_ne_u32 vcc, s45, v236
    v_cmp_ne_u32 s[66:67], s45, v237
    s_nop 1
    s_or_b64 vcc, vcc, s[66:67]
    s_cbranch_vccnz L_hp_19
L_hf_18:
    v_exp_f32 v120, v120
    v_exp_f32 v121, v121
    v_exp_f32 v122, v122
    v_exp_f32 v123, v123
    v_cvt_pk_bf16_f32 v148, v120, v121
    v_cvt_pk_bf16_f32 v149, v122, v123
    v_mfma_f32_32x32x16_bf16 v[96:111], v[172:175], v[156:159], v[96:111]
    v_exp_f32 v124, v124
    v_exp_f32 v125, v125
    v_exp_f32 v126, v126
    v_exp_f32 v127, v127
    v_cvt_pk_bf16_f32 v150, v124, v125
    v_cvt_pk_bf16_f32 v151, v126, v127
    v_mfma_f32_32x32x16_bf16 v[112:127], v[176:179], v[32:35], 0
    v_exp_f32 v128, v128
    v_exp_f32 v129, v129
    v_exp_f32 v130, v130
    v_exp_f32 v131, v131
    v_cvt_pk_bf16_f32 v152, v128, v129
    v_cvt_pk_bf16_f32 v153, v130, v131
    v_mfma_f32_32x32x16_bf16 v[112:127], v[180:183], v[36:39], v[112:127]
    s_mul_i32 s61, s69, 14
    s_add_u32 s60, s61, s68
    s_add_u32 s60, s60, 802816
    s_add_u32 m0, s61, 57344
    s_nop 0
    buffer_load_dwordx4 v2, s[36:39], s60 offen offset:0 sc1 lds
    v_exp_f32 v132, v132
    v_exp_f32 v133, v133
    v_exp_f32 v134, v134
    v_exp_f32 v135, v135
    v_cvt_pk_bf16_f32 v154, v132, v133
    v_cvt_pk_bf16_f32 v155, v134, v135
    v_mfma_f32_32x32x16_bf16 v[48:63], v[184:187], v[144:147], v[48:63]
    buffer_load_dwordx4 v2, s[36:39], s60 offen offset:1024 sc1 lds
    v_exp_f32 v136, v136
    v_exp_f32 v137, v137
    v_exp_f32 v138, v138
    v_exp_f32 v139, v139
    v_cvt_pk_bf16_f32 v156, v136, v137
    v_cvt_pk_bf16_f32 v157, v138, v139
    v_mfma_f32_32x32x16_bf16 v[48:63], v[188:191], v[148:151], v[48:63]
    v_exp_f32 v140, v140
    v_exp_f32 v141, v141
    v_exp_f32 v142, v142
    v_exp_f32 v143, v143
    v_cvt_pk_bf16_f32 v158, v140, v141
    v_cvt_pk_bf16_f32 v159, v142, v143
    v_mfma_f32_32x32x16_bf16 v[128:143], v[176:179], v[40:43], 0
    s_waitcnt vmcnt(5)
    ds_read_b128 a[36:39], v14 offset:0
    ds_read_b128 a[52:55], v15 offset:0
    v_exp_f32 v112, v112
    v_exp_f32 v113, v113
    v_exp_f32 v114, v114
    v_exp_f32 v115, v115
    v_cvt_pk_bf16_f32 v144, v112, v113
    v_cvt_pk_bf16_f32 v145, v114, v115
    v_mfma_f32_32x32x16_bf16 v[128:143], v[180:183], v[44:47], v[128:143]
    ds_read_b128 a[100:103], v14 offset:1024
    ds_read_b128 a[116:119], v15 offset:1024
    v_exp_f32 v116, v116
    v_exp_f32 v117, v117
    v_exp_f32 v118, v118
    v_exp_f32 v119, v119
    v_cvt_pk_bf16_f32 v146, v116, v117
    v_cvt_pk_bf16_f32 v147, v118, v119
    v_mfma_f32_32x32x16_bf16 v[64:79], v[184:187], v[152:155], v[64:79]
    buffer_load_dwordx4 v2, s[36:39], s60 offen offset:2048 sc1 lds
    v_exp_f32 v120, v120
    v_exp_f32 v121, v121
    v_exp_f32 v122, v122
    v_exp_f32 v123, v123
    v_cvt_pk_bf16_f32 v148, v120, v121
    v_cvt_pk_bf16_f32 v149, v122, v123
    v_mfma_f32_32x32x16_bf16 v[64:79], v[188:191], v[156:159], v[64:79]
    buffer_load_dwordx4 v2, s[36:39], s60 offen offset:3072 sc1 lds
    v_exp_f32 v124, v124
    v_exp_f32 v125, v125
    v_exp_f32 v126, v126
    v_exp_f32 v127, v127
    v_cvt_pk_bf16_f32 v150, v124, v125
    v_cvt_pk_bf16_f32 v151, v126, v127
    v_mfma_f32_32x32x16_bf16 v[112:127], v[192:195], v[16:19], 0
    ds_read_b128 a[164:167], v14 offset:2048
    ds_read_b128 a[180:183], v15 offset:2048
    v_exp_f32 v128, v128
    v_exp_f32 v129, v129
    v_exp_f32 v130, v130
    v_exp_f32 v131, v131
    v_cvt_pk_bf16_f32 v152, v128, v129
    v_cvt_pk_bf16_f32 v153, v130, v131
    v_mfma_f32_32x32x16_bf16 v[112:127], v[196:199], v[20:23], v[112:127]
    ds_read_b128 a[228:231], v14 offset:3072
    ds_read_b128 a[244:247], v15 offset:3072
    v_exp_f32 v132, v132
    v_exp_f32 v133, v133
    v_exp_f32 v134, v134
    v_exp_f32 v135, v135
    v_cvt_pk_bf16_f32 v154, v132, v133
    v_cvt_pk_bf16_f32 v155, v134, v135
    v_mfma_f32_32x32x16_bf16 v[80:95], v[184:187], v[144:147], v[80:95]
    s_add_u32 m0, s61, 61440
    s_add_u32 s60, s60, 4096
    buffer_load_dwordx4 v2, s[36:39], s60 offen offset:0 sc1 lds
    v_exp_f32 v136, v136
    v_exp_f32 v137, v137
    v_exp_f32 v138, v138
    v_exp_f32 v139, v139
    v_cvt_pk_bf16_f32 v156, v136, v137
    v_cvt_pk_bf16_f32 v157, v138, v139
    v_mfma_f32_32x32x16_bf16 v[80:95], v[188:191], v[148:151], v[80:95]
    buffer_load_dwordx4 v2, s[36:39], s60 offen offset:1024 sc1 lds
    v_exp_f32 v140, v140
    v_exp_f32 v141, v141
    v_exp_f32 v142, v142
    v_exp_f32 v143, v143
    v_cvt_pk_bf16_f32 v158, v140, v141
    v_cvt_pk_bf16_f32 v159, v142, v143
    v_mfma_f32_32x32x16_bf16 v[128:143], v[192:195], v[24:27], 0
    v_exp_f32 v112, v112
    v_exp_f32 v113, v113
    v_exp_f32 v114, v114
    v_exp_f32 v115, v115
    v_cvt_pk_bf16_f32 v144, v112, v113
    v_cvt_pk_bf16_f32 v145, v114, v115
    v_mfma_f32_32x32x16_bf16 v[128:143], v[196:199], v[28:31], v[128:143]
    s_waitcnt lgkmcnt(0)
    v_exp_f32 v116, v116
    v_exp_f32 v117, v117
    v_exp_f32 v118, v118
    v_exp_f32 v119, v119
    v_cvt_pk_bf16_f32 v146, v116, v117
    v_cvt_pk_bf16_f32 v147, v118, v119
    v_mfma_f32_32x32x16_bf16 v[96:111], v[184:187], v[152:155], v[96:111]
    buffer_load_dwordx4 v2, s[36:39], s60 offen offset:2048 sc1 lds
    v_exp_f32 v120, v120
    v_exp_f32 v121, v121
    v_exp_f32 v122, v122
    v_exp_f32 v123, v123
    v_cvt_pk_bf16_f32 v148, v120, v121
    v_cvt_pk_bf16_f32 v149, v122, v123
    v_mfma_f32_32x32x16_bf16 v[96:111], v[188:191], v[156:159], v[96:111]
    buffer_load_dwordx4 v2, s[36:39], s60 offen offset:3072 sc1 lds
    v_exp_f32 v124, v124
    v_exp_f32 v125, v125
    v_exp_f32 v126, v126
    v_exp_f32 v127, v127
    v_cvt_pk_bf16_f32 v150, v124, v125
    v_cvt_pk_bf16_f32 v151, v126, v127
    v_mfma_f32_32x32x16_bf16 v[112:127], v[192:195], v[32:35], 0
    v_exp_f32 v128, v128
    v_exp_f32 v129, v129
    v_exp_f32 v130, v130
    v_exp_f32 v131, v131
    v_cvt_pk_bf16_f32 v152, v128, v129
    v_cvt_pk_bf16_f32 v153, v130, v131
    v_mfma_f32_32x32x16_bf16 v[112:127], v[196:199], v[36:39], v[112:127]
    s_add_u32 m0, s61, 65536
    s_add_u32 s60, s60, 4096
    buffer_load_dwordx4 v2, s[36:39], s60 offen offset:0 sc1 lds
    v_exp_f32 v132, v132
    v_exp_f32 v133, v133
    v_exp_f32 v134, v134
    v_exp_f32 v135, v135
    v_cvt_pk_bf16_f32 v154, v132, v133
    v_cvt_pk_bf16_f32 v155, v134, v135
    v_mfma_f32_32x32x16_bf16 v[48:63], v[200:203], v[144:147], v[48:63]
    buffer_load_dwordx4 v2, s[36:39], s60 offen offset:1024 sc1 lds
    v_exp_f32 v136, v136
    v_exp_f32 v137, v137
    v_exp_f32 v138, v138
    v_exp_f32 v139, v139
    v_cvt_pk_bf16_f32 v156, v136, v137
    v_cvt_pk_bf16_f32 v157, v138, v139
    v_mfma_f32_32x32x16_bf16 v[48:63], v[204:207], v[148:151], v[48:63]
    v_exp_f32 v140, v140
    v_exp_f32 v141, v141
    v_exp_f32 v142, v142
    v_exp_f32 v143, v143
    v_cvt_pk_bf16_f32 v158, v140, v141
    v_cvt_pk_bf16_f32 v159, v142, v143
    v_mfma_f32_32x32x16_bf16 v[128:143], v[192:195], v[40:43], 0
    v_exp_f32 v112, v112
    v_exp_f32 v113, v113
    v_exp_f32 v114, v114
    v_exp_f32 v115, v115
    v_cvt_pk_bf16_f32 v144, v112, v113
    v_cvt_pk_bf16_f32 v145, v114, v115
    v_mfma_f32_32x32x16_bf16 v[128:143], v[196:199], v[44:47], v[128:143]
    buffer_load_dwordx4 v2, s[36:39], s60 offen offset:2048 sc1 lds
    v_exp_f32 v116, v116
    v_exp_f32 v117, v117
    v_exp_f32 v118, v118
    v_exp_f32 v119, v119
    v_cvt_pk_bf16_f32 v146, v116, v117
    v_cvt_pk_bf16_f32 v147, v118, v119
    v_mfma_f32_32x32x16_bf16 v[64:79], v[200:203], v[152:155], v[64:79]
    buffer_load_dwordx4 v2, s[36:39], s60 offen offset:3072 sc1 lds
    v_exp_f32 v120, v120
    v_exp_f32 v121, v121
    v_exp_f32 v122, v122
    v_exp_f32 v123, v123
    v_cvt_pk_bf16_f32 v148, v120, v121
    v_cvt_pk_bf16_f32 v149, v122, v123
    v_mfma_f32_32x32x16_bf16 v[64:79], v[204:207], v[156:159], v[64:79]
    v_exp_f32 v124, v124
    v_exp_f32 v125, v125
    v_exp_f32 v126, v126
    v_exp_f32 v127, v127
    v_cvt_pk_bf16_f32 v150, v124, v125
    v_cvt_pk_bf16_f32 v151, v126, v127
    v_mfma_f32_32x32x16_bf16 v[112:127], v[208:211], v[16:19], 0
    v_exp_f32 v128, v128
    v_exp_f32 v129, v129
    v_exp_f32 v130, v130
    v_exp_f32 v131, v131
    v_cvt_pk_bf16_f32 v152, v128, v129
    v_cvt_pk_bf16_f32 v153, v130, v131
    v_mfma_f32_32x32x16_bf16 v[112:127], v[212:215], v[20:23], v[112:127]
    s_add_u32 m0, s61, 69632
    s_add_u32 s60, s60, 4096
    buffer_load_dwordx4 v2, s[36:39], s60 offen offset:0 sc1 lds
    v_exp_f32 v132, v132
    v_exp_f32 v133, v133
    v_exp_f32 v134, v134
    v_exp_f32 v135, v135
    v_cvt_pk_bf16_f32 v154, v132, v133
    v_cvt_pk_bf16_f32 v155, v134, v135
    v_mfma_f32_32x32x16_bf16 v[80:95], v[200:203], v[144:147], v[80:95]
    buffer_load_dwordx4 v2, s[36:39], s60 offen offset:1024 sc1 lds
    v_exp_f32 v136, v136
    v_exp_f32 v137, v137
    v_exp_f32 v138, v138
    v_exp_f32 v139, v139
    v_cvt_pk_bf16_f32 v156, v136, v137
    v_cvt_pk_bf16_f32 v157, v138, v139
    v_mfma_f32_32x32x16_bf16 v[80:95], v[204:207], v[148:151], v[80:95]
    v_exp_f32 v140, v140
    v_exp_f32 v141, v141
    v_exp_f32 v142, v142
    v_exp_f32 v143, v143
    v_cvt_pk_bf16_f32 v158, v140, v141
    v_cvt_pk_bf16_f32 v159, v142, v143
    v_mfma_f32_32x32x16_bf16 v[128:143], v[208:211], v[24:27], 0
    v_exp_f32 v112, v112
    v_exp_f32 v113, v113
    v_exp_f32 v114, v114
    v_exp_f32 v115, v115
    v_cvt_pk_bf16_f32 v144, v112, v113
    v_cvt_pk_bf16_f32 v145, v114, v115
    v_mfma_f32_32x32x16_bf16 v[128:143], v[212:215], v[28:31], v[128:143]
    v_exp_f32 v116, v116
    v_exp_f32 v117, v117
    v_exp_f32 v118, v118
    v_exp_f32 v119, v119
    v_cvt_pk_bf16_f32 v146, v116, v117
    v_cvt_pk_bf16_f32 v147, v118, v119
    v_mfma_f32_32x32x16_bf16 v[96:111], v[200:203], v[152:155], v[96:111]
    v_exp_f32 v120, v120
    v_exp_f32 v121, v121
    v_exp_f32 v122, v122
    v_exp_f32 v123, v123
    v_cvt_pk_bf16_f32 v148, v120, v121
    v_cvt_pk_bf16_f32 v149, v122, v123
    v_mfma_f32_32x32x16_bf16 v[96:111], v[204:207], v[156:159], v[96:111]
    v_exp_f32 v124, v124
    v_exp_f32 v125, v125
    v_exp_f32 v126, v126
    v_exp_f32 v127, v127
    v_cvt_pk_bf16_f32 v150, v124, v125
    v_cvt_pk_bf16_f32 v151, v126, v127
    v_mfma_f32_32x32x16_bf16 v[112:127], v[208:211], v[32:35], 0
    v_exp_f32 v128, v128
    v_exp_f32 v129, v129
    v_exp_f32 v130, v130
    v_exp_f32 v131, v131
    v_cvt_pk_bf16_f32 v152, v128, v129
    v_cvt_pk_bf16_f32 v153, v130, v131
    v_mfma_f32_32x32x16_bf16 v[112:127], v[212:215], v[36:39], v[112:127]
    v_exp_f32 v132, v132
    v_exp_f32 v133, v133
    v_exp_f32 v134, v134
    v_exp_f32 v135, v135
    v_cvt_pk_bf16_f32 v154, v132, v133
    v_cvt_pk_bf16_f32 v155, v134, v135
    v_mfma_f32_32x32x16_bf16 v[48:63], v[216:219], v[144:147], v[48:63]
    v_exp_f32 v136, v136
    v_exp_f32 v137, v137
    v_exp_f32 v138, v138
    v_exp_f32 v139, v139
    v_cvt_pk_bf16_f32 v156, v136, v137
    v_cvt_pk_bf16_f32 v157, v138, v139
    v_mfma_f32_32x32x16_bf16 v[48:63], v[220:223], v[148:151], v[48:63]
    v_exp_f32 v140, v140
    v_exp_f32 v141, v141
    v_exp_f32 v142, v142
    v_exp_f32 v143, v143
    v_cvt_pk_bf16_f32 v158, v140, v141
    v_cvt_pk_bf16_f32 v159, v142, v143
    v_mfma_f32_32x32x16_bf16 v[128:143], v[208:211], v[40:43], 0
    s_nop 4
    ds_write_b128 v5, v[48:51] offset:0
    ds_write_b128 v5, v[52:55] offset:1024
    v_exp_f32 v112, v112
    v_exp_f32 v113, v113
    v_exp_f32 v114, v114
    v_exp_f32 v115, v115
    v_cvt_pk_bf16_f32 v144, v112, v113
    v_cvt_pk_bf16_f32 v145, v114, v115
    v_mfma_f32_32x32x16_bf16 v[128:143], v[212:215], v[44:47], v[128:143]
    ds_write_b128 v5, v[56:59] offset:2048
    ds_write_b128 v5, v[60:63] offset:3072
    v_exp_f32 v116, v116
    v_exp_f32 v117, v117
    v_exp_f32 v118, v118
    v_exp_f32 v119, v119
    v_cvt_pk_bf16_f32 v146, v116, v117
    v_cvt_pk_bf16_f32 v147, v118, v119
    v_mfma_f32_32x32x16_bf16 v[64:79], v[216:219], v[152:155], v[64:79]
    v_exp_f32 v120, v120
    v_exp_f32 v121, v121
    v_exp_f32 v122, v122
    v_exp_f32 v123, v123
    v_cvt_pk_bf16_f32 v148, v120, v121
    v_cvt_pk_bf16_f32 v149, v122, v123
    v_mfma_f32_32x32x16_bf16 v[64:79], v[220:223], v[156:159], v[64:79]
    v_exp_f32 v124, v124
    v_exp_f32 v125, v125
    v_exp_f32 v126, v126
    v_exp_f32 v127, v127
    v_cvt_pk_bf16_f32 v150, v124, v125
    v_cvt_pk_bf16_f32 v151, v126, v127
    s_nop 5
    ds_write_b128 v5, v[64:67] offset:4096
    ds_write_b128 v5, v[68:71] offset:5120
    v_exp_f32 v128, v128
    v_exp_f32 v129, v129
    v_exp_f32 v130, v130
    v_exp_f32 v131, v131
    v_cvt_pk_bf16_f32 v152, v128, v129
    v_cvt_pk_bf16_f32 v153, v130, v131
    ds_write_b128 v5, v[72:75] offset:6144
    ds_write_b128 v5, v[76:79] offset:7168
    v_exp_f32 v132, v132
    v_exp_f32 v133, v133
    v_exp_f32 v134, v134
    v_exp_f32 v135, v135
    v_cvt_pk_bf16_f32 v154, v132, v133
    v_cvt_pk_bf16_f32 v155, v134, v135
    v_mfma_f32_32x32x16_bf16 v[80:95], v[216:219], v[144:147], v[80:95]
    v_exp_f32 v136, v136
    v_exp_f32 v137, v137
    v_exp_f32 v138, v138
    v_exp_f32 v139, v139
    v_cvt_pk_bf16_f32 v156, v136, v137
    v_cvt_pk_bf16_f32 v157, v138, v139
    v_mfma_f32_32x32x16_bf16 v[80:95], v[220:223], v[148:151], v[80:95]
    v_exp_f32 v140, v140
    v_exp_f32 v141, v141
    v_exp_f32 v142, v142
    v_exp_f32 v143, v143
    v_cvt_pk_bf16_f32 v158, v140, v141
    v_cvt_pk_bf16_f32 v159, v142, v143
    v_mfma_f32_32x32x16_bf16 v[96:111], v[216:219], v[152:155], v[96:111]
    s_nop 0
    v_mfma_f32_32x32x16_bf16 v[96:111], v[220:223], v[156:159], v[96:111]
    s_nop 2
    ds_write_b128 v5, v[80:83] offset:8192
    ds_write_b128 v5, v[84:87] offset:9216
    ds_write_b128 v5, v[88:91] offset:10240
    v_max3_f32 v224, v60, v76, v92
    s_nop 4
    v_max_f32 v224, v224, v108
    v_cmp_nge_f32 vcc, 0x4e800000, v224
    s_nop 1
    s_and_b64 vcc, vcc, s[64:65]
    s_cselect_b32 s55, 1, 0
    v_mov_b32 v226, s55
    v_cndmask_b32 v93, v93, v226, s[64:65]
    ds_write_b128 v5, v[92:95] offset:11264
    s_lshl_b32 s54, s44, 3
    s_lshl_b32 s56, s40, 1
    s_add_u32 s54, s54, s56
    s_lshl_b32 s54, s54, 14
    s_lshl_b32 s56, s43, 10
    s_add_u32 s54, s54, s56
    s_add_u32 s54, s54, 9437184
    v_bfe_u32 v228, v1, 4, 1
    v_lshlrev_b32 v228, 14, v228
    v_lshrrev_b32 v229, 5, v1
    v_lshl_add_u32 v228, v229, 8, v228
    v_and_b32 v229, 15, v1
    v_lshl_add_u32 v228, v229, 4, v228
    s_waitcnt lgkmcnt(0)
    s_barrier
    ds_read_b32 v232, v8 offset:11268
    ds_read_b32 v233, v9 offset:11268
    ds_read_b32 v234, v10 offset:11268
    ds_read_b128 v[160:163], v8 offset:8192
    ds_read_b128 v[164:167], v8 offset:9216
    ds_read_b128 v[168:171], v8 offset:10240
    ds_read_b128 v[172:175], v8 offset:11264
    ds_read_b128 v[176:179], v9 offset:4096
    ds_read_b128 v[180:183], v9 offset:5120
    ds_read_b128 v[184:187], v9 offset:6144
    ds_read_b128 v[188:191], v9 offset:7168
    ds_read_b128 v[192:195], v10 offset:0
    ds_read_b128 v[196:199], v10 offset:1024
    ds_read_b128 v[200:203], v10 offset:2048
    ds_read_b128 v[204:207], v10 offset:3072
    s_waitcnt lgkmcnt(12)
    v_or3_b32 v232, v232, v233, v234
    v_or_b32 v232, v232, v226
    s_nop 0
    v_readlane_b32 s55, v232, 32
    s_nop 1
    s_cmp_gt_u32 s55, s53
    s_cbranch_scc1 L_att_fallback
    s_waitcnt lgkmcnt(11)
    v_pk_add_f32 v[96:97], v[96:97], v[160:161]
    v_pk_add_f32 v[98:99], v[98:99], v[162:163]
    s_waitcnt lgkmcnt(10)
    v_pk_add_f32 v[100:101], v[100:101], v[164:165]
    v_pk_add_f32 v[102:103], v[102:103], v[166:167]
    s_waitcnt lgkmcnt(9)
    v_pk_add_f32 v[104:105], v[104:105], v[168:169]
    v_pk_add_f32 v[106:107], v[106:107], v[170:171]
    s_waitcnt lgkmcnt(8)
    v_pk_add_f32 v[108:109], v[108:109], v[172:173]
    v_pk_add_f32 v[110:111], v[110:111], v[174:175]
    s_waitcnt lgkmcnt(7)
    v_pk_add_f32 v[96:97], v[96:97], v[176:177]
    v_pk_add_f32 v[98:99], v[98:99], v[178:179]
    s_waitcnt lgkmcnt(6)
    v_pk_add_f32 v[100:101], v[100:101], v[180:181]
    v_pk_add_f32 v[102:103], v[102:103], v[182:183]
    s_waitcnt lgkmcnt(5)
    v_pk_add_f32 v[104:105], v[104:105], v[184:185]
    v_pk_add_f32 v[106:107], v[106:107], v[186:187]
    s_waitcnt lgkmcnt(4)
    v_pk_add_f32 v[108:109], v[108:109], v[188:189]
    v_pk_add_f32 v[110:111], v[110:111], v[190:191]
    s_waitcnt lgkmcnt(3)
    v_pk_add_f32 v[96:97], v[96:97], v[192:193]
    v_pk_add_f32 v[98:99], v[98:99], v[194:195]
    s_waitcnt lgkmcnt(2)
    v_pk_add_f32 v[100:101], v[100:101], v[196:197]
    v_pk_add_f32 v[102:103], v[102:103], v[198:199]
    s_waitcnt lgkmcnt(1)
    v_pk_add_f32 v[104:105], v[104:105], v[200:201]
    v_pk_add_f32 v[106:107], v[106:107], v[202:203]
    s_waitcnt lgkmcnt(0)
    v_pk_add_f32 v[108:109], v[108:109], v[204:205]
    v_pk_add_f32 v[110:111], v[110:111], v[206:207]
    v_mov_b32 v224, v108
    v_mov_b32 v225, v108
    s_nop 1
    v_permlane32_swap_b32 v224, v225
    v_rcp_f32 v224, v225
    s_nop 0
    v_pk_mul_f32 v[96:97], v[96:97], v[224:225] op_sel_hi:[1,0]
    v_pk_mul_f32 v[98:99], v[98:99], v[224:225] op_sel_hi:[1,0]
    v_pk_mul_f32 v[100:101], v[100:101], v[224:225] op_sel_hi:[1,0]
    v_pk_mul_f32 v[102:103], v[102:103], v[224:225] op_sel_hi:[1,0]
    v_cvt_pk_bf16_f32 v144, v96, v97
    v_cvt_pk_bf16_f32 v145, v98, v99
    v_cvt_pk_bf16_f32 v146, v100, v101
    v_cvt_pk_bf16_f32 v147, v102, v103
    buffer_store_dwordx4 v[144:147], v228, s[36:39], s54 offen offset:0 sc1
    v_pk_mul_f32 v[104:105], v[104:105], v[224:225] op_sel_hi:[1,0]
    v_pk_mul_f32 v[106:107], v[106:107], v[224:225] op_sel_hi:[1,0]
    v_pk_mul_f32 v[108:109], v[108:109], v[224:225] op_sel_hi:[1,0]
    v_pk_mul_f32 v[110:111], v[110:111], v[224:225] op_sel_hi:[1,0]
    v_cvt_pk_bf16_f32 v148, v104, v105
    v_cvt_pk_bf16_f32 v149, v106, v107
    v_cvt_pk_bf16_f32 v150, v108, v109
    v_cvt_pk_bf16_f32 v151, v110, v111
    v_cndmask_b32 v150, v150, 0, s[64:65]
    v_cndmask_b32 v151, v151, 0, s[64:65]
    buffer_store_dwordx4 v[148:151], v228, s[36:39], s54 offen offset:512 sc1
    s_lshl_b32 s50, s44, 2
    s_add_u32 s50, s50, s40
    s_lshl_b32 s49, s50, 5
    s_add_u32 s49, s49, s43
    s_lshl_b32 s49, s49, 2
    s_add_u32 s49, s49, 8192
    v_and_b32 v5, 15, v1
    v_lshrrev_b32 v6, 4, v1
    v_bfe_u32 v7, v1, 2, 2
    v_and_b32 v8, 3, v1
    v_and_b32 v9, 1, v6
    v_lshrrev_b32 v10, 1, v7
    v_lshl_add_u32 v10, v9, 1, v10
    v_lshrrev_b32 v11, 1, v6
    v_lshl_add_u32 v11, v11, 2, v9
    v_lshl_add_u32 v11, v11, 2, v7
    v_lshlrev_b32 v11, 7, v11
    v_lshl_add_u32 v11, v8, 3, v11
    v_mov_b32 v7, 1024
    v_cmp_eq_u32 vcc, 3, v6
    s_nop 1
    v_cndmask_b32 v7, v7, 0, vcc
    v_xor_b32 v8, 0, v10
    v_lshl_add_u32 v232, v8, 5, v11
    v_add_u32 v233, v232, v7
    v_xor_b32 v8, 1, v10
    v_lshl_add_u32 v234, v8, 5, v11
    v_add_u32 v235, v234, v7
    v_xor_b32 v8, 2, v10
    v_lshl_add_u32 v236, v8, 5, v11
    v_add_u32 v237, v236, v7
    v_xor_b32 v8, 3, v10
    v_lshl_add_u32 v238, v8, 5, v11
    v_add_u32 v239, v238, v7
    s_lshr_b32 s53, s47, 1
    s_lshl_b32 s53, s53, 7
    s_add_u32 s53, s53, 8192
    v_lshl_add_u32 v4, v5, 2, s53
    s_lshl_b32 s53, s47, 14
    s_add_u32 s53, s53, 9437184
    ds_read_b64_tr_b16 a[8:9], v232 offset:0
    ds_read_b64_tr_b16 a[10:11], v233 offset:0
    ds_read_b64_tr_b16 a[12:13], v234 offset:0
    ds_read_b64_tr_b16 a[14:15], v235 offset:0
    ds_read_b64_tr_b16 a[24:25], v236 offset:0
    ds_read_b64_tr_b16 a[26:27], v237 offset:0
    ds_read_b64_tr_b16 a[28:29], v238 offset:0
    ds_read_b64_tr_b16 a[30:31], v239 offset:0
    ds_read_b64_tr_b16 a[40:41], v236 offset:3584
    ds_read_b64_tr_b16 a[42:43], v237 offset:3584
    ds_read_b64_tr_b16 a[44:45], v238 offset:3584
    ds_read_b64_tr_b16 a[46:47], v239 offset:3584
    ds_read_b64_tr_b16 a[56:57], v232 offset:3584
    ds_read_b64_tr_b16 a[58:59], v233 offset:3584
    ds_read_b64_tr_b16 a[60:61], v234 offset:3584
    ds_read_b64_tr_b16 a[62:63], v235 offset:3584
    ds_read_b64_tr_b16 a[72:73], v232 offset:7168
    ds_read_b64_tr_b16 a[74:75], v233 offset:7168
    ds_read_b64_tr_b16 a[76:77], v234 offset:7168
    ds_read_b64_tr_b16 a[78:79], v235 offset:7168
    ds_read_b64_tr_b16 a[88:89], v236 offset:7168
    ds_read_b64_tr_b16 a[90:91], v237 offset:7168
    ds_read_b64_tr_b16 a[92:93], v238 offset:7168
    ds_read_b64_tr_b16 a[94:95], v239 offset:7168
    ds_read_b64_tr_b16 a[104:105], v236 offset:10752
    ds_read_b64_tr_b16 a[106:107], v237 offset:10752
    ds_read_b64_tr_b16 a[108:109], v238 offset:10752
    ds_read_b64_tr_b16 a[110:111], v239 offset:10752
    ds_read_b64_tr_b16 a[120:121], v232 offset:10752
    ds_read_b64_tr_b16 a[122:123], v233 offset:10752
    ds_read_b64_tr_b16 a[124:125], v234 offset:10752
    ds_read_b64_tr_b16 a[126:127], v235 offset:10752
    ds_read_b64_tr_b16 a[136:137], v232 offset:14336
    ds_read_b64_tr_b16 a[138:139], v233 offset:14336
    ds_read_b64_tr_b16 a[140:141], v234 offset:14336
    ds_read_b64_tr_b16 a[142:143], v235 offset:14336
    ds_read_b64_tr_b16 a[152:153], v236 offset:14336
    ds_read_b64_tr_b16 a[154:155], v237 offset:14336
    ds_read_b64_tr_b16 a[156:157], v238 offset:14336
    ds_read_b64_tr_b16 a[158:159], v239 offset:14336
    ds_read_b64_tr_b16 a[168:169], v236 offset:17920
    ds_read_b64_tr_b16 a[170:171], v237 offset:17920
    ds_read_b64_tr_b16 a[172:173], v238 offset:17920
    ds_read_b64_tr_b16 a[174:175], v239 offset:17920
    ds_read_b64_tr_b16 a[184:185], v232 offset:17920
    ds_read_b64_tr_b16 a[186:187], v233 offset:17920
    ds_read_b64_tr_b16 a[188:189], v234 offset:17920
    ds_read_b64_tr_b16 a[190:191], v235 offset:17920
    v_mov_b32 v224, s45
    v_mov_b32 v225, 0
    s_waitcnt vmcnt(0)
    s_mov_b64 exec, 1
    buffer_store_dword v224, v225, s[36:39], s49 offen sc1
    s_mov_b64 exec, -1
    s_branch L_att_done
L_att_fallback:
    s_waitcnt vmcnt(0) lgkmcnt(0)
    s_barrier
    s_mov_b32 s53, 1
    s_mov_b64 exec, s[64:65]
    s_bitcmp1_b32 s43, 0
    s_cbranch_scc1 L_odd_20
    v_mov_b32 v22, 0
    v_mov_b32 v30, 0
    v_mov_b32 v38, 0
    v_mov_b32 v46, 0
    s_branch L_pd_21
L_odd_20:
    v_mov_b32 v20, 0
    v_mov_b32 v28, 0
    v_mov_b32 v36, 0
    v_mov_b32 v44, 0
L_pd_21:
    s_mov_b64 exec, -1
    v_mov_b32 v232, 0xff800000
    v_mov_b32 v233, 0xff800000
    v_mov_b32 v234, 0xff800000
    v_mov_b32 v235, 0xff800000
    s_mov_b32 s52, s50
    s_mov_b32 s51, 0
L_mx_22:
    buffer_load_dwordx4 v[160:163], v2, s[36:39], s52 offen offset:0 sc1
    buffer_load_dwordx4 v[164:167], v2, s[36:39], s52 offen offset:1024 sc1
    s_waitcnt vmcnt(0)
    v_mfma_f32_32x32x16_bf16 v[112:127], v[160:163], v[16:19], 0
    v_mfma_f32_32x32x16_bf16 v[112:127], v[164:167], v[20:23], v[112:127]
    s_nop 11
    v_max3_f32 v232, v232, v112, v113
    v_max3_f32 v232, v232, v114, v115
    v_max3_f32 v232, v232, v116, v117
    v_max3_f32 v232, v232, v118, v119
    v_max3_f32 v232, v232, v120, v121
    v_max3_f32 v232, v232, v122, v123
    v_max3_f32 v232, v232, v124, v125
    v_max3_f32 v232, v232, v126, v127
    v_mfma_f32_32x32x16_bf16 v[112:127], v[160:163], v[24:27], 0
    v_mfma_f32_32x32x16_bf16 v[112:127], v[164:167], v[28:31], v[112:127]
    s_nop 11
    v_max3_f32 v233, v233, v112, v113
    v_max3_f32 v233, v233, v114, v115
    v_max3_f32 v233, v233, v116, v117
    v_max3_f32 v233, v233, v118, v119
    v_max3_f32 v233, v233, v120, v121
    v_max3_f32 v233, v233, v122, v123
    v_max3_f32 v233, v233, v124, v125
    v_max3_f32 v233, v233, v126, v127
    v_mfma_f32_32x32x16_bf16 v[112:127], v[160:163], v[32:35], 0
    v_mfma_f32_32x32x16_bf16 v[112:127], v[164:167], v[36:39], v[112:127]
    s_nop 11
    v_max3_f32 v234, v234, v112, v113
    v_max3_f32 v234, v234, v114, v115
    v_max3_f32 v234, v234, v116, v117
    v_max3_f32 v234, v234, v118, v119
    v_max3_f32 v234, v234, v120, v121
    v_max3_f32 v234, v234, v122, v123
    v_max3_f32 v234, v234, v124, v125
    v_max3_f32 v234, v234, v126, v127
    v_mfma_f32_32x32x16_bf16 v[112:127], v[160:163], v[40:43], 0
    v_mfma_f32_32x32x16_bf16 v[112:127], v[164:167], v[44:47], v[112:127]
    s_nop 11
    v_max3_f32 v235, v235, v112, v113
    v_max3_f32 v235, v235, v114, v115
    v_max3_f32 v235, v235, v116, v117
    v_max3_f32 v235, v235, v118, v119
    v_max3_f32 v235, v235, v120, v121
    v_max3_f32 v235, v235, v122, v123
    v_max3_f32 v235, v235, v124, v125
    v_max3_f32 v235, v235, v126, v127
    s_add_u32 s52, s52, 4096
    s_add_u32 s51, s51, 1
    s_cmp_lt_u32 s51, 16
    s_cbranch_scc1 L_mx_22
    ds_write_b128 v5, v[232:235]
    s_waitcnt lgkmcnt(0)
    s_barrier
    ds_read_b128 v[112:115], v8
    s_waitcnt lgkmcnt(0)
    v_max_f32 v232, v232, v115
    v_max_f32 v233, v233, v112
    v_max_f32 v234, v234, v113
    v_max_f32 v235, v235, v114
    ds_read_b128 v[112:115], v9
    s_waitcnt lgkmcnt(0)
    v_max_f32 v232, v232, v114
    v_max_f32 v233, v233, v115
    v_max_f32 v234, v234, v112
    v_max_f32 v235, v235, v113
    ds_read_b128 v[112:115], v10
    s_waitcnt lgkmcnt(0)
    v_max_f32 v232, v232, v113
    v_max_f32 v233, v233, v114
    v_max_f32 v234, v234, v115
    v_max_f32 v235, v235, v112
    v_mov_b32 v224, v232
    v_mov_b32 v225, v232
    s_nop 1
    v_permlane32_swap_b32 v224, v225
    v_max_f32 v224, v224, v225
    v_sub_f32 v224, 0, v224
    v_and_b32 v225, 0xffff0000, v224
    v_sub_f32 v224, v224, v225
    v_and_b32 v226, 0xffff0000, v224
    v_sub_f32 v224, v224, v226
    v_lshrrev_b32 v225, 16, v225
    v_or_b32 v128, v225, v226
    v_lshrrev_b32 v129, 16, v224
    v_mov_b32 v224, v233
    v_mov_b32 v225, v233
    s_nop 1
    v_permlane32_swap_b32 v224, v225
    v_max_f32 v224, v224, v225
    v_sub_f32 v224, 0, v224
    v_and_b32 v225, 0xffff0000, v224
    v_sub_f32 v224, v224, v225
    v_and_b32 v226, 0xffff0000, v224
    v_sub_f32 v224, v224, v226
    v_lshrrev_b32 v225, 16, v225
    v_or_b32 v130, v225, v226
    v_lshrrev_b32 v131, 16, v224
    v_mov_b32 v224, v234
    v_mov_b32 v225, v234
    s_nop 1
    v_permlane32_swap_b32 v224, v225
    v_max_f32 v224, v224, v225
    v_sub_f32 v224, 0, v224
    v_and_b32 v225, 0xffff0000, v224
    v_sub_f32 v224, v224, v225
    v_and_b32 v226, 0xffff0000, v224
    v_sub_f32 v224, v224, v226
    v_lshrrev_b32 v225, 16, v225
    v_or_b32 v132, v225, v226
    v_lshrrev_b32 v133, 16, v224
    v_mov_b32 v224, v235
    v_mov_b32 v225, v235
    s_nop 1
    v_permlane32_swap_b32 v224, v225
    v_max_f32 v224, v224, v225
    v_sub_f32 v224, 0, v224
    v_and_b32 v225, 0xffff0000, v224
    v_sub_f32 v224, v224, v225
    v_and_b32 v226, 0xffff0000, v224
    v_sub_f32 v224, v224, v226
    v_lshrrev_b32 v225, 16, v225
    v_or_b32 v134, v225, v226
    v_lshrrev_b32 v135, 16, v224
    s_mov_b64 exec, s[64:65]
    s_bitcmp1_b32 s43, 0
    s_cbranch_scc1 L_odd_23
    v_mov_b32 v22, v128
    v_mov_b32 v23, v129
    v_mov_b32 v30, v130
    v_mov_b32 v31, v131
    v_mov_b32 v38, v132
    v_mov_b32 v39, v133
    v_mov_b32 v46, v134
    v_mov_b32 v47, v135
    s_branch L_pd_24
L_odd_23:
    v_mov_b32 v20, v128
    v_mov_b32 v21, v129
    v_mov_b32 v28, v130
    v_mov_b32 v29, v131
    v_mov_b32 v36, v132
    v_mov_b32 v37, v133
    v_mov_b32 v44, v134
    v_mov_b32 v45, v135
L_pd_24:
    s_mov_b64 exec, -1
    s_mov_b32 s52, s50
    buffer_load_dwordx4 v[160:163], v2, s[36:39], s52 offen offset:0 sc1
    buffer_load_dwordx4 v[164:167], v2, s[36:39], s52 offen offset:1024 sc1
    buffer_load_dwordx4 v[168:171], v2, s[36:39], s52 offen offset:2048 sc1
    buffer_load_dwordx4 v[172:175], v2, s[36:39], s52 offen offset:3072 sc1
    s_add_u32 s52, s52, 4096
    buffer_load_dwordx4 v[176:179], v2, s[36:39], s52 offen offset:0 sc1
    buffer_load_dwordx4 v[180:183], v2, s[36:39], s52 offen offset:1024 sc1
    buffer_load_dwordx4 v[184:187], v2, s[36:39], s52 offen offset:2048 sc1
    buffer_load_dwordx4 v[188:191], v2, s[36:39], s52 offen offset:3072 sc1
    s_add_u32 s52, s52, 4096
    v_mov_b32 v48, 0
    v_mov_b32 v49, 0
    v_mov_b32 v50, 0
    v_mov_b32 v51, 0
    v_mov_b32 v52, 0
    v_mov_b32 v53, 0
    v_mov_b32 v54, 0
    v_mov_b32 v55, 0
    v_mov_b32 v56, 0
    v_mov_b32 v57, 0
    v_mov_b32 v58, 0
    v_mov_b32 v59, 0
    v_mov_b32 v60, 0
    v_mov_b32 v61, 0
    v_mov_b32 v62, 0
    v_mov_b32 v63, 0
    v_mov_b32 v64, 0
    v_mov_b32 v65, 0
    v_mov_b32 v66, 0
    v_mov_b32 v67, 0
    v_mov_b32 v68, 0
    v_mov_b32 v69, 0
    v_mov_b32 v70, 0
    v_mov_b32 v71, 0
    v_mov_b32 v72, 0
    v_mov_b32 v73, 0
    v_mov_b32 v74, 0
    v_mov_b32 v75, 0
    v_mov_b32 v76, 0
    v_mov_b32 v77, 0
    v_mov_b32 v78, 0
    v_mov_b32 v79, 0
    v_mov_b32 v80, 0
    v_mov_b32 v81, 0
    v_mov_b32 v82, 0
    v_mov_b32 v83, 0
    v_mov_b32 v84, 0
    v_mov_b32 v85, 0
    v_mov_b32 v86, 0
    v_mov_b32 v87, 0
    v_mov_b32 v88, 0
    v_mov_b32 v89, 0
    v_mov_b32 v90, 0
    v_mov_b32 v91, 0
    v_mov_b32 v92, 0
    v_mov_b32 v93, 0
    v_mov_b32 v94, 0
    v_mov_b32 v95, 0
    v_mov_b32 v96, 0
    v_mov_b32 v97, 0
    v_mov_b32 v98, 0
    v_mov_b32 v99, 0
    v_mov_b32 v100, 0
    v_mov_b32 v101, 0
    v_mov_b32 v102, 0
    v_mov_b32 v103, 0
    v_mov_b32 v104, 0
    v_mov_b32 v105, 0
    v_mov_b32 v106, 0
    v_mov_b32 v107, 0
    v_mov_b32 v108, 0
    v_mov_b32 v109, 0
    v_mov_b32 v110, 0
    v_mov_b32 v111, 0
    s_waitcnt vmcnt(0) lgkmcnt(0)
    s_branch L_att_main
L_att_done:
    s_cmp_eq_u32 s42, 7
    s_cbranch_scc1 L_p3_idle
    s_waitcnt lgkmcnt(0)
    s_barrier
    buffer_load_dword v7, v4, s[36:39], 0 offen sc1
    v_lshlrev_b32 v80, 16, v240
    v_and_b32 v81, 0xffff0000, v240
    v_lshlrev_b32 v82, 16, v241
    v_and_b32 v83, 0xffff0000, v241
    v_lshlrev_b32 v84, 16, v242
    v_and_b32 v85, 0xffff0000, v242
    v_lshlrev_b32 v86, 16, v243
    v_and_b32 v87, 0xffff0000, v243
    v_lshlrev_b32 v88, 16, v244
    v_and_b32 v89, 0xffff0000, v244
    v_lshlrev_b32 v90, 16, v245
    v_and_b32 v91, 0xffff0000, v245
    v_lshlrev_b32 v92, 16, v246
    v_and_b32 v93, 0xffff0000, v246
    v_lshlrev_b32 v94, 16, v247
    v_and_b32 v95, 0xffff0000, v247
    ds_read_b64_tr_b16 a[200:201], v232 offset:21504
    ds_read_b64_tr_b16 a[202:203], v233 offset:21504
    ds_read_b64_tr_b16 a[204:205], v234 offset:21504
    ds_read_b64_tr_b16 a[206:207], v235 offset:21504
    ds_read_b64_tr_b16 a[216:217], v236 offset:21504
    ds_read_b64_tr_b16 a[218:219], v237 offset:21504
    ds_read_b64_tr_b16 a[220:221], v238 offset:21504
    ds_read_b64_tr_b16 a[222:223], v239 offset:21504
    ds_read_b64_tr_b16 a[232:233], v236 offset:25088
    ds_read_b64_tr_b16 a[234:235], v237 offset:25088
    ds_read_b64_tr_b16 a[236:237], v238 offset:25088
    ds_read_b64_tr_b16 a[238:239], v239 offset:25088
    ds_read_b64_tr_b16 a[248:249], v232 offset:25088
    ds_read_b64_tr_b16 a[250:251], v233 offset:25088
    ds_read_b64_tr_b16 a[252:253], v234 offset:25088
    ds_read_b64_tr_b16 a[254:255], v235 offset:25088
    ds_read_b64_tr_b16 v[96:97], v232 offset:28672
    ds_read_b64_tr_b16 v[98:99], v233 offset:28672
    ds_read_b64_tr_b16 v[100:101], v234 offset:28672
    ds_read_b64_tr_b16 v[102:103], v235 offset:28672
    ds_read_b64_tr_b16 v[104:105], v236 offset:28672
    ds_read_b64_tr_b16 v[106:107], v237 offset:28672
    ds_read_b64_tr_b16 v[108:109], v238 offset:28672
    ds_read_b64_tr_b16 v[110:111], v239 offset:28672
    ds_read_b64_tr_b16 v[112:113], v236 offset:32256
    ds_read_b64_tr_b16 v[114:115], v237 offset:32256
    ds_read_b64_tr_b16 v[116:117], v238 offset:32256
    ds_read_b64_tr_b16 v[118:119], v239 offset:32256
    ds_read_b64_tr_b16 v[120:121], v232 offset:32256
    ds_read_b64_tr_b16 v[122:123], v233 offset:32256
    ds_read_b64_tr_b16 v[124:125], v234 offset:32256
    ds_read_b64_tr_b16 v[126:127], v235 offset:32256
    ds_read_b64_tr_b16 v[128:129], v232 offset:35840
    ds_read_b64_tr_b16 v[130:131], v233 offset:35840
    ds_read_b64_tr_b16 v[132:133], v234 offset:35840
    ds_read_b64_tr_b16 v[134:135], v235 offset:35840
    ds_read_b64_tr_b16 v[136:137], v236 offset:35840
    ds_read_b64_tr_b16 v[138:139], v237 offset:35840
    ds_read_b64_tr_b16 v[140:141], v238 offset:35840
    ds_read_b64_tr_b16 v[142:143], v239 offset:35840
    s_mov_b32 s48, 0
    s_mov_b32 s57, 0
    s_branch L_pollc_26
L_poll_25:
    s_cmp_lg_u32 s57, 0
    s_cbranch_scc1 L_pollo_28
    s_mov_b32 s57, 1
    s_mul_i32 s63, s69, 11
    s_add_u32 s62, s63, s68
    s_add_u32 s62, s62, 860160
    s_add_u32 m0, s63, 114688
    s_nop 0
    buffer_load_dwordx4 v2, s[36:39], s62 offen offset:0 sc1 lds
    buffer_load_dwordx4 v2, s[36:39], s62 offen offset:1024 sc1 lds
    buffer_load_dwordx4 v2, s[36:39], s62 offen offset:2048 sc1 lds
    buffer_load_dwordx4 v2, s[36:39], s62 offen offset:3072 sc1 lds
    s_add_u32 m0, s63, 118784
    s_add_u32 s62, s62, 4096
    buffer_load_dwordx4 v2, s[36:39], s62 offen offset:0 sc1 lds
    buffer_load_dwordx4 v2, s[36:39], s62 offen offset:1024 sc1 lds
    buffer_load_dwordx4 v2, s[36:39], s62 offen offset:2048 sc1 lds
    buffer_load_dwordx4 v2, s[36:39], s62 offen offset:3072 sc1 lds
    s_add_u32 m0, s63, 122880
    s_add_u32 s62, s62, 4096
    buffer_load_dwordx4 v2, s[36:39], s62 offen offset:0 sc1 lds
    buffer_load_dwordx4 v2, s[36:39], s62 offen offset:1024 sc1 lds
    buffer_load_dwordx4 v2, s[36:39], s62 offen offset:2048 sc1 lds
L_pollo_28:
    buffer_load_dword v7, v4, s[36:39], 0 offen sc1
L_pollc_26:
    s_add_u32 s48, s48, 1
    s_cmp_gt_u32 s48, 0x80000
    s_waitcnt vmcnt(0)
    s_cbranch_scc1 L_polld_27
    v_cmp_ne_u32 vcc, s45, v7
    s_nop 1
    s_cbranch_vccnz L_poll_25
L_polld_27:
    buffer_load_dwordx4 v[16:19], v2, s[36:39], s53 offen offset:0 sc1
    ds_read_b64_tr_b16 v[144:145], v236 offset:39424
    ds_read_b64_tr_b16 v[146:147], v237 offset:39424
    ds_read_b64_tr_b16 v[148:149], v238 offset:39424
    ds_read_b64_tr_b16 v[150:151], v239 offset:39424
    ds_read_b64_tr_b16 v[152:153], v232 offset:39424
    buffer_load_dwordx4 v[20:23], v2, s[36:39], s53 offen offset:1024 sc1
    ds_read_b64_tr_b16 v[154:155], v233 offset:39424
    ds_read_b64_tr_b16 v[156:157], v234 offset:39424
    ds_read_b64_tr_b16 v[158:159], v235 offset:39424
    ds_read_b64_tr_b16 v[160:161], v232 offset:43008
    buffer_load_dwordx4 v[24:27], v2, s[36:39], s53 offen offset:2048 sc1
    ds_read_b64_tr_b16 v[162:163], v233 offset:43008
    ds_read_b64_tr_b16 v[164:165], v234 offset:43008
    ds_read_b64_tr_b16 v[166:167], v235 offset:43008
    ds_read_b64_tr_b16 v[168:169], v236 offset:43008
    ds_read_b64_tr_b16 v[170:171], v237 offset:43008
    buffer_load_dwordx4 v[28:31], v2, s[36:39], s53 offen offset:3072 sc1
    ds_read_b64_tr_b16 v[172:173], v238 offset:43008
    ds_read_b64_tr_b16 v[174:175], v239 offset:43008
    ds_read_b64_tr_b16 v[176:177], v236 offset:46592
    ds_read_b64_tr_b16 v[178:179], v237 offset:46592
    s_add_u32 s53, s53, 4096
    buffer_load_dwordx4 v[32:35], v2, s[36:39], s53 offen offset:0 sc1
    ds_read_b64_tr_b16 v[180:181], v238 offset:46592
    ds_read_b64_tr_b16 v[182:183], v239 offset:46592
    ds_read_b64_tr_b16 v[184:185], v232 offset:46592
    ds_read_b64_tr_b16 v[186:187], v233 offset:46592
    ds_read_b64_tr_b16 v[188:189], v234 offset:46592
    buffer_load_dwordx4 v[36:39], v2, s[36:39], s53 offen offset:1024 sc1
    ds_read_b64_tr_b16 v[190:191], v235 offset:46592
    ds_read_b64_tr_b16 v[192:193], v232 offset:50176
    ds_read_b64_tr_b16 v[194:195], v233 offset:50176
    ds_read_b64_tr_b16 v[196:197], v234 offset:50176
    buffer_load_dwordx4 v[40:43], v2, s[36:39], s53 offen offset:2048 sc1
    ds_read_b64_tr_b16 v[198:199], v235 offset:50176
    ds_read_b64_tr_b16 v[200:201], v236 offset:50176
    ds_read_b64_tr_b16 v[202:203], v237 offset:50176
    ds_read_b64_tr_b16 v[204:205], v238 offset:50176
    ds_read_b64_tr_b16 v[206:207], v239 offset:50176
    buffer_load_dwordx4 v[44:47], v2, s[36:39], s53 offen offset:3072 sc1
    ds_read_b64_tr_b16 v[208:209], v236 offset:53760
    ds_read_b64_tr_b16 v[210:211], v237 offset:53760
    ds_read_b64_tr_b16 v[212:213], v238 offset:53760
    ds_read_b64_tr_b16 v[214:215], v239 offset:53760
    s_add_u32 s53, s53, 4096
    buffer_load_dwordx4 v[48:51], v2, s[36:39], s53 offen offset:0 sc1
    ds_read_b64_tr_b16 v[216:217], v232 offset:53760
    ds_read_b64_tr_b16 v[218:219], v233 offset:53760
    ds_read_b64_tr_b16 v[220:221], v234 offset:53760
    ds_read_b64_tr_b16 v[222:223], v235 offset:53760
    s_mul_i32 s55, s47, 14336
    s_lshl_b32 s54, s42, 11
    s_add_u32 s55, s55, s54
    s_add_u32 s55, s55, 11534336
    s_lshl_b32 s56, s47, 10
    s_lshl_b32 s54, s42, 7
    s_add_u32 s56, s56, s54
    s_add_u32 s56, s56, 524288
    v_lshlrev_b32 v7, 3, v5
    v_lshl_add_u32 v7, v9, 2, v7
    s_lshl_b32 s49, s47, 5
    s_add_u32 s49, s49, s42
    s_lshl_b32 s49, s49, 2
    s_add_u32 s49, s49, 229376
    s_waitcnt vmcnt(8)
    v_mfma_f32_16x16x32_bf16 v[80:83], a[8:11], v[16:19], v[80:83]
    v_mfma_f32_16x16x32_bf16 v[84:87], a[12:15], v[16:19], v[84:87]
    v_mfma_f32_16x16x32_bf16 v[88:91], a[24:27], v[16:19], v[88:91]
    v_mfma_f32_16x16x32_bf16 v[92:95], a[28:31], v[16:19], v[92:95]
    buffer_load_dwordx4 v[52:55], v2, s[36:39], s53 offen offset:1024 sc1
    s_waitcnt vmcnt(8)
    v_mfma_f32_16x16x32_bf16 v[80:83], a[40:43], v[20:23], v[80:83]
    v_mfma_f32_16x16x32_bf16 v[84:87], a[44:47], v[20:23], v[84:87]
    v_mfma_f32_16x16x32_bf16 v[88:91], a[56:59], v[20:23], v[88:91]
    v_mfma_f32_16x16x32_bf16 v[92:95], a[60:63], v[20:23], v[92:95]
    buffer_load_dwordx4 v[56:59], v2, s[36:39], s53 offen offset:2048 sc1
    s_waitcnt vmcnt(8)
    v_mfma_f32_16x16x32_bf16 v[80:83], a[72:75], v[24:27], v[80:83]
    v_mfma_f32_16x16x32_bf16 v[84:87], a[76:79], v[24:27], v[84:87]
    v_mfma_f32_16x16x32_bf16 v[88:91], a[88:91], v[24:27], v[88:91]
    v_mfma_f32_16x16x32_bf16 v[92:95], a[92:95], v[24:27], v[92:95]
    buffer_load_dwordx4 v[60:63], v2, s[36:39], s53 offen offset:3072 sc1
    s_waitcnt vmcnt(8)
    v_mfma_f32_16x16x32_bf16 v[80:83], a[104:107], v[28:31], v[80:83]
    v_mfma_f32_16x16x32_bf16 v[84:87], a[108:111], v[28:31], v[84:87]
    v_mfma_f32_16x16x32_bf16 v[88:91], a[120:123], v[28:31], v[88:91]
    v_mfma_f32_16x16x32_bf16 v[92:95], a[124:127], v[28:31], v[92:95]
    s_add_u32 s53, s53, 4096
    buffer_load_dwordx4 v[64:67], v2, s[36:39], s53 offen offset:0 sc1
    s_waitcnt vmcnt(8)
    v_mfma_f32_16x16x32_bf16 v[80:83], a[136:139], v[32:35], v[80:83]
    v_mfma_f32_16x16x32_bf16 v[84:87], a[140:143], v[32:35], v[84:87]
    v_mfma_f32_16x16x32_bf16 v[88:91], a[152:155], v[32:35], v[88:91]
    v_mfma_f32_16x16x32_bf16 v[92:95], a[156:159], v[32:35], v[92:95]
    buffer_load_dwordx4 v[68:71], v2, s[36:39], s53 offen offset:1024 sc1
    s_waitcnt vmcnt(8)
    v_mfma_f32_16x16x32_bf16 v[80:83], a[168:171], v[36:39], v[80:83]
    v_mfma_f32_16x16x32_bf16 v[84:87], a[172:175], v[36:39], v[84:87]
    v_mfma_f32_16x16x32_bf16 v[88:91], a[184:187], v[36:39], v[88:91]
    v_mfma_f32_16x16x32_bf16 v[92:95], a[188:191], v[36:39], v[92:95]
    buffer_load_dwordx4 v[72:75], v2, s[36:39], s53 offen offset:2048 sc1
    s_waitcnt vmcnt(8) lgkmcnt(15)
    v_mfma_f32_16x16x32_bf16 v[80:83], a[200:203], v[40:43], v[80:83]
    v_mfma_f32_16x16x32_bf16 v[84:87], a[204:207], v[40:43], v[84:87]
    v_mfma_f32_16x16x32_bf16 v[88:91], a[216:219], v[40:43], v[88:91]
    v_mfma_f32_16x16x32_bf16 v[92:95], a[220:223], v[40:43], v[92:95]
    buffer_load_dwordx4 v[76:79], v2, s[36:39], s53 offen offset:3072 sc1
    s_waitcnt vmcnt(8)
    v_mfma_f32_16x16x32_bf16 v[80:83], a[232:235], v[44:47], v[80:83]
    v_mfma_f32_16x16x32_bf16 v[84:87], a[236:239], v[44:47], v[84:87]
    v_mfma_f32_16x16x32_bf16 v[88:91], a[248:251], v[44:47], v[88:91]
    v_mfma_f32_16x16x32_bf16 v[92:95], a[252:255], v[44:47], v[92:95]
    s_waitcnt vmcnt(7)
    v_mfma_f32_16x16x32_bf16 v[80:83], v[96:99], v[48:51], v[80:83]
    v_mfma_f32_16x16x32_bf16 v[84:87], v[100:103], v[48:51], v[84:87]
    v_mfma_f32_16x16x32_bf16 v[88:91], v[104:107], v[48:51], v[88:91]
    v_mfma_f32_16x16x32_bf16 v[92:95], v[108:111], v[48:51], v[92:95]
    s_waitcnt vmcnt(6)
    v_mfma_f32_16x16x32_bf16 v[80:83], v[112:115], v[52:55], v[80:83]
    v_mfma_f32_16x16x32_bf16 v[84:87], v[116:119], v[52:55], v[84:87]
    v_mfma_f32_16x16x32_bf16 v[88:91], v[120:123], v[52:55], v[88:91]
    v_mfma_f32_16x16x32_bf16 v[92:95], v[124:127], v[52:55], v[92:95]
    s_waitcnt vmcnt(5)
    v_mfma_f32_16x16x32_bf16 v[80:83], v[128:131], v[56:59], v[80:83]
    v_mfma_f32_16x16x32_bf16 v[84:87], v[132:135], v[56:59], v[84:87]
    v_mfma_f32_16x16x32_bf16 v[88:91], v[136:139], v[56:59], v[88:91]
    v_mfma_f32_16x16x32_bf16 v[92:95], v[140:143], v[56:59], v[92:95]
    s_waitcnt vmcnt(4)
    v_mfma_f32_16x16x32_bf16 v[80:83], v[144:147], v[60:63], v[80:83]
    v_mfma_f32_16x16x32_bf16 v[84:87], v[148:151], v[60:63], v[84:87]
    v_mfma_f32_16x16x32_bf16 v[88:91], v[152:155], v[60:63], v[88:91]
    v_mfma_f32_16x16x32_bf16 v[92:95], v[156:159], v[60:63], v[92:95]
    s_waitcnt vmcnt(3)
    v_mfma_f32_16x16x32_bf16 v[80:83], v[160:163], v[64:67], v[80:83]
    v_mfma_f32_16x16x32_bf16 v[84:87], v[164:167], v[64:67], v[84:87]
    v_mfma_f32_16x16x32_bf16 v[88:91], v[168:171], v[64:67], v[88:91]
    v_mfma_f32_16x16x32_bf16 v[92:95], v[172:175], v[64:67], v[92:95]
    s_waitcnt vmcnt(2)
    v_mfma_f32_16x16x32_bf16 v[80:83], v[176:179], v[68:71], v[80:83]
    v_mfma_f32_16x16x32_bf16 v[84:87], v[180:183], v[68:71], v[84:87]
    v_mfma_f32_16x16x32_bf16 v[88:91], v[184:187], v[68:71], v[88:91]
    v_mfma_f32_16x16x32_bf16 v[92:95], v[188:191], v[68:71], v[92:95]
    s_waitcnt vmcnt(1) lgkmcnt(14)
    v_mfma_f32_16x16x32_bf16 v[80:83], v[192:195], v[72:75], v[80:83]
    s_waitcnt lgkmcnt(12)
    v_mfma_f32_16x16x32_bf16 v[84:87], v[196:199], v[72:75], v[84:87]
    s_waitcnt lgkmcnt(10)
    v_mfma_f32_16x16x32_bf16 v[88:91], v[200:203], v[72:75], v[88:91]
    s_waitcnt lgkmcnt(8)
    v_mfma_f32_16x16x32_bf16 v[92:95], v[204:207], v[72:75], v[92:95]
    s_waitcnt vmcnt(0) lgkmcnt(6)
    v_mfma_f32_16x16x32_bf16 v[80:83], v[208:211], v[76:79], v[80:83]
    s_waitcnt lgkmcnt(4)
    v_mfma_f32_16x16x32_bf16 v[84:87], v[212:215], v[76:79], v[84:87]
    s_waitcnt lgkmcnt(2)
    v_mfma_f32_16x16x32_bf16 v[88:91], v[216:219], v[76:79], v[88:91]
    s_waitcnt lgkmcnt(0)
    v_mfma_f32_16x16x32_bf16 v[92:95], v[220:223], v[76:79], v[92:95]
    s_barrier
    s_nop 0
    v_cvt_pk_bf16_f32 v248, v80, v81
    v_cvt_pk_bf16_f32 v249, v82, v83
    v_cvt_pk_bf16_f32 v250, v84, v85
    v_cvt_pk_bf16_f32 v251, v86, v87
    buffer_store_dwordx4 v[248:251], v2, s[36:39], s55 offen offset:0 sc1
    v_cvt_pk_bf16_f32 v252, v88, v89
    v_cvt_pk_bf16_f32 v253, v90, v91
    v_cvt_pk_bf16_f32 v254, v92, v93
    v_cvt_pk_bf16_f32 v255, v94, v95
    buffer_store_dwordx4 v[252:255], v2, s[36:39], s55 offen offset:1024 sc1
    v_pk_add_f32 v[40:41], v[80:81], v[82:83]
    v_pk_mul_f32 v[42:43], v[80:81], v[80:81]
    v_pk_fma_f32 v[42:43], v[82:83], v[82:83], v[42:43]
    v_pk_add_f32 v[40:41], v[40:41], v[84:85]
    v_pk_fma_f32 v[42:43], v[84:85], v[84:85], v[42:43]
    v_pk_add_f32 v[40:41], v[40:41], v[86:87]
    v_pk_fma_f32 v[42:43], v[86:87], v[86:87], v[42:43]
    v_pk_add_f32 v[40:41], v[40:41], v[88:89]
    v_pk_fma_f32 v[42:43], v[88:89], v[88:89], v[42:43]
    v_pk_add_f32 v[40:41], v[40:41], v[90:91]
    v_pk_fma_f32 v[42:43], v[90:91], v[90:91], v[42:43]
    v_pk_add_f32 v[40:41], v[40:41], v[92:93]
    v_pk_fma_f32 v[42:43], v[92:93], v[92:93], v[42:43]
    v_pk_add_f32 v[40:41], v[40:41], v[94:95]
    v_pk_fma_f32 v[42:43], v[94:95], v[94:95], v[42:43]
    v_add_f32 v40, v40, v41
    v_add_f32 v42, v42, v43
    s_nop 1
    v_permlane16_swap_b32 v40, v42
    v_add_f32 v40, v40, v42
    v_mov_b32 v41, v40
    s_nop 1
    v_permlane32_swap_b32 v40, v41
    v_add_f32 v40, v40, v41
    buffer_store_dword v40, v7, s[36:39], s56 offen sc1
    s_cmp_lg_u32 s57, 0
    s_cbranch_scc1 L_dm_29
    s_mul_i32 s63, s69, 11
    s_add_u32 s62, s63, s68
    s_add_u32 s62, s62, 860160
    s_add_u32 m0, s63, 114688
    s_nop 0
    buffer_load_dwordx4 v2, s[36:39], s62 offen offset:0 sc1 lds
    buffer_load_dwordx4 v2, s[36:39], s62 offen offset:1024 sc1 lds
    buffer_load_dwordx4 v2, s[36:39], s62 offen offset:2048 sc1 lds
    buffer_load_dwordx4 v2, s[36:39], s62 offen offset:3072 sc1 lds
    s_add_u32 m0, s63, 118784
    s_add_u32 s62, s62, 4096
    buffer_load_dwordx4 v2, s[36:39], s62 offen offset:0 sc1 lds
    buffer_load_dwordx4 v2, s[36:39], s62 offen offset:1024 sc1 lds
    buffer_load_dwordx4 v2, s[36:39], s62 offen offset:2048 sc1 lds
    buffer_load_dwordx4 v2, s[36:39], s62 offen offset:3072 sc1 lds
    s_add_u32 m0, s63, 122880
    s_add_u32 s62, s62, 4096
    buffer_load_dwordx4 v2, s[36:39], s62 offen offset:0 sc1 lds
    buffer_load_dwordx4 v2, s[36:39], s62 offen offset:1024 sc1 lds
    buffer_load_dwordx4 v2, s[36:39], s62 offen offset:2048 sc1 lds
    s_waitcnt vmcnt(11)
    s_branch L_dmd_30
L_dm_29:
    s_waitcnt vmcnt(0)
L_dmd_30:
    v_mov_b32 v7, s45
    v_mov_b32 v8, 0
    s_mov_b64 exec, 1
    buffer_store_dword v7, v8, s[36:39], s49 offen sc1
    s_mov_b64 exec, -1
    s_branch L_p3_done
L_p3_idle:
    s_waitcnt lgkmcnt(0)
    s_barrier
    s_barrier
    s_mul_i32 s63, s69, 11
    s_add_u32 s62, s63, s68
    s_add_u32 s62, s62, 860160
    s_add_u32 m0, s63, 114688
    s_nop 0
    buffer_load_dwordx4 v2, s[36:39], s62 offen offset:0 sc1 lds
    buffer_load_dwordx4 v2, s[36:39], s62 offen offset:1024 sc1 lds
    buffer_load_dwordx4 v2, s[36:39], s62 offen offset:2048 sc1 lds
    buffer_load_dwordx4 v2, s[36:39], s62 offen offset:3072 sc1 lds
    s_add_u32 m0, s63, 118784
    s_add_u32 s62, s62, 4096
    buffer_load_dwordx4 v2, s[36:39], s62 offen offset:0 sc1 lds
    buffer_load_dwordx4 v2, s[36:39], s62 offen offset:1024 sc1 lds
    buffer_load_dwordx4 v2, s[36:39], s62 offen offset:2048 sc1 lds
    buffer_load_dwordx4 v2, s[36:39], s62 offen offset:3072 sc1 lds
    s_add_u32 m0, s63, 122880
    s_add_u32 s62, s62, 4096
    buffer_load_dwordx4 v2, s[36:39], s62 offen offset:0 sc1 lds
    buffer_load_dwordx4 v2, s[36:39], s62 offen offset:1024 sc1 lds
    buffer_load_dwordx4 v2, s[36:39], s62 offen offset:2048 sc1 lds
L_p3_done:
    v_and_b32 v216, 15, v1
    v_lshrrev_b32 v217, 4, v1
    v_lshlrev_b32 v218, 2, v216
    v_lshlrev_b32 v5, 4, v217
    s_mul_i32 s55, s42, 448
    s_add_u32 s55, s55, 32768
    v_mov_b32 v4, v2
    v_add_u32 v6, 57344, v2
    v_add_u32 v7, 114688, v2
    v_lshlrev_b32 v11, 1, v216
    v_mov_b32 v10, v218
    v_mov_b32 v214, 0xbdd2d3e8
    v_mov_b32 v215, 0xc0135761
    v_min_u32 v220, 6, v216
    s_lshl_b32 s56, s47, 7
    s_add_u32 s56, s56, 229376
    v_lshl_add_u32 v3, v220, 2, s56
    v_lshlrev_b32 v8, 3, v216
    v_lshl_add_u32 v8, v217, 7, v8
    v_add_u32 v9, 512, v8
    v_mov_b32 v220, 0x40000000
    v_cmp_eq_u32 vcc, 3, v217
    s_nop 1
    v_cndmask_b32 v9, v9, v220, vcc
    s_lshl_b32 s56, s47, 10
    s_add_u32 s56, s56, 524288
    s_mul_i32 s57, s47, 14336
    s_add_u32 s57, s57, 11534336
    s_mul_i32 s60, s40, 8192
    s_add_u32 s60, s60, 102400
    v_lshrrev_b32 v224, 3, v1
    v_and_b32 v225, 7, v1
    v_lshrrev_b32 v226, 1, v224
    v_xor_b32 v225, v225, v226
    v_lshlrev_b32 v224, 12, v224
    v_lshl_add_u32 v12, v225, 4, v224
    v_xor_b32 v13, 64, v12
    v_add_u32 v13, 0x8000, v13
    v_and_b32 v224, 15, v1
    v_lshrrev_b32 v225, 4, v1
    v_lshrrev_b32 v226, 1, v224
    v_xor_b32 v225, v225, v226
    v_lshrrev_b32 v226, 3, v224
    v_and_b32 v224, 7, v224
    v_lshlrev_b32 v226, 12, v226
    v_lshl_add_u32 v226, v224, 7, v226
    v_lshl_add_u32 v226, v225, 4, v226
    s_and_b32 s49, s70, 1
    s_lshl_b32 s49, s49, 6
    v_xor_b32 v226, s49, v226
    v_add_u32 v14, s60, v226
    v_xor_b32 v226, 64, v226
    v_add_u32 v15, s60, v226
    buffer_load_dword v220, v3, s[36:39], 0 offen sc1
    ds_read_b128 a[8:11], v6 offset:0
    ds_read_b128 a[12:15], v6 offset:1024
    ds_read_b128 a[24:27], v6 offset:2048
    ds_read_b128 a[28:31], v6 offset:3072
    ds_read_b128 a[40:43], v6 offset:4096
    ds_read_b128 a[44:47], v6 offset:5120
    ds_read_b128 a[56:59], v6 offset:6144
    ds_read_b128 a[60:63], v6 offset:7168
    ds_read_b128 a[72:75], v6 offset:8192
    ds_read_b128 a[76:79], v6 offset:9216
    ds_read_b128 a[88:91], v6 offset:10240
    ds_read_b128 a[92:95], v6 offset:11264
    ds_read_b128 a[104:107], v6 offset:12288
    ds_read_b128 a[108:111], v6 offset:13312
    ds_read_b128 a[120:123], v6 offset:14336
    ds_read_b128 a[124:127], v6 offset:15360
    ds_read_b128 a[136:139], v6 offset:16384
    ds_read_b128 a[140:143], v6 offset:17408
    ds_read_b128 a[152:155], v6 offset:18432
    ds_read_b128 a[156:159], v6 offset:19456
    ds_read_b128 a[168:171], v6 offset:20480
    ds_read_b128 a[172:175], v6 offset:21504
    ds_read_b128 a[184:187], v6 offset:22528
    ds_read_b128 a[188:191], v6 offset:23552
    ds_read_b128 a[200:203], v6 offset:24576
    ds_read_b128 a[204:207], v6 offset:25600
    ds_read_b128 a[216:219], v6 offset:26624
    ds_read_b128 a[220:223], v6 offset:27648
    s_mov_b32 s48, 0
    s_branch L_pollc_32
L_poll_31:
    buffer_load_dword v220, v3, s[36:39], 0 offen sc1
L_pollc_32:
    s_add_u32 s48, s48, 1
    s_cmp_gt_u32 s48, 0x80000
    s_waitcnt vmcnt(0)
    s_cbranch_scc1 L_polld_33
    v_cmp_ne_u32 vcc, s45, v220
    s_nop 1
    s_cbranch_vccnz L_poll_31
L_polld_33:
    buffer_load_dwordx2 v[220:221], v8, s[36:39], s56 offen sc1
    buffer_load_dwordx2 v[222:223], v9, s[36:39], s56 offen sc1
    buffer_load_dwordx4 v[16:19], v2, s[36:39], s57 offen offset:0 sc1
    ds_read_b128 a[232:235], v6 offset:28672
    ds_read_b128 a[236:239], v6 offset:29696
    buffer_load_dwordx4 v[20:23], v2, s[36:39], s57 offen offset:1024 sc1
    ds_read_b128 a[248:251], v6 offset:30720
    ds_read_b128 a[252:255], v6 offset:31744
    buffer_load_dwordx4 v[24:27], v2, s[36:39], s57 offen offset:2048 sc1
    ds_read_b128 v[100:103], v6 offset:32768
    ds_read_b128 v[104:107], v6 offset:33792
    buffer_load_dwordx4 v[28:31], v2, s[36:39], s57 offen offset:3072 sc1
    ds_read_b128 v[108:111], v6 offset:34816
    ds_read_b128 v[112:115], v6 offset:35840
    s_add_u32 s57, s57, 4096
    buffer_load_dwordx4 v[32:35], v2, s[36:39], s57 offen offset:0 sc1
    ds_read_b128 v[116:119], v6 offset:36864
    ds_read_b128 v[120:123], v6 offset:37888
    buffer_load_dwordx4 v[36:39], v2, s[36:39], s57 offen offset:1024 sc1
    ds_read_b128 v[124:127], v6 offset:38912
    ds_read_b128 v[196:199], v6 offset:39936
    buffer_load_dwordx4 v[40:43], v2, s[36:39], s57 offen offset:2048 sc1
    ds_read_b128 v[200:203], v6 offset:40960
    ds_read_b128 v[232:235], v6 offset:41984
    buffer_load_dwordx4 v[44:47], v2, s[36:39], s57 offen offset:3072 sc1
    ds_read_b128 v[236:239], v6 offset:43008
    ds_read_b128 v[240:243], v6 offset:44032
    s_barrier
    s_waitcnt vmcnt(7) lgkmcnt(15)
    v_mfma_f32_16x16x32_bf16 v[72:75], v[16:19], a[8:11], 0
    v_add_f32 v220, v220, v222
    v_mfma_f32_16x16x32_bf16 v[76:79], v[16:19], a[12:15], 0
    v_add_f32 v221, v221, v223
    v_mfma_f32_16x16x32_bf16 v[80:83], v[16:19], a[24:27], 0
    s_add_u32 s57, s57, 4096
    buffer_load_dwordx4 v[48:51], v2, s[36:39], s57 offen offset:0 sc1
    v_mfma_f32_16x16x32_bf16 v[84:87], v[16:19], a[28:31], 0
    v_permlane16_swap_b32 v220, v221
    v_mfma_f32_16x16x32_bf16 v[88:91], v[16:19], a[40:43], 0
    v_add_f32 v220, v220, v221
    v_mfma_f32_16x16x32_bf16 v[92:95], v[16:19], a[44:47], 0
    buffer_load_dwordx4 v[52:55], v2, s[36:39], s57 offen offset:1024 sc1
    v_mfma_f32_16x16x32_bf16 v[96:99], v[16:19], a[56:59], 0
    v_mov_b32 v222, v220
    s_waitcnt vmcnt(8)
    v_mfma_f32_16x16x32_bf16 v[72:75], v[20:23], a[60:63], v[72:75]
    v_permlane32_swap_b32 v220, v222
    v_mfma_f32_16x16x32_bf16 v[76:79], v[20:23], a[72:75], v[76:79]
    buffer_load_dwordx4 v[56:59], v2, s[36:39], s57 offen offset:2048 sc1
    v_mfma_f32_16x16x32_bf16 v[80:83], v[20:23], a[76:79], v[80:83]
    v_add_f32 v220, v220, v222
    v_mfma_f32_16x16x32_bf16 v[84:87], v[20:23], a[88:91], v[84:87]
    v_mov_b32 v221, v220
    v_mfma_f32_16x16x32_bf16 v[88:91], v[20:23], a[92:95], v[88:91]
    buffer_load_dwordx4 v[60:63], v2, s[36:39], s57 offen offset:3072 sc1
    v_mfma_f32_16x16x32_bf16 v[92:95], v[20:23], a[104:107], v[92:95]
    v_permlane16_swap_b32 v220, v221
    v_mfma_f32_16x16x32_bf16 v[96:99], v[20:23], a[108:111], v[96:99]
    v_mul_f32 v220, 0x3b124925, v220
    s_waitcnt vmcnt(9)
    v_mfma_f32_16x16x32_bf16 v[72:75], v[24:27], a[120:123], v[72:75]
    s_add_u32 s57, s57, 4096
    buffer_load_dwordx4 v[64:67], v2, s[36:39], s57 offen offset:0 sc1
    v_mfma_f32_16x16x32_bf16 v[76:79], v[24:27], a[124:127], v[76:79]
    v_mul_f32 v221, 0x3b124925, v221
    v_mfma_f32_16x16x32_bf16 v[80:83], v[24:27], a[136:139], v[80:83]
    v_fma_f32 v221, -v220, v220, v221
    v_mfma_f32_16x16x32_bf16 v[84:87], v[24:27], a[140:143], v[84:87]
    buffer_load_dwordx4 v[68:71], v2, s[36:39], s57 offen offset:1024 sc1
    v_mfma_f32_16x16x32_bf16 v[88:91], v[24:27], a[152:155], v[88:91]
    v_max_f32 v221, 0, v221
    v_mfma_f32_16x16x32_bf16 v[92:95], v[24:27], a[156:159], v[92:95]
    v_add_f32 v221, 0x3727c5ac, v221
    v_mfma_f32_16x16x32_bf16 v[96:99], v[24:27], a[168:171], v[96:99]
    buffer_load_dword v188, v10, s[36:39], s55 offen offset:3584 sc1
    s_waitcnt vmcnt(11)
    v_mfma_f32_16x16x32_bf16 v[72:75], v[28:31], a[172:175], v[72:75]
    v_rsq_f32 v212, v221
    v_mfma_f32_16x16x32_bf16 v[76:79], v[28:31], a[184:187], v[76:79]
    v_mul_f32 v213, v220, v212
    v_mfma_f32_16x16x32_bf16 v[80:83], v[28:31], a[188:191], v[80:83]
    buffer_load_dword v189, v10, s[36:39], s55 offen offset:3648 sc1
    v_mfma_f32_16x16x32_bf16 v[84:87], v[28:31], a[200:203], v[84:87]
    v_sub_f32 v213, 0, v213
    v_mfma_f32_16x16x32_bf16 v[88:91], v[28:31], a[204:207], v[88:91]
    ds_bpermute_b32 v204, v5, v212 offset:0
    v_mfma_f32_16x16x32_bf16 v[92:95], v[28:31], a[216:219], v[92:95]
    buffer_load_dword v190, v10, s[36:39], s55 offen offset:3712 sc1
    v_mfma_f32_16x16x32_bf16 v[96:99], v[28:31], a[220:223], v[96:99]
    ds_bpermute_b32 v208, v5, v213 offset:0
    s_waitcnt vmcnt(12)
    v_mfma_f32_16x16x32_bf16 v[72:75], v[32:35], a[232:235], v[72:75]
    ds_bpermute_b32 v205, v5, v212 offset:4
    s_waitcnt lgkmcnt(15)
    v_mfma_f32_16x16x32_bf16 v[76:79], v[32:35], a[236:239], v[76:79]
    buffer_load_dword v191, v10, s[36:39], s55 offen offset:3776 sc1
    v_mfma_f32_16x16x32_bf16 v[80:83], v[32:35], a[248:251], v[80:83]
    ds_bpermute_b32 v209, v5, v213 offset:4
    v_mfma_f32_16x16x32_bf16 v[84:87], v[32:35], a[252:255], v[84:87]
    ds_bpermute_b32 v206, v5, v212 offset:8
    s_waitcnt lgkmcnt(15)
    v_mfma_f32_16x16x32_bf16 v[88:91], v[32:35], v[100:103], v[88:91]
    buffer_load_dword v192, v10, s[36:39], s55 offen offset:3840 sc1
    v_mfma_f32_16x16x32_bf16 v[92:95], v[32:35], v[104:107], v[92:95]
    ds_bpermute_b32 v210, v5, v213 offset:8
    s_waitcnt lgkmcnt(15)
    v_mfma_f32_16x16x32_bf16 v[96:99], v[32:35], v[108:111], v[96:99]
    ds_bpermute_b32 v207, v5, v212 offset:12
    s_waitcnt vmcnt(13) lgkmcnt(15)
    v_mfma_f32_16x16x32_bf16 v[72:75], v[36:39], v[112:115], v[72:75]
    buffer_load_dword v193, v10, s[36:39], s55 offen offset:3904 sc1
    s_waitcnt lgkmcnt(14)
    v_mfma_f32_16x16x32_bf16 v[76:79], v[36:39], v[116:119], v[76:79]
    ds_bpermute_b32 v211, v5, v213 offset:12
    s_waitcnt lgkmcnt(14)
    v_mfma_f32_16x16x32_bf16 v[80:83], v[36:39], v[120:123], v[80:83]
    s_waitcnt lgkmcnt(13)
    v_mfma_f32_16x16x32_bf16 v[84:87], v[36:39], v[124:127], v[84:87]
    buffer_load_dword v194, v10, s[36:39], s55 offen offset:3968 sc1
    s_waitcnt lgkmcnt(12)
    v_mfma_f32_16x16x32_bf16 v[88:91], v[36:39], v[196:199], v[88:91]
    s_waitcnt lgkmcnt(11)
    v_mfma_f32_16x16x32_bf16 v[92:95], v[36:39], v[200:203], v[92:95]
    s_waitcnt lgkmcnt(10)
    v_mfma_f32_16x16x32_bf16 v[96:99], v[36:39], v[232:235], v[96:99]
    s_waitcnt vmcnt(14) lgkmcnt(9)
    v_mfma_f32_16x16x32_bf16 v[72:75], v[40:43], v[236:239], v[72:75]
    s_waitcnt lgkmcnt(8)
    v_mfma_f32_16x16x32_bf16 v[76:79], v[40:43], v[240:243], v[76:79]
    ds_read_b128 v[128:131], v6 offset:45056
    ds_read_b128 v[132:135], v6 offset:46080
    ds_read_b128 v[136:139], v6 offset:47104
    ds_read_b128 v[140:143], v6 offset:48128
    ds_read_b128 v[144:147], v6 offset:49152
    ds_read_b128 v[148:151], v6 offset:50176
    ds_read_b128 v[152:155], v6 offset:51200
    ds_read_b128 v[156:159], v6 offset:52224
    s_waitcnt lgkmcnt(6)
    v_mfma_f32_16x16x32_bf16 v[84:87], v[40:43], v[132:135], v[84:87]
    v_mfma_f32_16x16x32_bf16 v[80:83], v[40:43], v[128:131], v[80:83]
    s_mul_i32 s63, s69, 14
    s_add_u32 s62, s63, s68
    s_add_u32 s62, s62, 0
    s_add_u32 m0, s63, 0
    s_nop 0
    buffer_load_dwordx4 v2, s[36:39], s62 offen offset:0 sc1 lds
    ds_read_b128 v[128:131], v6 offset:53248
    ds_read_b128 v[132:135], v6 offset:54272
    s_waitcnt lgkmcnt(6)
    v_mfma_f32_16x16x32_bf16 v[92:95], v[40:43], v[140:143], v[92:95]
    v_mfma_f32_16x16x32_bf16 v[88:91], v[40:43], v[136:139], v[88:91]
    v_and_b32 v224, 15, v1
    v_lshrrev_b32 v225, 4, v1
    v_lshl_add_u32 v226, v225, 2, v224
    v_lshlrev_b32 v226, 4, v226
    ds_read_b128 v[136:139], v6 offset:55296
    ds_read_b128 v[140:143], v6 offset:56320
    s_waitcnt vmcnt(14) lgkmcnt(6)
    v_mfma_f32_16x16x32_bf16 v[72:75], v[44:47], v[148:151], v[72:75]
    v_mfma_f32_16x16x32_bf16 v[96:99], v[40:43], v[144:147], v[96:99]
    buffer_load_dwordx4 v2, s[36:39], s62 offen offset:1024 sc1 lds
    ds_read_b128 v[144:147], v7 offset:0
    ds_read_b128 v[148:151], v7 offset:1024
    s_waitcnt lgkmcnt(6)
    v_mfma_f32_16x16x32_bf16 v[80:83], v[44:47], v[156:159], v[80:83]
    v_mfma_f32_16x16x32_bf16 v[76:79], v[44:47], v[152:155], v[76:79]
    v_mov_b32 v227, 0x40000000
    v_cmp_gt_u32 vcc, 4, v224
    v_lshlrev_b32 v233, 4, v224
    v_lshl_add_u32 v233, v225, 10, v233
    ds_read_b128 v[152:155], v7 offset:2048
    ds_read_b128 v[156:159], v7 offset:3072
    s_waitcnt lgkmcnt(6)
    v_mfma_f32_16x16x32_bf16 v[88:91], v[44:47], v[132:135], v[88:91]
    v_mfma_f32_16x16x32_bf16 v[84:87], v[44:47], v[128:131], v[84:87]
    buffer_load_dwordx4 v2, s[36:39], s62 offen offset:2048 sc1 lds
    ds_read_b128 v[128:131], v7 offset:4096
    ds_read_b128 v[132:135], v7 offset:5120
    s_waitcnt lgkmcnt(6)
    v_mfma_f32_16x16x32_bf16 v[96:99], v[44:47], v[140:143], v[96:99]
    v_mfma_f32_16x16x32_bf16 v[92:95], v[44:47], v[136:139], v[92:95]
    v_cndmask_b32 v232, v227, v226, vcc
    v_cmp_eq_u32 s[66:67], 1, v224
    v_cmp_eq_u32 s[78:79], 2, v224
    v_cmp_eq_u32 vcc, 3, v224
    ds_read_b128 v[136:139], v7 offset:6144
    ds_read_b128 v[140:143], v7 offset:7168
    s_waitcnt vmcnt(15) lgkmcnt(6)
    v_mfma_f32_16x16x32_bf16 v[76:79], v[48:51], v[148:151], v[76:79]
    v_mfma_f32_16x16x32_bf16 v[72:75], v[48:51], v[144:147], v[72:75]
    buffer_load_dwordx4 v2, s[36:39], s62 offen offset:3072 sc1 lds
    ds_read_b128 v[144:147], v7 offset:8192
    ds_read_b128 v[148:151], v7 offset:9216
    s_waitcnt lgkmcnt(6)
    v_mfma_f32_16x16x32_bf16 v[84:87], v[48:51], v[156:159], v[84:87]
    v_mfma_f32_16x16x32_bf16 v[80:83], v[48:51], v[152:155], v[80:83]
    v_bfe_u32 v226, v1, 4, 1
    v_lshrrev_b32 v227, 5, v1
    v_lshlrev_b32 v224, 4, v224
    v_lshl_add_u32 v224, v227, 8, v224
    ds_read_b128 v[152:155], v7 offset:10240
    ds_read_b128 v[156:159], v7 offset:11264
    s_waitcnt lgkmcnt(6)
    v_mfma_f32_16x16x32_bf16 v[92:95], v[48:51], v[132:135], v[92:95]
    v_mfma_f32_16x16x32_bf16 v[88:91], v[48:51], v[128:131], v[88:91]
    s_add_u32 m0, s63, 4096
    s_add_u32 s62, s62, 4096
    buffer_load_dwordx4 v2, s[36:39], s62 offen offset:0 sc1 lds
    ds_read_b128 v[128:131], v7 offset:12288
    ds_read_b128 v[132:135], v7 offset:13312
    s_waitcnt vmcnt(16) lgkmcnt(6)
    v_mfma_f32_16x16x32_bf16 v[72:75], v[52:55], v[140:143], v[72:75]
    v_mfma_f32_16x16x32_bf16 v[96:99], v[48:51], v[136:139], v[96:99]
    v_lshl_add_u32 v235, v226, 3, v224
    v_lshl_add_u32 v234, v226, 10, v224
    s_lshl_b32 s72, s41, 13
    s_lshl_b32 s73, s40, 8
    ds_read_b128 v[136:139], v7 offset:14336
    ds_read_b128 v[140:143], v7 offset:15360
    s_waitcnt lgkmcnt(6)
    v_mfma_f32_16x16x32_bf16 v[80:83], v[52:55], v[148:151], v[80:83]
    v_mfma_f32_16x16x32_bf16 v[76:79], v[52:55], v[144:147], v[76:79]
    buffer_load_dwordx4 v2, s[36:39], s62 offen offset:1024 sc1 lds
    ds_read_b128 v[144:147], v7 offset:16384
    ds_read_b128 v[148:151], v7 offset:17408
    s_waitcnt lgkmcnt(6)
    v_mfma_f32_16x16x32_bf16 v[88:91], v[52:55], v[156:159], v[88:91]
    v_mfma_f32_16x16x32_bf16 v[84:87], v[52:55], v[152:155], v[84:87]
    s_add_u32 s72, s72, s73
    s_add_u32 s72, s72, 262144
    s_lshl_b32 s73, s42, 10
    s_add_u32 s73, s73, s72
    ds_read_b128 v[152:155], v7 offset:18432
    ds_read_b128 v[156:159], v7 offset:19456
    s_waitcnt lgkmcnt(6)
    v_mfma_f32_16x16x32_bf16 v[96:99], v[52:55], v[132:135], v[96:99]
    v_mfma_f32_16x16x32_bf16 v[92:95], v[52:55], v[128:131], v[92:95]
    buffer_load_dwordx4 v2, s[36:39], s62 offen offset:2048 sc1 lds
    ds_read_b128 v[128:131], v7 offset:20480
    ds_read_b128 v[132:135], v7 offset:21504
    s_waitcnt vmcnt(17) lgkmcnt(6)
    v_mfma_f32_16x16x32_bf16 v[76:79], v[56:59], v[140:143], v[76:79]
    v_mfma_f32_16x16x32_bf16 v[72:75], v[56:59], v[136:139], v[72:75]
    s_lshl_b32 s74, s42, 6
    s_lshr_b32 s75, s47, 1
    s_add_u32 s74, s74, s75
    s_mul_i32 s74, s74, 7168
    ds_read_b128 v[136:139], v7 offset:22528
    ds_read_b128 v[140:143], v7 offset:23552
    s_waitcnt lgkmcnt(6)
    v_mfma_f32_16x16x32_bf16 v[84:87], v[56:59], v[148:151], v[84:87]
    v_mfma_f32_16x16x32_bf16 v[80:83], v[56:59], v[144:147], v[80:83]
    buffer_load_dwordx4 v2, s[36:39], s62 offen offset:3072 sc1 lds
    ds_read_b128 v[144:147], v7 offset:24576
    ds_read_b128 v[148:151], v7 offset:25600
    s_waitcnt lgkmcnt(6)
    v_mfma_f32_16x16x32_bf16 v[92:95], v[56:59], v[156:159], v[92:95]
    v_mfma_f32_16x16x32_bf16 v[88:91], v[56:59], v[152:155], v[88:91]
    s_and_b32 s75, s47, 1
    s_lshl_b32 s75, s75, 9
    s_add_u32 s74, s74, s75
    s_add_u32 s74, s74, 13631488
    ds_read_b128 v[152:155], v7 offset:26624
    ds_read_b128 v[156:159], v7 offset:27648
    s_waitcnt vmcnt(17) lgkmcnt(6)
    v_mfma_f32_16x16x32_bf16 v[72:75], v[60:63], v[132:135], v[72:75]
    v_mfma_f32_16x16x32_bf16 v[96:99], v[56:59], v[128:131], v[96:99]
    s_add_u32 m0, s63, 8192
    s_add_u32 s62, s62, 4096
    buffer_load_dwordx4 v2, s[36:39], s62 offen offset:0 sc1 lds
    ds_read_b128 v[128:131], v7 offset:28672
    ds_read_b128 v[132:135], v7 offset:29696
    s_waitcnt lgkmcnt(6)
    v_mfma_f32_16x16x32_bf16 v[80:83], v[60:63], v[140:143], v[80:83]
    v_mfma_f32_16x16x32_bf16 v[76:79], v[60:63], v[136:139], v[76:79]
    s_add_u32 s75, s74, 4096
    s_bfe_u32 s50, s41, 0x20001
    s_lshl_b32 s51, s42, 2
    s_add_u32 s50, s50, s51
    ds_read_b128 v[136:139], v7 offset:30720
    ds_read_b128 v[140:143], v7 offset:31744
    s_waitcnt lgkmcnt(6)
    v_mfma_f32_16x16x32_bf16 v[88:91], v[60:63], v[148:151], v[88:91]
    v_mfma_f32_16x16x32_bf16 v[84:87], v[60:63], v[144:147], v[84:87]
    buffer_load_dwordx4 v2, s[36:39], s62 offen offset:1024 sc1 lds
    ds_read_b128 v[144:147], v7 offset:32768
    ds_read_b128 v[148:151], v7 offset:33792
    s_waitcnt lgkmcnt(6)
    v_mfma_f32_16x16x32_bf16 v[96:99], v[60:63], v[156:159], v[96:99]
    v_mfma_f32_16x16x32_bf16 v[92:95], v[60:63], v[152:155], v[92:95]
    s_lshl_b32 s50, s50, 5
    s_lshr_b32 s51, s41, 3
    s_lshl_b32 s51, s51, 1
    s_add_u32 s50, s50, s51
    ds_read_b128 v[152:155], v7 offset:34816
    ds_read_b128 v[156:159], v7 offset:35840
    s_waitcnt vmcnt(18) lgkmcnt(6)
    v_mfma_f32_16x16x32_bf16 v[76:79], v[64:67], v[132:135], v[76:79]
    v_mfma_f32_16x16x32_bf16 v[72:75], v[64:67], v[128:131], v[72:75]
    buffer_load_dwordx4 v2, s[36:39], s62 offen offset:2048 sc1 lds
    ds_read_b128 v[128:131], v7 offset:36864
    ds_read_b128 v[132:135], v7 offset:37888
    s_waitcnt lgkmcnt(6)
    v_mfma_f32_16x16x32_bf16 v[84:87], v[64:67], v[140:143], v[84:87]
    v_mfma_f32_16x16x32_bf16 v[80:83], v[64:67], v[136:139], v[80:83]
    s_and_b32 s51, s41, 1
    s_add_u32 s50, s50, s51
    s_lshl_b32 s50, s50, 2
    s_add_u32 s76, s50, 16384
    ds_read_b128 v[136:139], v7 offset:38912
    ds_read_b128 v[140:143], v7 offset:39936
    s_waitcnt lgkmcnt(6)
    v_mfma_f32_16x16x32_bf16 v[92:95], v[64:67], v[148:151], v[92:95]
    v_mfma_f32_16x16x32_bf16 v[88:91], v[64:67], v[144:147], v[88:91]
    buffer_load_dwordx4 v2, s[36:39], s62 offen offset:3072 sc1 lds
    ds_read_b128 v[144:147], v7 offset:40960
    ds_read_b128 v[148:151], v7 offset:41984
    s_waitcnt vmcnt(19) lgkmcnt(6)
    v_mfma_f32_16x16x32_bf16 v[72:75], v[68:71], v[156:159], v[72:75]
    v_mfma_f32_16x16x32_bf16 v[96:99], v[64:67], v[152:155], v[96:99]
    s_add_u32 m0, s63, 12288
    s_add_u32 s62, s62, 4096
    buffer_load_dwordx4 v2, s[36:39], s62 offen offset:0 sc1 lds
    s_waitcnt lgkmcnt(4)
    v_mfma_f32_16x16x32_bf16 v[80:83], v[68:71], v[132:135], v[80:83]
    v_mfma_f32_16x16x32_bf16 v[76:79], v[68:71], v[128:131], v[76:79]
    buffer_load_dwordx4 v2, s[36:39], s62 offen offset:1024 sc1 lds
    s_waitcnt lgkmcnt(2)
    v_mfma_f32_16x16x32_bf16 v[88:91], v[68:71], v[140:143], v[88:91]
    v_mfma_f32_16x16x32_bf16 v[84:87], v[68:71], v[136:139], v[84:87]
    s_waitcnt lgkmcnt(0)
    v_mfma_f32_16x16x32_bf16 v[96:99], v[68:71], v[148:151], v[96:99]
    v_mfma_f32_16x16x32_bf16 v[92:95], v[68:71], v[144:147], v[92:95]
    s_barrier
    s_add_u32 s58, s40, 3
    s_and_b32 s58, s58, 3
    s_lshl_b32 s58, s58, 8
    s_add_u32 s58, s58, s40
    s_lshl_b32 s58, s58, 8
    s_lshl_b32 s59, s41, 18
    s_add_u32 s58, s58, s59
    s_and_b32 s59, s70, 2
    s_lshl_b32 s59, s59, 6
    s_add_u32 s58, s58, s59
    s_add_u32 m0, s60, 0
    s_nop 0
    buffer_load_dwordx4 v12, s[20:23], s58 offen offset:0 lds
    s_waitcnt vmcnt(20)
    v_pk_mul_f32 v[216:217], v[208:209], v[188:189] op_sel_hi:[1,0]
    v_pk_mul_f32 v[218:219], v[210:211], v[188:189] op_sel_hi:[1,0]
    v_pk_fma_f32 v[72:73], v[72:73], v[204:205], v[216:217]
    v_pk_fma_f32 v[74:75], v[74:75], v[206:207], v[218:219]
    v_pk_mul_f32 v[216:217], v[208:209], v[188:189] op_sel:[0,1] op_sel_hi:[1,1]
    v_pk_mul_f32 v[218:219], v[210:211], v[188:189] op_sel:[0,1] op_sel_hi:[1,1]
    v_pk_fma_f32 v[76:77], v[76:77], v[204:205], v[216:217]
    v_pk_fma_f32 v[78:79], v[78:79], v[206:207], v[218:219]
    s_waitcnt vmcnt(18)
    v_pk_mul_f32 v[216:217], v[208:209], v[190:191] op_sel_hi:[1,0]
    v_pk_mul_f32 v[218:219], v[210:211], v[190:191] op_sel_hi:[1,0]
    buffer_load_dwordx4 v12, s[20:23], s58 offen offset:1024 lds
    v_pk_fma_f32 v[80:81], v[80:81], v[204:205], v[216:217]
    v_pk_fma_f32 v[82:83], v[82:83], v[206:207], v[218:219]
    v_pk_mul_f32 v[216:217], v[208:209], v[190:191] op_sel:[0,1] op_sel_hi:[1,1]
    v_pk_mul_f32 v[218:219], v[210:211], v[190:191] op_sel:[0,1] op_sel_hi:[1,1]
    v_pk_fma_f32 v[84:85], v[84:85], v[204:205], v[216:217]
    v_pk_fma_f32 v[86:87], v[86:87], v[206:207], v[218:219]
    s_waitcnt vmcnt(17)
    v_pk_mul_f32 v[216:217], v[208:209], v[192:193] op_sel_hi:[1,0]
    v_pk_mul_f32 v[218:219], v[210:211], v[192:193] op_sel_hi:[1,0]
    v_pk_fma_f32 v[88:89], v[88:89], v[204:205], v[216:217]
    buffer_load_dwordx4 v12, s[20:23], s58 offen offset:2048 lds
    v_pk_fma_f32 v[90:91], v[90:91], v[206:207], v[218:219]
    v_pk_mul_f32 v[216:217], v[208:209], v[192:193] op_sel:[0,1] op_sel_hi:[1,1]
    v_pk_mul_f32 v[218:219], v[210:211], v[192:193] op_sel:[0,1] op_sel_hi:[1,1]
    v_pk_fma_f32 v[92:93], v[92:93], v[204:205], v[216:217]
    v_pk_fma_f32 v[94:95], v[94:95], v[206:207], v[218:219]
    s_waitcnt vmcnt(17)
    v_pk_mul_f32 v[216:217], v[208:209], v[194:195] op_sel_hi:[1,0]
    v_pk_mul_f32 v[218:219], v[210:211], v[194:195] op_sel_hi:[1,0]
    v_pk_fma_f32 v[96:97], v[96:97], v[204:205], v[216:217]
    v_pk_fma_f32 v[98:99], v[98:99], v[206:207], v[218:219]
    buffer_load_dwordx4 v12, s[20:23], s58 offen offset:3072 lds
    v_pk_mul_f32 v[216:217], v[72:73], v[72:73]
    v_pk_mul_f32 v[218:219], v[74:75], v[74:75]
    v_pk_mul_f32 v[220:221], v[76:77], v[76:77]
    v_pk_mul_f32 v[222:223], v[78:79], v[78:79]
    v_pk_fma_f32 v[216:217], v[216:217], v[214:215], v[214:215] op_sel:[0,0,1] op_sel_hi:[1,0,1]
    v_pk_fma_f32 v[218:219], v[218:219], v[214:215], v[214:215] op_sel:[0,0,1] op_sel_hi:[1,0,1]
    v_pk_fma_f32 v[220:221], v[220:221], v[214:215], v[214:215] op_sel:[0,0,1] op_sel_hi:[1,0,1]
    v_pk_fma_f32 v[222:223], v[222:223], v[214:215], v[214:215] op_sel:[0,0,1] op_sel_hi:[1,0,1]
    v_pk_mul_f32 v[216:217], v[216:217], v[72:73]
    s_add_u32 m0, s60, 4096
    s_nop 0
    buffer_load_dwordx4 v13, s[20:23], s58 offen offset:0 lds
    v_pk_mul_f32 v[218:219], v[218:219], v[74:75]
    v_pk_mul_f32 v[220:221], v[220:221], v[76:77]
    v_pk_mul_f32 v[222:223], v[222:223], v[78:79]
    v_exp_f32 v216, v216
    v_exp_f32 v217, v217
    v_exp_f32 v218, v218
    v_exp_f32 v219, v219
    v_exp_f32 v220, v220
    v_exp_f32 v221, v221
    buffer_load_dwordx4 v13, s[20:23], s58 offen offset:1024 lds
    v_exp_f32 v222, v222
    v_exp_f32 v223, v223
    v_pk_add_f32 v[216:217], v[216:217], 1.0 op_sel_hi:[1,0]
    v_pk_add_f32 v[218:219], v[218:219], 1.0 op_sel_hi:[1,0]
    v_pk_add_f32 v[220:221], v[220:221], 1.0 op_sel_hi:[1,0]
    v_pk_add_f32 v[222:223], v[222:223], 1.0 op_sel_hi:[1,0]
    v_rcp_f32 v216, v216
    v_rcp_f32 v217, v217
    v_rcp_f32 v218, v218
    buffer_load_dwordx4 v13, s[20:23], s58 offen offset:2048 lds
    v_rcp_f32 v219, v219
    v_rcp_f32 v220, v220
    v_rcp_f32 v221, v221
    v_rcp_f32 v222, v222
    v_rcp_f32 v223, v223
    v_pk_mul_f32 v[72:73], v[72:73], v[216:217]
    v_pk_mul_f32 v[74:75], v[74:75], v[218:219]
    v_pk_mul_f32 v[76:77], v[76:77], v[220:221]
    v_pk_mul_f32 v[78:79], v[78:79], v[222:223]
    buffer_load_dwordx4 v13, s[20:23], s58 offen offset:3072 lds
    v_pk_mul_f32 v[216:217], v[80:81], v[80:81]
    v_pk_mul_f32 v[218:219], v[82:83], v[82:83]
    v_pk_mul_f32 v[220:221], v[84:85], v[84:85]
    v_pk_mul_f32 v[222:223], v[86:87], v[86:87]
    v_pk_fma_f32 v[216:217], v[216:217], v[214:215], v[214:215] op_sel:[0,0,1] op_sel_hi:[1,0,1]
    v_pk_fma_f32 v[218:219], v[218:219], v[214:215], v[214:215] op_sel:[0,0,1] op_sel_hi:[1,0,1]
    v_pk_fma_f32 v[220:221], v[220:221], v[214:215], v[214:215] op_sel:[0,0,1] op_sel_hi:[1,0,1]
    v_pk_fma_f32 v[222:223], v[222:223], v[214:215], v[214:215] op_sel:[0,0,1] op_sel_hi:[1,0,1]
    v_pk_mul_f32 v[216:217], v[216:217], v[80:81]
    s_mul_i32 s63, s69, 11
    s_add_u32 s62, s63, s68
    s_add_u32 s62, s62, 57344
    s_add_u32 m0, s63, 57344
    s_nop 0
    buffer_load_dwordx4 v2, s[36:39], s62 offen offset:0 sc1 lds
    v_pk_mul_f32 v[218:219], v[218:219], v[82:83]
    v_pk_mul_f32 v[220:221], v[220:221], v[84:85]
    v_pk_mul_f32 v[222:223], v[222:223], v[86:87]
    v_exp_f32 v216, v216
    v_exp_f32 v217, v217
    v_exp_f32 v218, v218
    v_exp_f32 v219, v219
    v_exp_f32 v220, v220
    v_exp_f32 v221, v221
    buffer_load_dwordx4 v2, s[36:39], s62 offen offset:1024 sc1 lds
    v_exp_f32 v222, v222
    v_exp_f32 v223, v223
    v_pk_add_f32 v[216:217], v[216:217], 1.0 op_sel_hi:[1,0]
    v_pk_add_f32 v[218:219], v[218:219], 1.0 op_sel_hi:[1,0]
    v_pk_add_f32 v[220:221], v[220:221], 1.0 op_sel_hi:[1,0]
    v_pk_add_f32 v[222:223], v[222:223], 1.0 op_sel_hi:[1,0]
    v_rcp_f32 v216, v216
    v_rcp_f32 v217, v217
    v_rcp_f32 v218, v218
    buffer_load_dwordx4 v2, s[36:39], s62 offen offset:2048 sc1 lds
    v_rcp_f32 v219, v219
    v_rcp_f32 v220, v220
    v_rcp_f32 v221, v221
    v_rcp_f32 v222, v222
    v_rcp_f32 v223, v223
    v_pk_mul_f32 v[80:81], v[80:81], v[216:217]
    v_pk_mul_f32 v[82:83], v[82:83], v[218:219]
    v_pk_mul_f32 v[84:85], v[84:85], v[220:221]
    v_pk_mul_f32 v[86:87], v[86:87], v[222:223]
    buffer_load_dwordx4 v2, s[36:39], s62 offen offset:3072 sc1 lds
    v_pk_mul_f32 v[216:217], v[88:89], v[88:89]
    v_pk_mul_f32 v[218:219], v[90:91], v[90:91]
    v_pk_mul_f32 v[220:221], v[92:93], v[92:93]
    v_pk_mul_f32 v[222:223], v[94:95], v[94:95]
    v_pk_fma_f32 v[216:217], v[216:217], v[214:215], v[214:215] op_sel:[0,0,1] op_sel_hi:[1,0,1]
    v_pk_fma_f32 v[218:219], v[218:219], v[214:215], v[214:215] op_sel:[0,0,1] op_sel_hi:[1,0,1]
    v_pk_fma_f32 v[220:221], v[220:221], v[214:215], v[214:215] op_sel:[0,0,1] op_sel_hi:[1,0,1]
    v_pk_fma_f32 v[222:223], v[222:223], v[214:215], v[214:215] op_sel:[0,0,1] op_sel_hi:[1,0,1]
    v_pk_mul_f32 v[216:217], v[216:217], v[88:89]
    s_add_u32 m0, s63, 61440
    s_add_u32 s62, s62, 4096
    buffer_load_dwordx4 v2, s[36:39], s62 offen offset:0 sc1 lds
    v_pk_mul_f32 v[218:219], v[218:219], v[90:91]
    v_pk_mul_f32 v[220:221], v[220:221], v[92:93]
    v_pk_mul_f32 v[222:223], v[222:223], v[94:95]
    v_exp_f32 v216, v216
    v_exp_f32 v217, v217
    v_exp_f32 v218, v218
    v_exp_f32 v219, v219
    v_exp_f32 v220, v220
    v_exp_f32 v221, v221
    buffer_load_dwordx4 v2, s[36:39], s62 offen offset:1024 sc1 lds
    v_exp_f32 v222, v222
    v_exp_f32 v223, v223
    v_pk_add_f32 v[216:217], v[216:217], 1.0 op_sel_hi:[1,0]
    v_pk_add_f32 v[218:219], v[218:219], 1.0 op_sel_hi:[1,0]
    v_pk_add_f32 v[220:221], v[220:221], 1.0 op_sel_hi:[1,0]
    v_pk_add_f32 v[222:223], v[222:223], 1.0 op_sel_hi:[1,0]
    v_rcp_f32 v216, v216
    v_rcp_f32 v217, v217
    v_rcp_f32 v218, v218
    buffer_load_dwordx4 v2, s[36:39], s62 offen offset:2048 sc1 lds
    v_rcp_f32 v219, v219
    v_rcp_f32 v220, v220
    v_rcp_f32 v221, v221
    v_rcp_f32 v222, v222
    v_rcp_f32 v223, v223
    v_pk_mul_f32 v[88:89], v[88:89], v[216:217]
    v_pk_mul_f32 v[90:91], v[90:91], v[218:219]
    v_pk_mul_f32 v[92:93], v[92:93], v[220:221]
    v_pk_mul_f32 v[94:95], v[94:95], v[222:223]
    buffer_load_dwordx4 v2, s[36:39], s62 offen offset:3072 sc1 lds
    v_pk_mul_f32 v[216:217], v[96:97], v[96:97]
    v_pk_mul_f32 v[218:219], v[98:99], v[98:99]
    v_pk_fma_f32 v[216:217], v[216:217], v[214:215], v[214:215] op_sel:[0,0,1] op_sel_hi:[1,0,1]
    v_pk_fma_f32 v[218:219], v[218:219], v[214:215], v[214:215] op_sel:[0,0,1] op_sel_hi:[1,0,1]
    v_pk_mul_f32 v[216:217], v[216:217], v[96:97]
    v_pk_mul_f32 v[218:219], v[218:219], v[98:99]
    v_exp_f32 v216, v216
    v_exp_f32 v217, v217
    v_exp_f32 v218, v218
    s_lshl_b32 s54, s47, 5
    buffer_load_ushort v247, v11, s[24:27], s54 offen
    v_exp_f32 v219, v219
    v_pk_add_f32 v[216:217], v[216:217], 1.0 op_sel_hi:[1,0]
    v_pk_add_f32 v[218:219], v[218:219], 1.0 op_sel_hi:[1,0]
    v_rcp_f32 v216, v216
    v_rcp_f32 v217, v217
    v_rcp_f32 v218, v218
    v_rcp_f32 v219, v219
    v_pk_mul_f32 v[96:97], v[96:97], v[216:217]
    v_pk_mul_f32 v[98:99], v[98:99], v[218:219]
    v_pk_add_f32 v[216:217], v[72:73], v[76:77]
    v_pk_mul_f32 v[220:221], v[72:73], v[72:73]
    v_pk_add_f32 v[218:219], v[74:75], v[78:79]
    v_pk_mul_f32 v[222:223], v[74:75], v[74:75]
    v_pk_fma_f32 v[220:221], v[76:77], v[76:77], v[220:221]
    v_pk_fma_f32 v[222:223], v[78:79], v[78:79], v[222:223]
    v_pk_add_f32 v[216:217], v[216:217], v[80:81]
    v_pk_fma_f32 v[220:221], v[80:81], v[80:81], v[220:221]
    v_pk_add_f32 v[218:219], v[218:219], v[82:83]
    v_pk_fma_f32 v[222:223], v[82:83], v[82:83], v[222:223]
    v_pk_add_f32 v[216:217], v[216:217], v[84:85]
    v_pk_fma_f32 v[220:221], v[84:85], v[84:85], v[220:221]
    v_pk_add_f32 v[218:219], v[218:219], v[86:87]
    v_pk_fma_f32 v[222:223], v[86:87], v[86:87], v[222:223]
    v_pk_add_f32 v[216:217], v[216:217], v[88:89]
    v_pk_fma_f32 v[220:221], v[88:89], v[88:89], v[220:221]
    v_pk_add_f32 v[218:219], v[218:219], v[90:91]
    v_pk_fma_f32 v[222:223], v[90:91], v[90:91], v[222:223]
    v_pk_add_f32 v[216:217], v[216:217], v[92:93]
    v_pk_fma_f32 v[220:221], v[92:93], v[92:93], v[220:221]
    v_pk_add_f32 v[218:219], v[218:219], v[94:95]
    v_pk_fma_f32 v[222:223], v[94:95], v[94:95], v[222:223]
    v_pk_add_f32 v[216:217], v[216:217], v[96:97]
    v_pk_fma_f32 v[220:221], v[96:97], v[96:97], v[220:221]
    v_pk_add_f32 v[218:219], v[218:219], v[98:99]
    v_pk_fma_f32 v[222:223], v[98:99], v[98:99], v[222:223]
    v_add_f32_dpp v216, v216, v216 row_ror:8 row_mask:0xf bank_mask:0xf
    v_add_f32_dpp v217, v217, v217 row_ror:8 row_mask:0xf bank_mask:0xf
    v_add_f32_dpp v218, v218, v218 row_ror:8 row_mask:0xf bank_mask:0xf
    v_add_f32_dpp v219, v219, v219 row_ror:8 row_mask:0xf bank_mask:0xf
    v_add_f32_dpp v220, v220, v220 row_ror:8 row_mask:0xf bank_mask:0xf
    v_add_f32_dpp v221, v221, v221 row_ror:8 row_mask:0xf bank_mask:0xf
    v_add_f32_dpp v222, v222, v222 row_ror:8 row_mask:0xf bank_mask:0xf
    v_add_f32_dpp v223, v223, v223 row_ror:8 row_mask:0xf bank_mask:0xf
    v_add_f32_dpp v216, v216, v216 row_ror:4 row_mask:0xf bank_mask:0xf
    v_add_f32_dpp v217, v217, v217 row_ror:4 row_mask:0xf bank_mask:0xf
    v_add_f32_dpp v218, v218, v218 row_ror:4 row_mask:0xf bank_mask:0xf
    v_add_f32_dpp v219, v219, v219 row_ror:4 row_mask:0xf bank_mask:0xf
    v_add_f32_dpp v220, v220, v220 row_ror:4 row_mask:0xf bank_mask:0xf
    v_add_f32_dpp v221, v221, v221 row_ror:4 row_mask:0xf bank_mask:0xf
    v_add_f32_dpp v222, v222, v222 row_ror:4 row_mask:0xf bank_mask:0xf
    v_add_f32_dpp v223, v223, v223 row_ror:4 row_mask:0xf bank_mask:0xf
    v_add_f32_dpp v216, v216, v216 row_ror:2 row_mask:0xf bank_mask:0xf
    v_add_f32_dpp v217, v217, v217 row_ror:2 row_mask:0xf bank_mask:0xf
    v_add_f32_dpp v218, v218, v218 row_ror:2 row_mask:0xf bank_mask:0xf
    v_add_f32_dpp v219, v219, v219 row_ror:2 row_mask:0xf bank_mask:0xf
    v_add_f32_dpp v220, v220, v220 row_ror:2 row_mask:0xf bank_mask:0xf
    v_add_f32_dpp v221, v221, v221 row_ror:2 row_mask:0xf bank_mask:0xf
    v_add_f32_dpp v222, v222, v222 row_ror:2 row_mask:0xf bank_mask:0xf
    v_add_f32_dpp v223, v223, v223 row_ror:2 row_mask:0xf bank_mask:0xf
    v_add_f32_dpp v216, v216, v216 row_ror:1 row_mask:0xf bank_mask:0xf
    v_add_f32_dpp v217, v217, v217 row_ror:1 row_mask:0xf bank_mask:0xf
    v_add_f32_dpp v218, v218, v218 row_ror:1 row_mask:0xf bank_mask:0xf
    v_add_f32_dpp v219, v219, v219 row_ror:1 row_mask:0xf bank_mask:0xf
    v_add_f32_dpp v220, v220, v220 row_ror:1 row_mask:0xf bank_mask:0xf
    v_add_f32_dpp v221, v221, v221 row_ror:1 row_mask:0xf bank_mask:0xf
    v_add_f32_dpp v222, v222, v222 row_ror:1 row_mask:0xf bank_mask:0xf
    v_add_f32_dpp v223, v223, v223 row_ror:1 row_mask:0xf bank_mask:0xf
    v_cndmask_b32 v216, v216, v217, s[66:67]
    v_cndmask_b32 v220, v220, v221, s[66:67]
    v_cndmask_b32 v216, v216, v218, s[78:79]
    v_cndmask_b32 v220, v220, v222, s[78:79]
    v_cndmask_b32 v216, v216, v219, vcc
    v_cndmask_b32 v220, v220, v223, vcc
    v_mov_b32 v217, s45
    v_mov_b32 v218, v220
    v_mov_b32 v219, s45
    buffer_store_dwordx4 v[216:219], v232, s[36:39], s73 offen sc1
    s_add_u32 s73, s72, 4096
    s_waitcnt vmcnt(10)
    ds_read_b128 a[8:11], v14 offset:0
    ds_read_b128 a[24:27], v15 offset:0
    ds_read_b128 a[72:75], v14 offset:1024
    ds_read_b128 a[88:91], v15 offset:1024
    ds_read_b128 a[136:139], v14 offset:2048
    ds_read_b128 a[152:155], v15 offset:2048
    ds_read_b128 a[200:203], v14 offset:3072
    ds_read_b128 a[216:219], v15 offset:3072
    s_waitcnt lgkmcnt(0)
    s_barrier
    ds_read_b128 v[128:131], v4 offset:0
    ds_read_b128 v[132:135], v4 offset:1024
    ds_read_b128 v[136:139], v4 offset:2048
    ds_read_b128 v[140:143], v4 offset:3072
    ds_read_b128 v[144:147], v4 offset:4096
    ds_read_b128 v[148:151], v4 offset:5120
    ds_read_b128 v[152:155], v4 offset:6144
    ds_read_b128 v[156:159], v4 offset:7168
    s_waitcnt lgkmcnt(6)
    v_mfma_f32_16x16x32_bf16 v[104:107], v[132:135], v[16:19], 0
    v_mfma_f32_16x16x32_bf16 v[100:103], v[128:131], v[16:19], 0
    s_add_u32 m0, s63, 65536
    s_add_u32 s62, s62, 4096
    buffer_load_dwordx4 v2, s[36:39], s62 offen offset:0 sc1 lds
    ds_read_b128 v[128:131], v4 offset:8192
    ds_read_b128 v[132:135], v4 offset:9216
    s_waitcnt lgkmcnt(6)
    v_mfma_f32_16x16x32_bf16 v[112:115], v[140:143], v[16:19], 0
    v_mfma_f32_16x16x32_bf16 v[108:111], v[136:139], v[16:19], 0
    buffer_load_dwordx4 v2, s[36:39], s62 offen offset:1024 sc1 lds
    ds_read_b128 v[136:139], v4 offset:10240
    ds_read_b128 v[140:143], v4 offset:11264
    s_waitcnt lgkmcnt(6)
    v_mfma_f32_16x16x32_bf16 v[120:123], v[148:151], v[16:19], 0
    v_mfma_f32_16x16x32_bf16 v[116:119], v[144:147], v[16:19], 0
    buffer_load_dwordx4 v2, s[36:39], s62 offen offset:2048 sc1 lds
    ds_read_b128 v[144:147], v4 offset:12288
    ds_read_b128 v[148:151], v4 offset:13312
    s_waitcnt lgkmcnt(6)
    v_mfma_f32_16x16x32_bf16 v[100:103], v[156:159], v[20:23], v[100:103]
    v_mfma_f32_16x16x32_bf16 v[124:127], v[152:155], v[16:19], 0
    s_add_u32 s58, s40, 3
    s_and_b32 s58, s58, 3
    s_lshl_b32 s58, s58, 8
    s_add_u32 s58, s58, s40
    s_lshl_b32 s58, s58, 8
    s_lshl_b32 s59, s41, 18
    s_add_u32 s58, s58, s59
    s_and_b32 s59, s70, 2
    s_lshl_b32 s59, s59, 6
    s_add_u32 s58, s58, s59
    s_xor_b32 s58, s58, 128
    s_add_u32 m0, s60, 0
    s_nop 0
    buffer_load_dwordx4 v12, s[20:23], s58 offen offset:0 lds
    ds_read_b128 v[152:155], v4 offset:14336
    ds_read_b128 v[156:159], v4 offset:15360
    s_waitcnt lgkmcnt(6)
    v_mfma_f32_16x16x32_bf16 v[108:111], v[132:135], v[20:23], v[108:111]
    v_mfma_f32_16x16x32_bf16 v[104:107], v[128:131], v[20:23], v[104:107]
    buffer_load_dwordx4 v12, s[20:23], s58 offen offset:1024 lds
    ds_read_b128 v[128:131], v4 offset:16384
    ds_read_b128 v[132:135], v4 offset:17408
    s_waitcnt lgkmcnt(6)
    v_mfma_f32_16x16x32_bf16 v[116:119], v[140:143], v[20:23], v[116:119]
    v_mfma_f32_16x16x32_bf16 v[112:115], v[136:139], v[20:23], v[112:115]
    buffer_load_dwordx4 v12, s[20:23], s58 offen offset:2048 lds
    ds_read_b128 v[136:139], v4 offset:18432
    ds_read_b128 v[140:143], v4 offset:19456
    s_waitcnt lgkmcnt(6)
    v_mfma_f32_16x16x32_bf16 v[124:127], v[148:151], v[20:23], v[124:127]
    v_mfma_f32_16x16x32_bf16 v[120:123], v[144:147], v[20:23], v[120:123]
    buffer_load_dwordx4 v12, s[20:23], s58 offen offset:3072 lds
    ds_read_b128 v[144:147], v4 offset:20480
    ds_read_b128 v[148:151], v4 offset:21504
    s_waitcnt lgkmcnt(6)
    v_mfma_f32_16x16x32_bf16 v[104:107], v[156:159], v[24:27], v[104:107]
    v_mfma_f32_16x16x32_bf16 v[100:103], v[152:155], v[24:27], v[100:103]
    s_add_u32 m0, s60, 4096
    s_nop 0
    buffer_load_dwordx4 v13, s[20:23], s58 offen offset:0 lds
    ds_read_b128 v[152:155], v4 offset:22528
    ds_read_b128 v[156:159], v4 offset:23552
    s_waitcnt lgkmcnt(6)
    v_mfma_f32_16x16x32_bf16 v[112:115], v[132:135], v[24:27], v[112:115]
    v_mfma_f32_16x16x32_bf16 v[108:111], v[128:131], v[24:27], v[108:111]
    buffer_load_dwordx4 v13, s[20:23], s58 offen offset:1024 lds
    ds_read_b128 v[128:131], v4 offset:24576
    ds_read_b128 v[132:135], v4 offset:25600
    s_waitcnt lgkmcnt(6)
    v_mfma_f32_16x16x32_bf16 v[120:123], v[140:143], v[24:27], v[120:123]
    v_mfma_f32_16x16x32_bf16 v[116:119], v[136:139], v[24:27], v[116:119]
    buffer_load_dwordx4 v13, s[20:23], s58 offen offset:2048 lds
    ds_read_b128 v[136:139], v4 offset:26624
    ds_read_b128 v[140:143], v4 offset:27648
    s_waitcnt lgkmcnt(6)
    v_mfma_f32_16x16x32_bf16 v[100:103], v[148:151], v[28:31], v[100:103]
    v_mfma_f32_16x16x32_bf16 v[124:127], v[144:147], v[24:27], v[124:127]
    buffer_load_dwordx4 v13, s[20:23], s58 offen offset:3072 lds
    ds_read_b128 v[144:147], v4 offset:28672
    ds_read_b128 v[148:151], v4 offset:29696
    s_waitcnt lgkmcnt(6)
    v_mfma_f32_16x16x32_bf16 v[108:111], v[156:159], v[28:31], v[108:111]
    v_mfma_f32_16x16x32_bf16 v[104:107], v[152:155], v[28:31], v[104:107]
    buffer_load_dwordx4 v[224:227], v233, s[36:39], s72 offen sc1
    buffer_load_dwordx4 v[220:223], v233, s[36:39], s73 offen sc1
    ds_read_b128 v[152:155], v4 offset:30720
    ds_read_b128 v[156:159], v4 offset:31744
    s_waitcnt lgkmcnt(6)
    v_mfma_f32_16x16x32_bf16 v[116:119], v[132:135], v[28:31], v[116:119]
    v_mfma_f32_16x16x32_bf16 v[112:115], v[128:131], v[28:31], v[112:115]
    ds_read_b128 v[128:131], v4 offset:32768
    ds_read_b128 v[132:135], v4 offset:33792
    s_waitcnt lgkmcnt(6)
    v_mfma_f32_16x16x32_bf16 v[124:127], v[140:143], v[28:31], v[124:127]
    v_mfma_f32_16x16x32_bf16 v[120:123], v[136:139], v[28:31], v[120:123]
    ds_read_b128 v[136:139], v4 offset:34816
    ds_read_b128 v[140:143], v4 offset:35840
    s_waitcnt lgkmcnt(6)
    v_mfma_f32_16x16x32_bf16 v[104:107], v[148:151], v[32:35], v[104:107]
    v_mfma_f32_16x16x32_bf16 v[100:103], v[144:147], v[32:35], v[100:103]
    ds_read_b128 v[144:147], v4 offset:36864
    ds_read_b128 v[148:151], v4 offset:37888
    s_waitcnt lgkmcnt(6)
    v_mfma_f32_16x16x32_bf16 v[112:115], v[156:159], v[32:35], v[112:115]
    v_mfma_f32_16x16x32_bf16 v[108:111], v[152:155], v[32:35], v[108:111]
    ds_read_b128 v[152:155], v4 offset:38912
    ds_read_b128 v[156:159], v4 offset:39936
    s_waitcnt lgkmcnt(6)
    v_mfma_f32_16x16x32_bf16 v[120:123], v[132:135], v[32:35], v[120:123]
    v_mfma_f32_16x16x32_bf16 v[116:119], v[128:131], v[32:35], v[116:119]
    s_waitcnt lgkmcnt(4)
    v_mfma_f32_16x16x32_bf16 v[100:103], v[140:143], v[36:39], v[100:103]
    v_mfma_f32_16x16x32_bf16 v[124:127], v[136:139], v[32:35], v[124:127]
    s_waitcnt lgkmcnt(2)
    v_mfma_f32_16x16x32_bf16 v[108:111], v[148:151], v[36:39], v[108:111]
    v_mfma_f32_16x16x32_bf16 v[104:107], v[144:147], v[36:39], v[104:107]
    s_waitcnt lgkmcnt(0)
    v_mfma_f32_16x16x32_bf16 v[116:119], v[156:159], v[36:39], v[116:119]
    v_mfma_f32_16x16x32_bf16 v[112:115], v[152:155], v[36:39], v[112:115]
    s_mov_b32 s48, 0
    s_branch L_stc_35
L_st_34:
    buffer_load_dwordx4 v[224:227], v233, s[36:39], s72 offen sc1
    buffer_load_dwordx4 v[220:223], v233, s[36:39], s73 offen sc1
L_stc_35:
    s_add_u32 s48, s48, 1
    s_cmp_gt_u32 s48, 0x80000
    s_waitcnt vmcnt(0)
    s_cbranch_scc1 L_std_36
    v_xor_b32 v216, s45, v225
    v_xor_b32 v217, s45, v227
    v_xor_b32 v218, s45, v221
    v_xor_b32 v219, s45, v223
    v_or3_b32 v216, v216, v217, v218
    v_or_b32 v216, v216, v219
    v_cmp_ne_u32 vcc, 0, v216
    s_nop 1
    s_cbranch_vccnz L_st_34
L_std_36:
    v_add_f32 v216, v224, v220
    v_add_f32 v218, v226, v222
    s_nop 1
    v_permlane16_swap_b32 v216, v218
    v_add_f32 v216, v216, v218
    v_mov_b32 v217, v216
    s_nop 1
    v_permlane32_swap_b32 v216, v217
    v_add_f32 v216, v216, v217
    v_mov_b32 v217, v216
    s_nop 1
    v_permlane16_swap_b32 v216, v217
    v_mul_f32 v216, 0x3a924925, v216
    v_mul_f32 v217, 0x3a924925, v217
    v_fma_f32 v217, -v216, v216, v217
    v_max_f32 v217, 0, v217
    v_add_f32 v217, 0x3727c5ac, v217
    v_rsq_f32 v220, v217
    s_nop 0
    v_mul_f32 v221, v216, v220
    v_sub_f32 v221, 0, v221
    ds_bpermute_b32 v204, v5, v220 offset:0
    ds_bpermute_b32 v208, v5, v221 offset:0
    ds_bpermute_b32 v205, v5, v220 offset:4
    ds_bpermute_b32 v209, v5, v221 offset:4
    ds_bpermute_b32 v206, v5, v220 offset:8
    ds_bpermute_b32 v210, v5, v221 offset:8
    ds_bpermute_b32 v207, v5, v220 offset:12
    ds_bpermute_b32 v211, v5, v221 offset:12
    s_waitcnt lgkmcnt(4)
    v_pk_fma_f32 v[72:73], v[72:73], v[204:205], v[208:209]
    s_waitcnt lgkmcnt(0)
    v_pk_fma_f32 v[74:75], v[74:75], v[206:207], v[210:211]
    v_pk_fma_f32 v[76:77], v[76:77], v[204:205], v[208:209]
    v_pk_fma_f32 v[78:79], v[78:79], v[206:207], v[210:211]
    v_cvt_pk_bf16_f32 v188, v72, v73
    v_cvt_pk_bf16_f32 v189, v74, v75
    v_cvt_pk_bf16_f32 v190, v76, v77
    v_cvt_pk_bf16_f32 v191, v78, v79
    s_nop 0
    v_permlane16_swap_b32 v188, v190
    v_permlane16_swap_b32 v189, v191
    buffer_store_dwordx4 v[188:191], v234, s[36:39], s74 offen offset:0 sc1
    v_pk_fma_f32 v[80:81], v[80:81], v[204:205], v[208:209]
    v_pk_fma_f32 v[82:83], v[82:83], v[206:207], v[210:211]
    v_pk_fma_f32 v[84:85], v[84:85], v[204:205], v[208:209]
    v_pk_fma_f32 v[86:87], v[86:87], v[206:207], v[210:211]
    v_cvt_pk_bf16_f32 v192, v80, v81
    v_cvt_pk_bf16_f32 v193, v82, v83
    v_cvt_pk_bf16_f32 v194, v84, v85
    v_cvt_pk_bf16_f32 v195, v86, v87
    s_nop 0
    v_permlane16_swap_b32 v192, v194
    v_permlane16_swap_b32 v193, v195
    buffer_store_dwordx4 v[192:195], v234, s[36:39], s74 offen offset:2048 sc1
    v_pk_fma_f32 v[88:89], v[88:89], v[204:205], v[208:209]
    v_pk_fma_f32 v[90:91], v[90:91], v[206:207], v[210:211]
    v_pk_fma_f32 v[92:93], v[92:93], v[204:205], v[208:209]
    v_pk_fma_f32 v[94:95], v[94:95], v[206:207], v[210:211]
    v_cvt_pk_bf16_f32 v196, v88, v89
    v_cvt_pk_bf16_f32 v197, v90, v91
    v_cvt_pk_bf16_f32 v198, v92, v93
    v_cvt_pk_bf16_f32 v199, v94, v95
    s_nop 0
    v_permlane16_swap_b32 v196, v198
    v_permlane16_swap_b32 v197, v199
    buffer_store_dwordx4 v[196:199], v234, s[36:39], s75 offen offset:0 sc1
    v_pk_fma_f32 v[96:97], v[96:97], v[204:205], v[208:209]
    v_pk_fma_f32 v[98:99], v[98:99], v[206:207], v[210:211]
    v_cvt_pk_bf16_f32 v200, v96, v97
    v_cvt_pk_bf16_f32 v201, v98, v99
    buffer_store_dwordx2 v[200:201], v235, s[36:39], s75 offen offset:2048 sc1
    ds_read_b128 a[40:43], v14 offset:0
    ds_read_b128 a[56:59], v15 offset:0
    ds_read_b128 a[104:107], v14 offset:1024
    ds_read_b128 a[120:123], v15 offset:1024
    ds_read_b128 a[168:171], v14 offset:2048
    ds_read_b128 a[184:187], v15 offset:2048
    ds_read_b128 a[232:235], v14 offset:3072
    ds_read_b128 a[248:251], v15 offset:3072
    s_waitcnt lgkmcnt(0)
    s_barrier
    s_lshl_b32 s61, s40, 13
    ds_read_b128 v[128:131], v4 offset:40960
    ds_read_b128 v[132:135], v4 offset:41984
    ds_read_b128 v[136:139], v4 offset:43008
    ds_read_b128 v[140:143], v4 offset:44032
    ds_read_b128 v[144:147], v4 offset:45056
    ds_read_b128 v[148:151], v4 offset:46080
    ds_read_b128 v[152:155], v4 offset:47104
    ds_read_b128 v[156:159], v4 offset:48128
    s_waitcnt lgkmcnt(6)
    v_mfma_f32_16x16x32_bf16 v[124:127], v[132:135], v[36:39], v[124:127]
    v_mfma_f32_16x16x32_bf16 v[120:123], v[128:131], v[36:39], v[120:123]
    ds_read_b128 v[128:131], v4 offset:49152
    ds_read_b128 v[132:135], v4 offset:50176
    s_waitcnt lgkmcnt(6)
    v_mfma_f32_16x16x32_bf16 v[104:107], v[140:143], v[40:43], v[104:107]
    v_mfma_f32_16x16x32_bf16 v[100:103], v[136:139], v[40:43], v[100:103]
    buffer_load_dwordx4 v[160:163], v5, s[36:39], s55 offen offset:0 sc1
    ds_read_b128 v[136:139], v4 offset:51200
    ds_read_b128 v[140:143], v4 offset:52224
    s_waitcnt lgkmcnt(6)
    v_mfma_f32_16x16x32_bf16 v[112:115], v[148:151], v[40:43], v[112:115]
    v_mfma_f32_16x16x32_bf16 v[108:111], v[144:147], v[40:43], v[108:111]
    ds_read_b128 v[144:147], v4 offset:53248
    ds_read_b128 v[148:151], v4 offset:54272
    s_waitcnt lgkmcnt(6)
    v_mfma_f32_16x16x32_bf16 v[120:123], v[156:159], v[40:43], v[120:123]
    v_mfma_f32_16x16x32_bf16 v[116:119], v[152:155], v[40:43], v[116:119]
    buffer_load_dwordx4 v[164:167], v5, s[36:39], s55 offen offset:64 sc1
    ds_read_b128 v[152:155], v4 offset:55296
    ds_read_b128 v[156:159], v4 offset:56320
    s_waitcnt lgkmcnt(6)
    v_mfma_f32_16x16x32_bf16 v[100:103], v[132:135], v[44:47], v[100:103]
    v_mfma_f32_16x16x32_bf16 v[124:127], v[128:131], v[40:43], v[124:127]
    ds_read_b128 v[128:131], v6 offset:0
    ds_read_b128 v[132:135], v6 offset:1024
    s_waitcnt lgkmcnt(6)
    v_mfma_f32_16x16x32_bf16 v[108:111], v[140:143], v[44:47], v[108:111]
    v_mfma_f32_16x16x32_bf16 v[104:107], v[136:139], v[44:47], v[104:107]
    buffer_load_dwordx4 v[168:171], v5, s[36:39], s55 offen offset:128 sc1
    ds_read_b128 v[136:139], v6 offset:2048
    ds_read_b128 v[140:143], v6 offset:3072
    s_waitcnt lgkmcnt(6)
    v_mfma_f32_16x16x32_bf16 v[116:119], v[148:151], v[44:47], v[116:119]
    v_mfma_f32_16x16x32_bf16 v[112:115], v[144:147], v[44:47], v[112:115]
    s_waitcnt lgkmcnt(4)
    v_mfma_f32_16x16x32_bf16 v[124:127], v[156:159], v[44:47], v[124:127]
    v_mfma_f32_16x16x32_bf16 v[120:123], v[152:155], v[44:47], v[120:123]
    buffer_load_dwordx4 v[172:175], v5, s[36:39], s55 offen offset:192 sc1
    s_waitcnt lgkmcnt(2)
    v_mfma_f32_16x16x32_bf16 v[104:107], v[132:135], v[48:51], v[104:107]
    v_mfma_f32_16x16x32_bf16 v[100:103], v[128:131], v[48:51], v[100:103]
    s_waitcnt lgkmcnt(0)
    v_mfma_f32_16x16x32_bf16 v[112:115], v[140:143], v[48:51], v[112:115]
    v_mfma_f32_16x16x32_bf16 v[108:111], v[136:139], v[48:51], v[108:111]
    s_waitcnt vmcnt(4)
    s_barrier
    s_cmp_lg_u32 s40, 0
    s_cbranch_scc1 L_sig_37
    v_mov_b32 v220, s45
    v_mov_b32 v221, 0
    s_mov_b64 exec, 1
    buffer_store_dword v220, v221, s[36:39], s76 offen sc1
    s_mov_b64 exec, -1
L_sig_37:
    ds_read_b128 v[128:131], v6 offset:4096
    ds_read_b128 v[132:135], v6 offset:5120
    ds_read_b128 v[136:139], v6 offset:6144
    ds_read_b128 v[140:143], v6 offset:7168
    ds_read_b128 v[144:147], v6 offset:8192
    ds_read_b128 v[148:151], v6 offset:9216
    ds_read_b128 v[152:155], v6 offset:10240
    ds_read_b128 v[156:159], v6 offset:11264
    s_waitcnt lgkmcnt(6)
    v_mfma_f32_16x16x32_bf16 v[120:123], v[132:135], v[48:51], v[120:123]
    v_mfma_f32_16x16x32_bf16 v[116:119], v[128:131], v[48:51], v[116:119]
    ds_read_b128 v[128:131], v6 offset:12288
    ds_read_b128 v[132:135], v6 offset:13312
    s_waitcnt lgkmcnt(6)
    v_mfma_f32_16x16x32_bf16 v[100:103], v[140:143], v[52:55], v[100:103]
    v_mfma_f32_16x16x32_bf16 v[124:127], v[136:139], v[48:51], v[124:127]
    buffer_load_dwordx4 v[176:179], v5, s[36:39], s55 offen offset:256 sc1
    ds_read_b128 v[136:139], v6 offset:14336
    ds_read_b128 v[140:143], v6 offset:15360
    s_waitcnt lgkmcnt(6)
    v_mfma_f32_16x16x32_bf16 v[108:111], v[148:151], v[52:55], v[108:111]
    v_mfma_f32_16x16x32_bf16 v[104:107], v[144:147], v[52:55], v[104:107]
    ds_read_b128 v[144:147], v6 offset:16384
    ds_read_b128 v[148:151], v6 offset:17408
    s_waitcnt lgkmcnt(6)
    v_mfma_f32_16x16x32_bf16 v[116:119], v[156:159], v[52:55], v[116:119]
    v_mfma_f32_16x16x32_bf16 v[112:115], v[152:155], v[52:55], v[112:115]
    buffer_load_dwordx4 v[180:183], v5, s[36:39], s55 offen offset:320 sc1
    ds_read_b128 v[152:155], v6 offset:18432
    ds_read_b128 v[156:159], v6 offset:19456
    s_waitcnt lgkmcnt(6)
    v_mfma_f32_16x16x32_bf16 v[124:127], v[132:135], v[52:55], v[124:127]
    v_mfma_f32_16x16x32_bf16 v[120:123], v[128:131], v[52:55], v[120:123]
    ds_read_b128 v[128:131], v6 offset:20480
    ds_read_b128 v[132:135], v6 offset:21504
    s_waitcnt lgkmcnt(6)
    v_mfma_f32_16x16x32_bf16 v[104:107], v[140:143], v[56:59], v[104:107]
    v_mfma_f32_16x16x32_bf16 v[100:103], v[136:139], v[56:59], v[100:103]
    buffer_load_dwordx4 v[184:187], v5, s[36:39], s55 offen offset:384 sc1
    ds_read_b128 v[136:139], v6 offset:22528
    ds_read_b128 v[140:143], v6 offset:23552
    s_waitcnt lgkmcnt(6)
    v_mfma_f32_16x16x32_bf16 v[112:115], v[148:151], v[56:59], v[112:115]
    v_mfma_f32_16x16x32_bf16 v[108:111], v[144:147], v[56:59], v[108:111]
    ds_read_b128 v[144:147], v6 offset:24576
    ds_read_b128 v[148:151], v6 offset:25600
    s_waitcnt lgkmcnt(6)
    v_mfma_f32_16x16x32_bf16 v[120:123], v[156:159], v[56:59], v[120:123]
    v_mfma_f32_16x16x32_bf16 v[116:119], v[152:155], v[56:59], v[116:119]
    s_add_u32 s58, s40, 4
    s_and_b32 s58, s58, 3
    s_lshl_b32 s58, s58, 8
    s_add_u32 s58, s58, s40
    s_lshl_b32 s58, s58, 8
    s_lshl_b32 s59, s41, 18
    s_add_u32 s58, s58, s59
    s_and_b32 s59, s70, 2
    s_lshl_b32 s59, s59, 6
    s_add_u32 s58, s58, s59
    s_add_u32 m0, s60, 0
    s_nop 0
    buffer_load_dwordx4 v12, s[20:23], s58 offen offset:0 lds
    ds_read_b128 v[152:155], v6 offset:26624
    ds_read_b128 v[156:159], v6 offset:27648
    s_waitcnt lgkmcnt(6)
    v_mfma_f32_16x16x32_bf16 v[100:103], v[132:135], v[60:63], v[100:103]
    v_mfma_f32_16x16x32_bf16 v[124:127], v[128:131], v[56:59], v[124:127]
    ds_read_b128 v[128:131], v6 offset:28672
    ds_read_b128 v[132:135], v6 offset:29696
    s_waitcnt lgkmcnt(6)
    v_mfma_f32_16x16x32_bf16 v[108:111], v[140:143], v[60:63], v[108:111]
    v_mfma_f32_16x16x32_bf16 v[104:107], v[136:139], v[60:63], v[104:107]
    buffer_load_dwordx4 v12, s[20:23], s58 offen offset:1024 lds
    ds_read_b128 v[136:139], v6 offset:30720
    ds_read_b128 v[140:143], v6 offset:31744
    s_waitcnt lgkmcnt(6)
    v_mfma_f32_16x16x32_bf16 v[116:119], v[148:151], v[60:63], v[116:119]
    v_mfma_f32_16x16x32_bf16 v[112:115], v[144:147], v[60:63], v[112:115]
    ds_read_b128 v[144:147], v6 offset:32768
    ds_read_b128 v[148:151], v6 offset:33792
    s_waitcnt lgkmcnt(6)
    v_mfma_f32_16x16x32_bf16 v[124:127], v[156:159], v[60:63], v[124:127]
    v_mfma_f32_16x16x32_bf16 v[120:123], v[152:155], v[60:63], v[120:123]
    buffer_load_dwordx4 v12, s[20:23], s58 offen offset:2048 lds
    ds_read_b128 v[152:155], v6 offset:34816
    ds_read_b128 v[156:159], v6 offset:35840
    s_waitcnt lgkmcnt(6)
    v_mfma_f32_16x16x32_bf16 v[104:107], v[132:135], v[64:67], v[104:107]
    v_mfma_f32_16x16x32_bf16 v[100:103], v[128:131], v[64:67], v[100:103]
    ds_read_b128 v[128:131], v6 offset:36864
    ds_read_b128 v[132:135], v6 offset:37888
    s_waitcnt lgkmcnt(6)
    v_mfma_f32_16x16x32_bf16 v[112:115], v[140:143], v[64:67], v[112:115]
    v_mfma_f32_16x16x32_bf16 v[108:111], v[136:139], v[64:67], v[108:111]
    buffer_load_dwordx4 v12, s[20:23], s58 offen offset:3072 lds
    ds_read_b128 v[136:139], v6 offset:38912
    ds_read_b128 v[140:143], v6 offset:39936
    s_waitcnt lgkmcnt(6)
    v_mfma_f32_16x16x32_bf16 v[120:123], v[148:151], v[64:67], v[120:123]
    v_mfma_f32_16x16x32_bf16 v[116:119], v[144:147], v[64:67], v[116:119]
    ds_read_b128 v[144:147], v6 offset:40960
    ds_read_b128 v[148:151], v6 offset:41984
    s_waitcnt lgkmcnt(6)
    v_mfma_f32_16x16x32_bf16 v[100:103], v[156:159], v[68:71], v[100:103]
    v_mfma_f32_16x16x32_bf16 v[124:127], v[152:155], v[64:67], v[124:127]
    s_add_u32 m0, s60, 4096
    s_nop 0
    buffer_load_dwordx4 v13, s[20:23], s58 offen offset:0 lds
    s_waitcnt lgkmcnt(4)
    v_mfma_f32_16x16x32_bf16 v[108:111], v[132:135], v[68:71], v[108:111]
    v_mfma_f32_16x16x32_bf16 v[104:107], v[128:131], v[68:71], v[104:107]
    s_waitcnt lgkmcnt(2)
    v_mfma_f32_16x16x32_bf16 v[116:119], v[140:143], v[68:71], v[116:119]
    v_mfma_f32_16x16x32_bf16 v[112:115], v[136:139], v[68:71], v[112:115]
    buffer_load_dwordx4 v13, s[20:23], s58 offen offset:1024 lds
    s_waitcnt lgkmcnt(0)
    v_mfma_f32_16x16x32_bf16 v[124:127], v[148:151], v[68:71], v[124:127]
    v_mfma_f32_16x16x32_bf16 v[120:123], v[144:147], v[68:71], v[120:123]
    buffer_load_dwordx4 v13, s[20:23], s58 offen offset:2048 lds
    buffer_load_dwordx4 v13, s[20:23], s58 offen offset:3072 lds
    s_add_u32 s58, s40, 4
    s_and_b32 s58, s58, 3
    s_lshl_b32 s58, s58, 8
    s_add_u32 s58, s58, s40
    s_lshl_b32 s58, s58, 8
    s_lshl_b32 s59, s41, 18
    s_add_u32 s58, s58, s59
    s_and_b32 s59, s70, 2
    s_lshl_b32 s59, s59, 6
    s_add_u32 s58, s58, s59
    s_xor_b32 s58, s58, 128
    s_add_u32 m0, s61, 0
    s_nop 0
    buffer_load_dwordx4 v12, s[20:23], s58 offen offset:0 lds
    buffer_load_dwordx4 v12, s[20:23], s58 offen offset:1024 lds
    buffer_load_dwordx4 v12, s[20:23], s58 offen offset:2048 lds
    buffer_load_dwordx4 v12, s[20:23], s58 offen offset:3072 lds
    s_add_u32 m0, s61, 4096
    s_nop 0
    buffer_load_dwordx4 v13, s[20:23], s58 offen offset:0 lds
    buffer_load_dwordx4 v13, s[20:23], s58 offen offset:1024 lds
    buffer_load_dwordx4 v13, s[20:23], s58 offen offset:2048 lds
    buffer_load_dwordx4 v13, s[20:23], s58 offen offset:3072 lds
    s_sub_u32 s55, s61, s60
    v_add_u32 v12, s55, v14
    v_add_u32 v13, s55, v15
    s_waitcnt vmcnt(22)
    v_pk_mul_f32 v[160:161], v[160:161], v[212:213] op_sel:[0,1] op_sel_hi:[1,1]
    v_pk_fma_f32 v[100:101], v[100:101], v[212:213], v[160:161] op_sel_hi:[1,0,1]
    v_pk_mul_f32 v[162:163], v[162:163], v[212:213] op_sel:[0,1] op_sel_hi:[1,1]
    v_pk_fma_f32 v[102:103], v[102:103], v[212:213], v[162:163] op_sel_hi:[1,0,1]
    s_waitcnt vmcnt(21)
    v_pk_mul_f32 v[164:165], v[164:165], v[212:213] op_sel:[0,1] op_sel_hi:[1,1]
    v_pk_fma_f32 v[104:105], v[104:105], v[212:213], v[164:165] op_sel_hi:[1,0,1]
    v_pk_mul_f32 v[166:167], v[166:167], v[212:213] op_sel:[0,1] op_sel_hi:[1,1]
    v_pk_fma_f32 v[106:107], v[106:107], v[212:213], v[166:167] op_sel_hi:[1,0,1]
    s_waitcnt vmcnt(20)
    v_pk_mul_f32 v[168:169], v[168:169], v[212:213] op_sel:[0,1] op_sel_hi:[1,1]
    v_pk_fma_f32 v[108:109], v[108:109], v[212:213], v[168:169] op_sel_hi:[1,0,1]
    v_pk_mul_f32 v[170:171], v[170:171], v[212:213] op_sel:[0,1] op_sel_hi:[1,1]
    v_pk_fma_f32 v[110:111], v[110:111], v[212:213], v[170:171] op_sel_hi:[1,0,1]
    s_waitcnt vmcnt(19)
    v_pk_mul_f32 v[172:173], v[172:173], v[212:213] op_sel:[0,1] op_sel_hi:[1,1]
    v_pk_fma_f32 v[112:113], v[112:113], v[212:213], v[172:173] op_sel_hi:[1,0,1]
    v_pk_mul_f32 v[174:175], v[174:175], v[212:213] op_sel:[0,1] op_sel_hi:[1,1]
    v_pk_fma_f32 v[114:115], v[114:115], v[212:213], v[174:175] op_sel_hi:[1,0,1]
    s_waitcnt vmcnt(18)
    v_pk_mul_f32 v[176:177], v[176:177], v[212:213] op_sel:[0,1] op_sel_hi:[1,1]
    v_pk_fma_f32 v[116:117], v[116:117], v[212:213], v[176:177] op_sel_hi:[1,0,1]
    v_pk_mul_f32 v[178:179], v[178:179], v[212:213] op_sel:[0,1] op_sel_hi:[1,1]
    v_pk_fma_f32 v[118:119], v[118:119], v[212:213], v[178:179] op_sel_hi:[1,0,1]
    s_waitcnt vmcnt(17)
    v_pk_mul_f32 v[180:181], v[180:181], v[212:213] op_sel:[0,1] op_sel_hi:[1,1]
    v_pk_fma_f32 v[120:121], v[120:121], v[212:213], v[180:181] op_sel_hi:[1,0,1]
    v_pk_mul_f32 v[182:183], v[182:183], v[212:213] op_sel:[0,1] op_sel_hi:[1,1]
    v_pk_fma_f32 v[122:123], v[122:123], v[212:213], v[182:183] op_sel_hi:[1,0,1]
    s_waitcnt vmcnt(16)
    v_pk_mul_f32 v[184:185], v[184:185], v[212:213] op_sel:[0,1] op_sel_hi:[1,1]
    v_pk_fma_f32 v[124:125], v[124:125], v[212:213], v[184:185] op_sel_hi:[1,0,1]
    v_pk_mul_f32 v[186:187], v[186:187], v[212:213] op_sel:[0,1] op_sel_hi:[1,1]
    v_pk_fma_f32 v[126:127], v[126:127], v[212:213], v[186:187] op_sel_hi:[1,0,1]
    v_mov_b32 v212, v100
    v_mov_b32 v213, v101
    v_mov_b32 v214, v102
    v_mov_b32 v215, v103
    v_mov_b32 v216, v104
    v_mov_b32 v217, v105
    v_mov_b32 v218, v106
    v_mov_b32 v219, v107
    v_mov_b32 v220, v108
    v_mov_b32 v221, v109
    v_mov_b32 v222, v110
    v_mov_b32 v223, v111
    v_mov_b32 v224, v112
    v_mov_b32 v225, v113
    v_mov_b32 v226, v114
    v_mov_b32 v227, v115
    v_mov_b32 v228, v116
    v_mov_b32 v229, v117
    v_mov_b32 v230, v118
    v_mov_b32 v231, v119
    v_mov_b32 v232, v120
    v_mov_b32 v233, v121
    v_mov_b32 v234, v122
    v_mov_b32 v235, v123
    v_mov_b32 v236, v124
    v_mov_b32 v237, v125
    v_mov_b32 v238, v126
    v_mov_b32 v239, v127
    s_lshl_b32 s54, s42, 2
    s_add_u32 s54, s54, s40
    s_lshl_b32 s54, s54, 7
    s_add_u32 s54, s54, 16384
    v_and_b32 v128, 7, v1
    v_lshl_add_u32 v3, v128, 2, s54
    s_lshl_b32 s54, s42, 6
    s_lshl_b32 s55, s40, 2
    s_add_u32 s54, s54, s55
    s_mul_i32 s52, s54, 7168
    s_add_u32 s52, s52, 13631488
    s_mul_i32 s54, s40, 10752
    s_add_u32 s54, s54, 114688
    v_add_u32 v5, s54, v2
    v_lshlrev_b32 v128, 3, v1
    v_add_u32 v6, s54, v128
    v_mov_b32 v7, 0xbdd2d3e8
    s_add_u32 s54, s40, 1
    s_and_b32 s54, s54, 3
    s_mul_i32 s54, s54, 10752
    s_add_u32 s54, s54, 121856
    v_add_u32 v8, s54, v2
    v_add_u32 v244, s54, v128
    s_add_u32 s54, s40, 2
    s_and_b32 s54, s54, 3
    s_mul_i32 s54, s54, 10752
    s_add_u32 s54, s54, 118272
    v_add_u32 v9, s54, v2
    v_add_u32 v245, s54, v128
    s_add_u32 s54, s40, 3
    s_and_b32 s54, s54, 3
    s_mul_i32 s54, s54, 10752
    s_add_u32 s54, s54, 114688
    v_add_u32 v10, s54, v2
    v_add_u32 v246, s54, v128
    s_xor_b32 s54, s70, 0
    s_mul_i32 s54, s54, 7168
    s_add_u32 s56, s52, s54
    s_xor_b32 s54, s70, 1
    s_mul_i32 s54, s54, 7168
    s_add_u32 s57, s52, s54
    s_xor_b32 s54, s70, 2
    s_mul_i32 s54, s54, 7168
    s_add_u32 s58, s52, s54
    s_xor_b32 s54, s70, 3
    s_mul_i32 s54, s54, 7168
    s_add_u32 s59, s52, s54
    v_lshrrev_b32 v128, 3, v1
    v_and_b32 v129, 7, v1
    v_and_b32 v4, 6, v128
    v_xor_b32 v129, v129, v4
    v_mul_u32_u24 v4, 896, v128
    v_lshl_add_u32 v4, v129, 4, v4
    v_lshlrev_b32 v240, 16, v247
    v_mov_b32 v241, v240
    v_mov_b32 v242, v240
    v_mov_b32 v243, v240
    s_waitcnt vmcnt(0)
    ds_read_b128 a[12:15], v14 offset:0
    ds_read_b128 a[28:31], v15 offset:0
    ds_read_b128 a[76:79], v14 offset:1024
    ds_read_b128 a[92:95], v15 offset:1024
    ds_read_b128 a[140:143], v14 offset:2048
    ds_read_b128 a[156:159], v15 offset:2048
    ds_read_b128 a[204:207], v14 offset:3072
    ds_read_b128 a[220:223], v15 offset:3072
    ds_read_b128 a[44:47], v12 offset:0
    ds_read_b128 a[60:63], v13 offset:0
    ds_read_b128 a[108:111], v12 offset:1024
    ds_read_b128 a[124:127], v13 offset:1024
    ds_read_b128 a[172:175], v12 offset:2048
    ds_read_b128 a[188:191], v13 offset:2048
    ds_read_b128 a[236:239], v12 offset:3072
    ds_read_b128 a[252:255], v13 offset:3072
    s_waitcnt vmcnt(0) lgkmcnt(0)
    s_mov_b32 s48, 0
L_poll_38:
    buffer_load_dword v128, v3, s[36:39], 0 offen sc1
    s_add_u32 s48, s48, 1
    s_cmp_gt_u32 s48, 0x80000
    s_cbranch_scc1 L_polld_39
    s_waitcnt vmcnt(0)
    v_cmp_ne_u32 vcc, s45, v128
    s_nop 1
    s_cbranch_vccnz L_poll_38
L_polld_39:
    s_waitcnt vmcnt(0)
    s_add_u32 s54, s56, 0
    buffer_load_dwordx4 v[128:131], v2, s[36:39], s54 offen offset:0 sc1
    buffer_load_dwordx4 v[132:135], v2, s[36:39], s54 offen offset:1024 sc1
    buffer_load_dwordx4 v[136:139], v2, s[36:39], s54 offen offset:2048 sc1
    buffer_load_dwordx4 v[140:143], v2, s[36:39], s54 offen offset:3072 sc1
    s_add_u32 s54, s56, 4096
    buffer_load_dwordx4 v[144:147], v2, s[36:39], s54 offen offset:0 sc1
    buffer_load_dwordx4 v[148:151], v2, s[36:39], s54 offen offset:1024 sc1
    buffer_load_dwordx4 v[152:155], v2, s[36:39], s54 offen offset:2048 sc1
    s_add_u32 s54, s57, 0
    buffer_load_dwordx4 v[156:159], v2, s[36:39], s54 offen offset:0 sc1
    buffer_load_dwordx4 v[160:163], v2, s[36:39], s54 offen offset:1024 sc1
    buffer_load_dwordx4 v[164:167], v2, s[36:39], s54 offen offset:2048 sc1
    buffer_load_dwordx4 v[168:171], v2, s[36:39], s54 offen offset:3072 sc1
    s_add_u32 s54, s57, 4096
    buffer_load_dwordx4 v[172:175], v2, s[36:39], s54 offen offset:0 sc1
    buffer_load_dwordx4 v[176:179], v2, s[36:39], s54 offen offset:1024 sc1
    buffer_load_dwordx4 v[180:183], v2, s[36:39], s54 offen offset:2048 sc1
    s_waitcnt vmcnt(13)
    v_mfma_f32_16x16x32_bf16 v[16:19], v[128:131], a[0:3], 0
    v_mfma_f32_16x16x32_bf16 v[44:47], v[128:131], a[4:7], 0
    s_add_u32 s54, s58, 0
    buffer_load_dwordx4 v[184:187], v2, s[36:39], s54 offen offset:0 sc1
    v_mfma_f32_16x16x32_bf16 v[72:75], v[128:131], a[8:11], 0
    v_mfma_f32_16x16x32_bf16 v[100:103], v[128:131], a[12:15], v[240:243]
    s_waitcnt vmcnt(13)
    v_mfma_f32_16x16x32_bf16 v[20:23], v[132:135], a[0:3], 0
    v_mfma_f32_16x16x32_bf16 v[48:51], v[132:135], a[4:7], 0
    buffer_load_dwordx4 v[188:191], v2, s[36:39], s54 offen offset:1024 sc1
    v_mfma_f32_16x16x32_bf16 v[76:79], v[132:135], a[8:11], 0
    v_mfma_f32_16x16x32_bf16 v[104:107], v[132:135], a[12:15], v[240:243]
    s_waitcnt vmcnt(13)
    v_mfma_f32_16x16x32_bf16 v[24:27], v[136:139], a[0:3], 0
    v_mfma_f32_16x16x32_bf16 v[52:55], v[136:139], a[4:7], 0
    buffer_load_dwordx4 v[192:195], v2, s[36:39], s54 offen offset:2048 sc1
    v_mfma_f32_16x16x32_bf16 v[80:83], v[136:139], a[8:11], 0
    v_mfma_f32_16x16x32_bf16 v[108:111], v[136:139], a[12:15], v[240:243]
    s_waitcnt vmcnt(13)
    v_mfma_f32_16x16x32_bf16 v[28:31], v[140:143], a[0:3], 0
    v_mfma_f32_16x16x32_bf16 v[56:59], v[140:143], a[4:7], 0
    buffer_load_dwordx4 v[196:199], v2, s[36:39], s54 offen offset:3072 sc1
    v_mfma_f32_16x16x32_bf16 v[84:87], v[140:143], a[8:11], 0
    v_mfma_f32_16x16x32_bf16 v[112:115], v[140:143], a[12:15], v[240:243]
    s_waitcnt vmcnt(13)
    v_mfma_f32_16x16x32_bf16 v[32:35], v[144:147], a[0:3], 0
    v_mfma_f32_16x16x32_bf16 v[60:63], v[144:147], a[4:7], 0
    s_add_u32 s54, s58, 4096
    buffer_load_dwordx4 v[200:203], v2, s[36:39], s54 offen offset:0 sc1
    v_mfma_f32_16x16x32_bf16 v[88:91], v[144:147], a[8:11], 0
    v_mfma_f32_16x16x32_bf16 v[116:119], v[144:147], a[12:15], v[240:243]
    s_waitcnt vmcnt(13)
    v_mfma_f32_16x16x32_bf16 v[36:39], v[148:151], a[0:3], 0
    v_mfma_f32_16x16x32_bf16 v[64:67], v[148:151], a[4:7], 0
    buffer_load_dwordx4 v[204:207], v2, s[36:39], s54 offen offset:1024 sc1
    v_mfma_f32_16x16x32_bf16 v[92:95], v[148:151], a[8:11], 0
    v_mfma_f32_16x16x32_bf16 v[120:123], v[148:151], a[12:15], v[240:243]
    s_waitcnt vmcnt(13)
    v_mfma_f32_16x16x32_bf16 v[40:43], v[152:155], a[0:3], 0
    v_mfma_f32_16x16x32_bf16 v[68:71], v[152:155], a[4:7], 0
    buffer_load_dwordx4 v[208:211], v2, s[36:39], s54 offen offset:2048 sc1
    v_mfma_f32_16x16x32_bf16 v[96:99], v[152:155], a[8:11], 0
    v_mfma_f32_16x16x32_bf16 v[124:127], v[152:155], a[12:15], v[240:243]
    s_waitcnt vmcnt(13)
    v_mfma_f32_16x16x32_bf16 v[16:19], v[156:159], a[16:19], v[16:19]
    v_mul_f32 v11, v212, v212
    v_mfma_f32_16x16x32_bf16 v[44:47], v[156:159], a[20:23], v[44:47]
    s_add_u32 s54, s59, 0
    buffer_load_dwordx4 v[128:131], v2, s[36:39], s54 offen offset:0 sc1
    v_mfma_f32_16x16x32_bf16 v[72:75], v[156:159], a[24:27], v[72:75]
    v_mul_f32 v12, v213, v213
    v_mfma_f32_16x16x32_bf16 v[100:103], v[156:159], a[28:31], v[100:103]
    v_fmaak_f32 v11, v11, v7, 0xc0135761
    s_waitcnt vmcnt(13)
    v_mfma_f32_16x16x32_bf16 v[20:23], v[160:163], a[16:19], v[20:23]
    v_fmaak_f32 v12, v12, v7, 0xc0135761
    v_mfma_f32_16x16x32_bf16 v[48:51], v[160:163], a[20:23], v[48:51]
    buffer_load_dwordx4 v[132:135], v2, s[36:39], s54 offen offset:1024 sc1
    v_mfma_f32_16x16x32_bf16 v[76:79], v[160:163], a[24:27], v[76:79]
    v_mul_f32 v11, v11, v212
    v_mfma_f32_16x16x32_bf16 v[104:107], v[160:163], a[28:31], v[104:107]
    v_mul_f32 v12, v12, v213
    s_waitcnt vmcnt(13)
    v_mfma_f32_16x16x32_bf16 v[24:27], v[164:167], a[16:19], v[24:27]
    v_exp_f32 v11, v11
    v_mfma_f32_16x16x32_bf16 v[52:55], v[164:167], a[20:23], v[52:55]
    buffer_load_dwordx4 v[136:139], v2, s[36:39], s54 offen offset:2048 sc1
    v_mfma_f32_16x16x32_bf16 v[80:83], v[164:167], a[24:27], v[80:83]
    v_exp_f32 v12, v12
    v_mfma_f32_16x16x32_bf16 v[108:111], v[164:167], a[28:31], v[108:111]
    v_add_f32 v11, 1.0, v11
    s_waitcnt vmcnt(13)
    v_mfma_f32_16x16x32_bf16 v[28:31], v[168:171], a[16:19], v[28:31]
    v_add_f32 v12, 1.0, v12
    v_mfma_f32_16x16x32_bf16 v[56:59], v[168:171], a[20:23], v[56:59]
    buffer_load_dwordx4 v[140:143], v2, s[36:39], s54 offen offset:3072 sc1
    v_mfma_f32_16x16x32_bf16 v[84:87], v[168:171], a[24:27], v[84:87]
    v_rcp_f32 v11, v11
    v_mfma_f32_16x16x32_bf16 v[112:115], v[168:171], a[28:31], v[112:115]
    v_rcp_f32 v12, v12
    s_waitcnt vmcnt(13)
    v_mfma_f32_16x16x32_bf16 v[32:35], v[172:175], a[16:19], v[32:35]
    v_mul_f32 v212, v212, v11
    v_mfma_f32_16x16x32_bf16 v[60:63], v[172:175], a[20:23], v[60:63]
    s_add_u32 s54, s59, 4096
    buffer_load_dwordx4 v[144:147], v2, s[36:39], s54 offen offset:0 sc1
    v_mfma_f32_16x16x32_bf16 v[88:91], v[172:175], a[24:27], v[88:91]
    v_mul_f32 v213, v213, v12
    v_mfma_f32_16x16x32_bf16 v[116:119], v[172:175], a[28:31], v[116:119]
    v_mul_f32 v11, v214, v214
    s_waitcnt vmcnt(13)
    v_mfma_f32_16x16x32_bf16 v[36:39], v[176:179], a[16:19], v[36:39]
    v_mul_f32 v12, v215, v215
    v_mfma_f32_16x16x32_bf16 v[64:67], v[176:179], a[20:23], v[64:67]
    buffer_load_dwordx4 v[148:151], v2, s[36:39], s54 offen offset:1024 sc1
    v_mfma_f32_16x16x32_bf16 v[92:95], v[176:179], a[24:27], v[92:95]
    v_fmaak_f32 v11, v11, v7, 0xc0135761
    v_mfma_f32_16x16x32_bf16 v[120:123], v[176:179], a[28:31], v[120:123]
    v_fmaak_f32 v12, v12, v7, 0xc0135761
    s_waitcnt vmcnt(13)
    v_mfma_f32_16x16x32_bf16 v[40:43], v[180:183], a[16:19], v[40:43]
    v_mul_f32 v11, v11, v214
    v_mfma_f32_16x16x32_bf16 v[68:71], v[180:183], a[20:23], v[68:71]
    buffer_load_dwordx4 v[152:155], v2, s[36:39], s54 offen offset:2048 sc1
    v_mfma_f32_16x16x32_bf16 v[96:99], v[180:183], a[24:27], v[96:99]
    v_mul_f32 v12, v12, v215
    v_mfma_f32_16x16x32_bf16 v[124:127], v[180:183], a[28:31], v[124:127]
    v_exp_f32 v11, v11
    s_waitcnt vmcnt(13)
    v_mfma_f32_16x16x32_bf16 v[16:19], v[184:187], a[32:35], v[16:19]
    v_exp_f32 v12, v12
    v_mfma_f32_16x16x32_bf16 v[44:47], v[184:187], a[36:39], v[44:47]
    s_add_u32 s54, s56, 114688
    buffer_load_dwordx4 v[156:159], v2, s[36:39], s54 offen offset:0 sc1
    v_mfma_f32_16x16x32_bf16 v[72:75], v[184:187], a[40:43], v[72:75]
    v_add_f32 v11, 1.0, v11
    v_mfma_f32_16x16x32_bf16 v[100:103], v[184:187], a[44:47], v[100:103]
    v_add_f32 v12, 1.0, v12
    s_waitcnt vmcnt(13)
    v_mfma_f32_16x16x32_bf16 v[20:23], v[188:191], a[32:35], v[20:23]
    v_rcp_f32 v11, v11
    v_mfma_f32_16x16x32_bf16 v[48:51], v[188:191], a[36:39], v[48:51]
    buffer_load_dwordx4 v[160:163], v2, s[36:39], s54 offen offset:1024 sc1
    v_mfma_f32_16x16x32_bf16 v[76:79], v[188:191], a[40:43], v[76:79]
    v_rcp_f32 v12, v12
    v_mfma_f32_16x16x32_bf16 v[104:107], v[188:191], a[44:47], v[104:107]
    v_mul_f32 v214, v214, v11
    s_waitcnt vmcnt(13)
    v_mfma_f32_16x16x32_bf16 v[24:27], v[192:195], a[32:35], v[24:27]
    v_mul_f32 v215, v215, v12
    v_mfma_f32_16x16x32_bf16 v[52:55], v[192:195], a[36:39], v[52:55]
    buffer_load_dwordx4 v[164:167], v2, s[36:39], s54 offen offset:2048 sc1
    v_mfma_f32_16x16x32_bf16 v[80:83], v[192:195], a[40:43], v[80:83]
    v_mul_f32 v11, v216, v216
    v_mfma_f32_16x16x32_bf16 v[108:111], v[192:195], a[44:47], v[108:111]
    v_mul_f32 v12, v217, v217
    s_waitcnt vmcnt(13)
    v_mfma_f32_16x16x32_bf16 v[28:31], v[196:199], a[32:35], v[28:31]
    v_fmaak_f32 v11, v11, v7, 0xc0135761
    v_mfma_f32_16x16x32_bf16 v[56:59], v[196:199], a[36:39], v[56:59]
    buffer_load_dwordx4 v[168:171], v2, s[36:39], s54 offen offset:3072 sc1
    v_mfma_f32_16x16x32_bf16 v[84:87], v[196:199], a[40:43], v[84:87]
    v_fmaak_f32 v12, v12, v7, 0xc0135761
    v_mfma_f32_16x16x32_bf16 v[112:115], v[196:199], a[44:47], v[112:115]
    v_mul_f32 v11, v11, v216
    s_waitcnt vmcnt(13)
    v_mfma_f32_16x16x32_bf16 v[32:35], v[200:203], a[32:35], v[32:35]
    v_mul_f32 v12, v12, v217
    v_mfma_f32_16x16x32_bf16 v[60:63], v[200:203], a[36:39], v[60:63]
    s_add_u32 s54, s56, 118784
    buffer_load_dwordx4 v[172:175], v2, s[36:39], s54 offen offset:0 sc1
    v_mfma_f32_16x16x32_bf16 v[88:91], v[200:203], a[40:43], v[88:91]
    v_exp_f32 v11, v11
    v_mfma_f32_16x16x32_bf16 v[116:119], v[200:203], a[44:47], v[116:119]
    v_exp_f32 v12, v12
    s_waitcnt vmcnt(13)
    v_mfma_f32_16x16x32_bf16 v[36:39], v[204:207], a[32:35], v[36:39]
    v_add_f32 v11, 1.0, v11
    v_mfma_f32_16x16x32_bf16 v[64:67], v[204:207], a[36:39], v[64:67]
    buffer_load_dwordx4 v[176:179], v2, s[36:39], s54 offen offset:1024 sc1
    v_mfma_f32_16x16x32_bf16 v[92:95], v[204:207], a[40:43], v[92:95]
    v_add_f32 v12, 1.0, v12
    v_mfma_f32_16x16x32_bf16 v[120:123], v[204:207], a[44:47], v[120:123]
    v_rcp_f32 v11, v11
    s_waitcnt vmcnt(13)
    v_mfma_f32_16x16x32_bf16 v[40:43], v[208:211], a[32:35], v[40:43]
    v_rcp_f32 v12, v12
    v_mfma_f32_16x16x32_bf16 v[68:71], v[208:211], a[36:39], v[68:71]
    buffer_load_dwordx4 v[180:183], v2, s[36:39], s54 offen offset:2048 sc1
    v_mfma_f32_16x16x32_bf16 v[96:99], v[208:211], a[40:43], v[96:99]
    v_mul_f32 v216, v216, v11
    v_mfma_f32_16x16x32_bf16 v[124:127], v[208:211], a[44:47], v[124:127]
    v_mul_f32 v217, v217, v12
    s_waitcnt vmcnt(13)
    v_mfma_f32_16x16x32_bf16 v[16:19], v[128:131], a[48:51], v[16:19]
    v_mul_f32 v11, v218, v218
    v_mfma_f32_16x16x32_bf16 v[44:47], v[128:131], a[52:55], v[44:47]
    s_add_u32 s54, s57, 114688
    buffer_load_dwordx4 v[184:187], v2, s[36:39], s54 offen offset:0 sc1
    v_mfma_f32_16x16x32_bf16 v[72:75], v[128:131], a[56:59], v[72:75]
    v_mul_f32 v12, v219, v219
    v_mfma_f32_16x16x32_bf16 v[100:103], v[128:131], a[60:63], v[100:103]
    v_fmaak_f32 v11, v11, v7, 0xc0135761
    s_waitcnt vmcnt(13)
    v_mfma_f32_16x16x32_bf16 v[20:23], v[132:135], a[48:51], v[20:23]
    v_fmaak_f32 v12, v12, v7, 0xc0135761
    v_mfma_f32_16x16x32_bf16 v[48:51], v[132:135], a[52:55], v[48:51]
    buffer_load_dwordx4 v[188:191], v2, s[36:39], s54 offen offset:1024 sc1
    v_mfma_f32_16x16x32_bf16 v[76:79], v[132:135], a[56:59], v[76:79]
    v_mul_f32 v11, v11, v218
    v_mfma_f32_16x16x32_bf16 v[104:107], v[132:135], a[60:63], v[104:107]
    v_mul_f32 v12, v12, v219
    s_waitcnt vmcnt(13)
    v_mfma_f32_16x16x32_bf16 v[24:27], v[136:139], a[48:51], v[24:27]
    v_exp_f32 v11, v11
    v_mfma_f32_16x16x32_bf16 v[52:55], v[136:139], a[52:55], v[52:55]
    buffer_load_dwordx4 v[192:195], v2, s[36:39], s54 offen offset:2048 sc1
    v_mfma_f32_16x16x32_bf16 v[80:83], v[136:139], a[56:59], v[80:83]
    v_exp_f32 v12, v12
    v_mfma_f32_16x16x32_bf16 v[108:111], v[136:139], a[60:63], v[108:111]
    v_add_f32 v11, 1.0, v11
    s_waitcnt vmcnt(13)
    v_mfma_f32_16x16x32_bf16 v[28:31], v[140:143], a[48:51], v[28:31]
    v_add_f32 v12, 1.0, v12
    v_mfma_f32_16x16x32_bf16 v[56:59], v[140:143], a[52:55], v[56:59]
    buffer_load_dwordx4 v[196:199], v2, s[36:39], s54 offen offset:3072 sc1
    v_mfma_f32_16x16x32_bf16 v[84:87], v[140:143], a[56:59], v[84:87]
    v_rcp_f32 v11, v11
    v_mfma_f32_16x16x32_bf16 v[112:115], v[140:143], a[60:63], v[112:115]
    v_rcp_f32 v12, v12
    s_waitcnt vmcnt(13)
    v_mfma_f32_16x16x32_bf16 v[32:35], v[144:147], a[48:51], v[32:35]
    v_mul_f32 v218, v218, v11
    v_mfma_f32_16x16x32_bf16 v[60:63], v[144:147], a[52:55], v[60:63]
    s_add_u32 s54, s57, 118784
    buffer_load_dwordx4 v[200:203], v2, s[36:39], s54 offen offset:0 sc1
    v_mfma_f32_16x16x32_bf16 v[88:91], v[144:147], a[56:59], v[88:91]
    v_mul_f32 v219, v219, v12
    v_mfma_f32_16x16x32_bf16 v[116:119], v[144:147], a[60:63], v[116:119]
    v_mul_f32 v11, v220, v220
    s_waitcnt vmcnt(13)
    v_mfma_f32_16x16x32_bf16 v[36:39], v[148:151], a[48:51], v[36:39]
    v_mul_f32 v12, v221, v221
    v_mfma_f32_16x16x32_bf16 v[64:67], v[148:151], a[52:55], v[64:67]
    buffer_load_dwordx4 v[204:207], v2, s[36:39], s54 offen offset:1024 sc1
    v_mfma_f32_16x16x32_bf16 v[92:95], v[148:151], a[56:59], v[92:95]
    v_fmaak_f32 v11, v11, v7, 0xc0135761
    v_mfma_f32_16x16x32_bf16 v[120:123], v[148:151], a[60:63], v[120:123]
    v_fmaak_f32 v12, v12, v7, 0xc0135761
    s_waitcnt vmcnt(13)
    v_mfma_f32_16x16x32_bf16 v[40:43], v[152:155], a[48:51], v[40:43]
    v_mul_f32 v11, v11, v220
    v_mfma_f32_16x16x32_bf16 v[68:71], v[152:155], a[52:55], v[68:71]
    buffer_load_dwordx4 v[208:211], v2, s[36:39], s54 offen offset:2048 sc1
    v_mfma_f32_16x16x32_bf16 v[96:99], v[152:155], a[56:59], v[96:99]
    v_mul_f32 v12, v12, v221
    v_mfma_f32_16x16x32_bf16 v[124:127], v[152:155], a[60:63], v[124:127]
    v_exp_f32 v11, v11
    s_waitcnt vmcnt(13)
    v_mfma_f32_16x16x32_bf16 v[16:19], v[156:159], a[64:67], v[16:19]
    v_exp_f32 v12, v12
    v_mfma_f32_16x16x32_bf16 v[44:47], v[156:159], a[68:71], v[44:47]
    s_add_u32 s54, s58, 114688
    buffer_load_dwordx4 v[128:131], v2, s[36:39], s54 offen offset:0 sc1
    v_mfma_f32_16x16x32_bf16 v[72:75], v[156:159], a[72:75], v[72:75]
    v_add_f32 v11, 1.0, v11
    v_mfma_f32_16x16x32_bf16 v[100:103], v[156:159], a[76:79], v[100:103]
    v_add_f32 v12, 1.0, v12
    s_waitcnt vmcnt(13)
    v_mfma_f32_16x16x32_bf16 v[20:23], v[160:163], a[64:67], v[20:23]
    v_rcp_f32 v11, v11
    v_mfma_f32_16x16x32_bf16 v[48:51], v[160:163], a[68:71], v[48:51]
    buffer_load_dwordx4 v[132:135], v2, s[36:39], s54 offen offset:1024 sc1
    v_mfma_f32_16x16x32_bf16 v[76:79], v[160:163], a[72:75], v[76:79]
    v_rcp_f32 v12, v12
    v_mfma_f32_16x16x32_bf16 v[104:107], v[160:163], a[76:79], v[104:107]
    v_mul_f32 v220, v220, v11
    s_waitcnt vmcnt(13)
    v_mfma_f32_16x16x32_bf16 v[24:27], v[164:167], a[64:67], v[24:27]
    v_mul_f32 v221, v221, v12
    v_mfma_f32_16x16x32_bf16 v[52:55], v[164:167], a[68:71], v[52:55]
    buffer_load_dwordx4 v[136:139], v2, s[36:39], s54 offen offset:2048 sc1
    v_mfma_f32_16x16x32_bf16 v[80:83], v[164:167], a[72:75], v[80:83]
    v_mul_f32 v11, v222, v222
    v_mfma_f32_16x16x32_bf16 v[108:111], v[164:167], a[76:79], v[108:111]
    v_mul_f32 v12, v223, v223
    s_waitcnt vmcnt(13)
    v_mfma_f32_16x16x32_bf16 v[28:31], v[168:171], a[64:67], v[28:31]
    v_fmaak_f32 v11, v11, v7, 0xc0135761
    v_mfma_f32_16x16x32_bf16 v[56:59], v[168:171], a[68:71], v[56:59]
    buffer_load_dwordx4 v[140:143], v2, s[36:39], s54 offen offset:3072 sc1
    v_mfma_f32_16x16x32_bf16 v[84:87], v[168:171], a[72:75], v[84:87]
    v_fmaak_f32 v12, v12, v7, 0xc0135761
    v_mfma_f32_16x16x32_bf16 v[112:115], v[168:171], a[76:79], v[112:115]
    v_mul_f32 v11, v11, v222
    s_waitcnt vmcnt(13)
    v_mfma_f32_16x16x32_bf16 v[32:35], v[172:175], a[64:67], v[32:35]
    v_mul_f32 v12, v12, v223
    v_mfma_f32_16x16x32_bf16 v[60:63], v[172:175], a[68:71], v[60:63]
    s_add_u32 s54, s58, 118784
    buffer_load_dwordx4 v[144:147], v2, s[36:39], s54 offen offset:0 sc1
    v_mfma_f32_16x16x32_bf16 v[88:91], v[172:175], a[72:75], v[88:91]
    v_exp_f32 v11, v11
    v_mfma_f32_16x16x32_bf16 v[116:119], v[172:175], a[76:79], v[116:119]
    v_exp_f32 v12, v12
    s_waitcnt vmcnt(13)
    v_mfma_f32_16x16x32_bf16 v[36:39], v[176:179], a[64:67], v[36:39]
    v_add_f32 v11, 1.0, v11
    v_mfma_f32_16x16x32_bf16 v[64:67], v[176:179], a[68:71], v[64:67]
    buffer_load_dwordx4 v[148:151], v2, s[36:39], s54 offen offset:1024 sc1
    v_mfma_f32_16x16x32_bf16 v[92:95], v[176:179], a[72:75], v[92:95]
    v_add_f32 v12, 1.0, v12
    v_mfma_f32_16x16x32_bf16 v[120:123], v[176:179], a[76:79], v[120:123]
    v_rcp_f32 v11, v11
    s_waitcnt vmcnt(13)
    v_mfma_f32_16x16x32_bf16 v[40:43], v[180:183], a[64:67], v[40:43]
    v_rcp_f32 v12, v12
    v_mfma_f32_16x16x32_bf16 v[68:71], v[180:183], a[68:71], v[68:71]
    buffer_load_dwordx4 v[152:155], v2, s[36:39], s54 offen offset:2048 sc1
    v_mfma_f32_16x16x32_bf16 v[96:99], v[180:183], a[72:75], v[96:99]
    v_mul_f32 v222, v222, v11
    v_mfma_f32_16x16x32_bf16 v[124:127], v[180:183], a[76:79], v[124:127]
    v_mul_f32 v223, v223, v12
    s_waitcnt vmcnt(13)
    v_mfma_f32_16x16x32_bf16 v[16:19], v[184:187], a[80:83], v[16:19]
    v_mul_f32 v11, v224, v224
    v_mfma_f32_16x16x32_bf16 v[44:47], v[184:187], a[84:87], v[44:47]
    s_add_u32 s54, s59, 114688
    buffer_load_dwordx4 v[156:159], v2, s[36:39], s54 offen offset:0 sc1
    v_mfma_f32_16x16x32_bf16 v[72:75], v[184:187], a[88:91], v[72:75]
    v_mul_f32 v12, v225, v225
    v_mfma_f32_16x16x32_bf16 v[100:103], v[184:187], a[92:95], v[100:103]
    v_fmaak_f32 v11, v11, v7, 0xc0135761
    s_waitcnt vmcnt(13)
    v_mfma_f32_16x16x32_bf16 v[20:23], v[188:191], a[80:83], v[20:23]
    v_fmaak_f32 v12, v12, v7, 0xc0135761
    v_mfma_f32_16x16x32_bf16 v[48:51], v[188:191], a[84:87], v[48:51]
    buffer_load_dwordx4 v[160:163], v2, s[36:39], s54 offen offset:1024 sc1
    v_mfma_f32_16x16x32_bf16 v[76:79], v[188:191], a[88:91], v[76:79]
    v_mul_f32 v11, v11, v224
    v_mfma_f32_16x16x32_bf16 v[104:107], v[188:191], a[92:95], v[104:107]
    v_mul_f32 v12, v12, v225
    s_waitcnt vmcnt(13)
    v_mfma_f32_16x16x32_bf16 v[24:27], v[192:195], a[80:83], v[24:27]
    v_exp_f32 v11, v11
    v_mfma_f32_16x16x32_bf16 v[52:55], v[192:195], a[84:87], v[52:55]
    buffer_load_dwordx4 v[164:167], v2, s[36:39], s54 offen offset:2048 sc1
    v_mfma_f32_16x16x32_bf16 v[80:83], v[192:195], a[88:91], v[80:83]
    v_exp_f32 v12, v12
    v_mfma_f32_16x16x32_bf16 v[108:111], v[192:195], a[92:95], v[108:111]
    v_add_f32 v11, 1.0, v11
    s_waitcnt vmcnt(13)
    v_mfma_f32_16x16x32_bf16 v[28:31], v[196:199], a[80:83], v[28:31]
    v_add_f32 v12, 1.0, v12
    v_mfma_f32_16x16x32_bf16 v[56:59], v[196:199], a[84:87], v[56:59]
    buffer_load_dwordx4 v[168:171], v2, s[36:39], s54 offen offset:3072 sc1
    v_mfma_f32_16x16x32_bf16 v[84:87], v[196:199], a[88:91], v[84:87]
    v_rcp_f32 v11, v11
    v_mfma_f32_16x16x32_bf16 v[112:115], v[196:199], a[92:95], v[112:115]
    v_rcp_f32 v12, v12
    s_waitcnt vmcnt(13)
    v_mfma_f32_16x16x32_bf16 v[32:35], v[200:203], a[80:83], v[32:35]
    v_mul_f32 v224, v224, v11
    v_mfma_f32_16x16x32_bf16 v[60:63], v[200:203], a[84:87], v[60:63]
    s_add_u32 s54, s59, 118784
    buffer_load_dwordx4 v[172:175], v2, s[36:39], s54 offen offset:0 sc1
    v_mfma_f32_16x16x32_bf16 v[88:91], v[200:203], a[88:91], v[88:91]
    v_mul_f32 v225, v225, v12
    v_mfma_f32_16x16x32_bf16 v[116:119], v[200:203], a[92:95], v[116:119]
    v_mul_f32 v11, v226, v226
    s_waitcnt vmcnt(13)
    v_mfma_f32_16x16x32_bf16 v[36:39], v[204:207], a[80:83], v[36:39]
    v_mul_f32 v12, v227, v227
    v_mfma_f32_16x16x32_bf16 v[64:67], v[204:207], a[84:87], v[64:67]
    buffer_load_dwordx4 v[176:179], v2, s[36:39], s54 offen offset:1024 sc1
    v_mfma_f32_16x16x32_bf16 v[92:95], v[204:207], a[88:91], v[92:95]
    v_fmaak_f32 v11, v11, v7, 0xc0135761
    v_mfma_f32_16x16x32_bf16 v[120:123], v[204:207], a[92:95], v[120:123]
    v_fmaak_f32 v12, v12, v7, 0xc0135761
    s_waitcnt vmcnt(13)
    v_mfma_f32_16x16x32_bf16 v[40:43], v[208:211], a[80:83], v[40:43]
    v_mul_f32 v11, v11, v226
    v_mfma_f32_16x16x32_bf16 v[68:71], v[208:211], a[84:87], v[68:71]
    buffer_load_dwordx4 v[180:183], v2, s[36:39], s54 offen offset:2048 sc1
    v_mfma_f32_16x16x32_bf16 v[96:99], v[208:211], a[88:91], v[96:99]
    v_mul_f32 v12, v12, v227
    v_mfma_f32_16x16x32_bf16 v[124:127], v[208:211], a[92:95], v[124:127]
    v_exp_f32 v11, v11
    s_waitcnt vmcnt(13)
    v_mfma_f32_16x16x32_bf16 v[16:19], v[128:131], a[96:99], v[16:19]
    v_exp_f32 v12, v12
    v_mfma_f32_16x16x32_bf16 v[44:47], v[128:131], a[100:103], v[44:47]
    s_add_u32 s54, s56, 229376
    buffer_load_dwordx4 v[184:187], v2, s[36:39], s54 offen offset:0 sc1
    v_mfma_f32_16x16x32_bf16 v[72:75], v[128:131], a[104:107], v[72:75]
    v_add_f32 v11, 1.0, v11
    v_mfma_f32_16x16x32_bf16 v[100:103], v[128:131], a[108:111], v[100:103]
    v_add_f32 v12, 1.0, v12
    s_waitcnt vmcnt(13)
    v_mfma_f32_16x16x32_bf16 v[20:23], v[132:135], a[96:99], v[20:23]
    v_rcp_f32 v11, v11
    v_mfma_f32_16x16x32_bf16 v[48:51], v[132:135], a[100:103], v[48:51]
    buffer_load_dwordx4 v[188:191], v2, s[36:39], s54 offen offset:1024 sc1
    v_mfma_f32_16x16x32_bf16 v[76:79], v[132:135], a[104:107], v[76:79]
    v_rcp_f32 v12, v12
    v_mfma_f32_16x16x32_bf16 v[104:107], v[132:135], a[108:111], v[104:107]
    v_mul_f32 v226, v226, v11
    s_waitcnt vmcnt(13)
    v_mfma_f32_16x16x32_bf16 v[24:27], v[136:139], a[96:99], v[24:27]
    v_mul_f32 v227, v227, v12
    v_mfma_f32_16x16x32_bf16 v[52:55], v[136:139], a[100:103], v[52:55]
    buffer_load_dwordx4 v[192:195], v2, s[36:39], s54 offen offset:2048 sc1
    v_mfma_f32_16x16x32_bf16 v[80:83], v[136:139], a[104:107], v[80:83]
    v_mul_f32 v11, v228, v228
    v_mfma_f32_16x16x32_bf16 v[108:111], v[136:139], a[108:111], v[108:111]
    v_mul_f32 v12, v229, v229
    s_waitcnt vmcnt(13)
    v_mfma_f32_16x16x32_bf16 v[28:31], v[140:143], a[96:99], v[28:31]
    v_fmaak_f32 v11, v11, v7, 0xc0135761
    v_mfma_f32_16x16x32_bf16 v[56:59], v[140:143], a[100:103], v[56:59]
    buffer_load_dwordx4 v[196:199], v2, s[36:39], s54 offen offset:3072 sc1
    v_mfma_f32_16x16x32_bf16 v[84:87], v[140:143], a[104:107], v[84:87]
    v_fmaak_f32 v12, v12, v7, 0xc0135761
    v_mfma_f32_16x16x32_bf16 v[112:115], v[140:143], a[108:111], v[112:115]
    v_mul_f32 v11, v11, v228
    s_waitcnt vmcnt(13)
    v_mfma_f32_16x16x32_bf16 v[32:35], v[144:147], a[96:99], v[32:35]
    v_mul_f32 v12, v12, v229
    v_mfma_f32_16x16x32_bf16 v[60:63], v[144:147], a[100:103], v[60:63]
    s_add_u32 s54, s56, 233472
    buffer_load_dwordx4 v[200:203], v2, s[36:39], s54 offen offset:0 sc1
    v_mfma_f32_16x16x32_bf16 v[88:91], v[144:147], a[104:107], v[88:91]
    v_exp_f32 v11, v11
    v_mfma_f32_16x16x32_bf16 v[116:119], v[144:147], a[108:111], v[116:119]
    v_exp_f32 v12, v12
    s_waitcnt vmcnt(13)
    v_mfma_f32_16x16x32_bf16 v[36:39], v[148:151], a[96:99], v[36:39]
    v_add_f32 v11, 1.0, v11
    v_mfma_f32_16x16x32_bf16 v[64:67], v[148:151], a[100:103], v[64:67]
    buffer_load_dwordx4 v[204:207], v2, s[36:39], s54 offen offset:1024 sc1
    v_mfma_f32_16x16x32_bf16 v[92:95], v[148:151], a[104:107], v[92:95]
    v_add_f32 v12, 1.0, v12
    v_mfma_f32_16x16x32_bf16 v[120:123], v[148:151], a[108:111], v[120:123]
    v_rcp_f32 v11, v11
    s_waitcnt vmcnt(13)
    v_mfma_f32_16x16x32_bf16 v[40:43], v[152:155], a[96:99], v[40:43]
    v_rcp_f32 v12, v12
    v_mfma_f32_16x16x32_bf16 v[68:71], v[152:155], a[100:103], v[68:71]
    buffer_load_dwordx4 v[208:211], v2, s[36:39], s54 offen offset:2048 sc1
    v_mfma_f32_16x16x32_bf16 v[96:99], v[152:155], a[104:107], v[96:99]
    v_mul_f32 v228, v228, v11
    v_mfma_f32_16x16x32_bf16 v[124:127], v[152:155], a[108:111], v[124:127]
    v_mul_f32 v229, v229, v12
    s_waitcnt vmcnt(13)
    v_mfma_f32_16x16x32_bf16 v[16:19], v[156:159], a[112:115], v[16:19]
    v_mul_f32 v11, v230, v230
    v_mfma_f32_16x16x32_bf16 v[44:47], v[156:159], a[116:119], v[44:47]
    s_add_u32 s54, s57, 229376
    buffer_load_dwordx4 v[128:131], v2, s[36:39], s54 offen offset:0 sc1
    v_mfma_f32_16x16x32_bf16 v[72:75], v[156:159], a[120:123], v[72:75]
    v_mul_f32 v12, v231, v231
    v_mfma_f32_16x16x32_bf16 v[100:103], v[156:159], a[124:127], v[100:103]
    v_fmaak_f32 v11, v11, v7, 0xc0135761
    s_waitcnt vmcnt(13)
    v_mfma_f32_16x16x32_bf16 v[20:23], v[160:163], a[112:115], v[20:23]
    v_fmaak_f32 v12, v12, v7, 0xc0135761
    v_mfma_f32_16x16x32_bf16 v[48:51], v[160:163], a[116:119], v[48:51]
    buffer_load_dwordx4 v[132:135], v2, s[36:39], s54 offen offset:1024 sc1
    v_mfma_f32_16x16x32_bf16 v[76:79], v[160:163], a[120:123], v[76:79]
    v_mul_f32 v11, v11, v230
    v_mfma_f32_16x16x32_bf16 v[104:107], v[160:163], a[124:127], v[104:107]
    v_mul_f32 v12, v12, v231
    s_waitcnt vmcnt(13)
    v_mfma_f32_16x16x32_bf16 v[24:27], v[164:167], a[112:115], v[24:27]
    v_exp_f32 v11, v11
    v_mfma_f32_16x16x32_bf16 v[52:55], v[164:167], a[116:119], v[52:55]
    buffer_load_dwordx4 v[136:139], v2, s[36:39], s54 offen offset:2048 sc1
    v_mfma_f32_16x16x32_bf16 v[80:83], v[164:167], a[120:123], v[80:83]
    v_exp_f32 v12, v12
    v_mfma_f32_16x16x32_bf16 v[108:111], v[164:167], a[124:127], v[108:111]
    v_add_f32 v11, 1.0, v11
    s_waitcnt vmcnt(13)
    v_mfma_f32_16x16x32_bf16 v[28:31], v[168:171], a[112:115], v[28:31]
    v_add_f32 v12, 1.0, v12
    v_mfma_f32_16x16x32_bf16 v[56:59], v[168:171], a[116:119], v[56:59]
    buffer_load_dwordx4 v[140:143], v2, s[36:39], s54 offen offset:3072 sc1
    v_mfma_f32_16x16x32_bf16 v[84:87], v[168:171], a[120:123], v[84:87]
    v_rcp_f32 v11, v11
    v_mfma_f32_16x16x32_bf16 v[112:115], v[168:171], a[124:127], v[112:115]
    v_rcp_f32 v12, v12
    s_waitcnt vmcnt(13)
    v_mfma_f32_16x16x32_bf16 v[32:35], v[172:175], a[112:115], v[32:35]
    v_mul_f32 v230, v230, v11
    v_mfma_f32_16x16x32_bf16 v[60:63], v[172:175], a[116:119], v[60:63]
    s_add_u32 s54, s57, 233472
    buffer_load_dwordx4 v[144:147], v2, s[36:39], s54 offen offset:0 sc1
    v_mfma_f32_16x16x32_bf16 v[88:91], v[172:175], a[120:123], v[88:91]
    v_mul_f32 v231, v231, v12
    v_mfma_f32_16x16x32_bf16 v[116:119], v[172:175], a[124:127], v[116:119]
    v_mul_f32 v11, v232, v232
    s_waitcnt vmcnt(13)
    v_mfma_f32_16x16x32_bf16 v[36:39], v[176:179], a[112:115], v[36:39]
    v_mul_f32 v12, v233, v233
    v_mfma_f32_16x16x32_bf16 v[64:67], v[176:179], a[116:119], v[64:67]
    buffer_load_dwordx4 v[148:151], v2, s[36:39], s54 offen offset:1024 sc1
    v_mfma_f32_16x16x32_bf16 v[92:95], v[176:179], a[120:123], v[92:95]
    v_fmaak_f32 v11, v11, v7, 0xc0135761
    v_mfma_f32_16x16x32_bf16 v[120:123], v[176:179], a[124:127], v[120:123]
    v_fmaak_f32 v12, v12, v7, 0xc0135761
    s_waitcnt vmcnt(13)
    v_mfma_f32_16x16x32_bf16 v[40:43], v[180:183], a[112:115], v[40:43]
    v_mul_f32 v11, v11, v232
    v_mfma_f32_16x16x32_bf16 v[68:71], v[180:183], a[116:119], v[68:71]
    buffer_load_dwordx4 v[152:155], v2, s[36:39], s54 offen offset:2048 sc1
    v_mfma_f32_16x16x32_bf16 v[96:99], v[180:183], a[120:123], v[96:99]
    v_mul_f32 v12, v12, v233
    v_mfma_f32_16x16x32_bf16 v[124:127], v[180:183], a[124:127], v[124:127]
    v_exp_f32 v11, v11
    s_waitcnt vmcnt(13)
    v_mfma_f32_16x16x32_bf16 v[16:19], v[184:187], a[128:131], v[16:19]
    v_exp_f32 v12, v12
    v_mfma_f32_16x16x32_bf16 v[44:47], v[184:187], a[132:135], v[44:47]
    s_add_u32 s54, s58, 229376
    buffer_load_dwordx4 v[156:159], v2, s[36:39], s54 offen offset:0 sc1
    v_mfma_f32_16x16x32_bf16 v[72:75], v[184:187], a[136:139], v[72:75]
    v_add_f32 v11, 1.0, v11
    v_mfma_f32_16x16x32_bf16 v[100:103], v[184:187], a[140:143], v[100:103]
    v_add_f32 v12, 1.0, v12
    s_waitcnt vmcnt(13)
    v_mfma_f32_16x16x32_bf16 v[20:23], v[188:191], a[128:131], v[20:23]
    v_rcp_f32 v11, v11
    v_mfma_f32_16x16x32_bf16 v[48:51], v[188:191], a[132:135], v[48:51]
    buffer_load_dwordx4 v[160:163], v2, s[36:39], s54 offen offset:1024 sc1
    v_mfma_f32_16x16x32_bf16 v[76:79], v[188:191], a[136:139], v[76:79]
    v_rcp_f32 v12, v12
    v_mfma_f32_16x16x32_bf16 v[104:107], v[188:191], a[140:143], v[104:107]
    v_mul_f32 v232, v232, v11
    s_waitcnt vmcnt(13)
    v_mfma_f32_16x16x32_bf16 v[24:27], v[192:195], a[128:131], v[24:27]
    v_mul_f32 v233, v233, v12
    v_mfma_f32_16x16x32_bf16 v[52:55], v[192:195], a[132:135], v[52:55]
    buffer_load_dwordx4 v[164:167], v2, s[36:39], s54 offen offset:2048 sc1
    v_mfma_f32_16x16x32_bf16 v[80:83], v[192:195], a[136:139], v[80:83]
    v_mul_f32 v11, v234, v234
    v_mfma_f32_16x16x32_bf16 v[108:111], v[192:195], a[140:143], v[108:111]
    v_mul_f32 v12, v235, v235
    s_waitcnt vmcnt(13)
    v_mfma_f32_16x16x32_bf16 v[28:31], v[196:199], a[128:131], v[28:31]
    v_fmaak_f32 v11, v11, v7, 0xc0135761
    v_mfma_f32_16x16x32_bf16 v[56:59], v[196:199], a[132:135], v[56:59]
    buffer_load_dwordx4 v[168:171], v2, s[36:39], s54 offen offset:3072 sc1
    v_mfma_f32_16x16x32_bf16 v[84:87], v[196:199], a[136:139], v[84:87]
    v_fmaak_f32 v12, v12, v7, 0xc0135761
    v_mfma_f32_16x16x32_bf16 v[112:115], v[196:199], a[140:143], v[112:115]
    v_mul_f32 v11, v11, v234
    s_waitcnt vmcnt(13)
    v_mfma_f32_16x16x32_bf16 v[32:35], v[200:203], a[128:131], v[32:35]
    v_mul_f32 v12, v12, v235
    v_mfma_f32_16x16x32_bf16 v[60:63], v[200:203], a[132:135], v[60:63]
    s_add_u32 s54, s58, 233472
    buffer_load_dwordx4 v[172:175], v2, s[36:39], s54 offen offset:0 sc1
    v_mfma_f32_16x16x32_bf16 v[88:91], v[200:203], a[136:139], v[88:91]
    v_exp_f32 v11, v11
    v_mfma_f32_16x16x32_bf16 v[116:119], v[200:203], a[140:143], v[116:119]
    v_exp_f32 v12, v12
    s_waitcnt vmcnt(13)
    v_mfma_f32_16x16x32_bf16 v[36:39], v[204:207], a[128:131], v[36:39]
    v_add_f32 v11, 1.0, v11
    v_mfma_f32_16x16x32_bf16 v[64:67], v[204:207], a[132:135], v[64:67]
    buffer_load_dwordx4 v[176:179], v2, s[36:39], s54 offen offset:1024 sc1
    v_mfma_f32_16x16x32_bf16 v[92:95], v[204:207], a[136:139], v[92:95]
    v_add_f32 v12, 1.0, v12
    v_mfma_f32_16x16x32_bf16 v[120:123], v[204:207], a[140:143], v[120:123]
    v_rcp_f32 v11, v11
    s_waitcnt vmcnt(13)
    v_mfma_f32_16x16x32_bf16 v[40:43], v[208:211], a[128:131], v[40:43]
    v_rcp_f32 v12, v12
    v_mfma_f32_16x16x32_bf16 v[68:71], v[208:211], a[132:135], v[68:71]
    buffer_load_dwordx4 v[180:183], v2, s[36:39], s54 offen offset:2048 sc1
    v_mfma_f32_16x16x32_bf16 v[96:99], v[208:211], a[136:139], v[96:99]
    v_mul_f32 v234, v234, v11
    v_mfma_f32_16x16x32_bf16 v[124:127], v[208:211], a[140:143], v[124:127]
    v_mul_f32 v235, v235, v12
    s_waitcnt vmcnt(13)
    v_mfma_f32_16x16x32_bf16 v[16:19], v[128:131], a[144:147], v[16:19]
    v_mul_f32 v11, v236, v236
    v_mfma_f32_16x16x32_bf16 v[44:47], v[128:131], a[148:151], v[44:47]
    s_add_u32 s54, s59, 229376
    buffer_load_dwordx4 v[184:187], v2, s[36:39], s54 offen offset:0 sc1
    v_mfma_f32_16x16x32_bf16 v[72:75], v[128:131], a[152:155], v[72:75]
    v_mul_f32 v12, v237, v237
    v_mfma_f32_16x16x32_bf16 v[100:103], v[128:131], a[156:159], v[100:103]
    v_fmaak_f32 v11, v11, v7, 0xc0135761
    s_waitcnt vmcnt(13)
    v_mfma_f32_16x16x32_bf16 v[20:23], v[132:135], a[144:147], v[20:23]
    v_fmaak_f32 v12, v12, v7, 0xc0135761
    v_mfma_f32_16x16x32_bf16 v[48:51], v[132:135], a[148:151], v[48:51]
    buffer_load_dwordx4 v[188:191], v2, s[36:39], s54 offen offset:1024 sc1
    v_mfma_f32_16x16x32_bf16 v[76:79], v[132:135], a[152:155], v[76:79]
    v_mul_f32 v11, v11, v236
    v_mfma_f32_16x16x32_bf16 v[104:107], v[132:135], a[156:159], v[104:107]
    v_mul_f32 v12, v12, v237
    s_waitcnt vmcnt(13)
    v_mfma_f32_16x16x32_bf16 v[24:27], v[136:139], a[144:147], v[24:27]
    v_exp_f32 v11, v11
    v_mfma_f32_16x16x32_bf16 v[52:55], v[136:139], a[148:151], v[52:55]
    buffer_load_dwordx4 v[192:195], v2, s[36:39], s54 offen offset:2048 sc1
    v_mfma_f32_16x16x32_bf16 v[80:83], v[136:139], a[152:155], v[80:83]
    v_exp_f32 v12, v12
    v_mfma_f32_16x16x32_bf16 v[108:111], v[136:139], a[156:159], v[108:111]
    v_add_f32 v11, 1.0, v11
    s_waitcnt vmcnt(13)
    v_mfma_f32_16x16x32_bf16 v[28:31], v[140:143], a[144:147], v[28:31]
    v_add_f32 v12, 1.0, v12
    v_mfma_f32_16x16x32_bf16 v[56:59], v[140:143], a[148:151], v[56:59]
    buffer_load_dwordx4 v[196:199], v2, s[36:39], s54 offen offset:3072 sc1
    v_mfma_f32_16x16x32_bf16 v[84:87], v[140:143], a[152:155], v[84:87]
    v_rcp_f32 v11, v11
    v_mfma_f32_16x16x32_bf16 v[112:115], v[140:143], a[156:159], v[112:115]
    v_rcp_f32 v12, v12
    s_waitcnt vmcnt(13)
    v_mfma_f32_16x16x32_bf16 v[32:35], v[144:147], a[144:147], v[32:35]
    v_mul_f32 v236, v236, v11
    v_mfma_f32_16x16x32_bf16 v[60:63], v[144:147], a[148:151], v[60:63]
    s_add_u32 s54, s59, 233472
    buffer_load_dwordx4 v[200:203], v2, s[36:39], s54 offen offset:0 sc1
    v_mfma_f32_16x16x32_bf16 v[88:91], v[144:147], a[152:155], v[88:91]
    v_mul_f32 v237, v237, v12
    v_mfma_f32_16x16x32_bf16 v[116:119], v[144:147], a[156:159], v[116:119]
    v_mul_f32 v11, v238, v238
    s_waitcnt vmcnt(13)
    v_mfma_f32_16x16x32_bf16 v[36:39], v[148:151], a[144:147], v[36:39]
    v_mul_f32 v12, v239, v239
    v_mfma_f32_16x16x32_bf16 v[64:67], v[148:151], a[148:151], v[64:67]
    buffer_load_dwordx4 v[204:207], v2, s[36:39], s54 offen offset:1024 sc1
    v_mfma_f32_16x16x32_bf16 v[92:95], v[148:151], a[152:155], v[92:95]
    v_fmaak_f32 v11, v11, v7, 0xc0135761
    v_mfma_f32_16x16x32_bf16 v[120:123], v[148:151], a[156:159], v[120:123]
    v_fmaak_f32 v12, v12, v7, 0xc0135761
    s_waitcnt vmcnt(13)
    v_mfma_f32_16x16x32_bf16 v[40:43], v[152:155], a[144:147], v[40:43]
    v_mul_f32 v11, v11, v238
    v_mfma_f32_16x16x32_bf16 v[68:71], v[152:155], a[148:151], v[68:71]
    buffer_load_dwordx4 v[208:211], v2, s[36:39], s54 offen offset:2048 sc1
    v_mfma_f32_16x16x32_bf16 v[96:99], v[152:155], a[152:155], v[96:99]
    v_mul_f32 v12, v12, v239
    v_mfma_f32_16x16x32_bf16 v[124:127], v[152:155], a[156:159], v[124:127]
    v_exp_f32 v11, v11
    s_waitcnt vmcnt(13)
    v_mfma_f32_16x16x32_bf16 v[16:19], v[156:159], a[160:163], v[16:19]
    v_exp_f32 v12, v12
    v_mfma_f32_16x16x32_bf16 v[44:47], v[156:159], a[164:167], v[44:47]
    s_add_u32 s54, s56, 344064
    buffer_load_dwordx4 v[128:131], v2, s[36:39], s54 offen offset:0 sc1
    v_mfma_f32_16x16x32_bf16 v[72:75], v[156:159], a[168:171], v[72:75]
    v_add_f32 v11, 1.0, v11
    v_mfma_f32_16x16x32_bf16 v[100:103], v[156:159], a[172:175], v[100:103]
    v_add_f32 v12, 1.0, v12
    s_waitcnt vmcnt(13)
    v_mfma_f32_16x16x32_bf16 v[20:23], v[160:163], a[160:163], v[20:23]
    v_rcp_f32 v11, v11
    v_mfma_f32_16x16x32_bf16 v[48:51], v[160:163], a[164:167], v[48:51]
    buffer_load_dwordx4 v[132:135], v2, s[36:39], s54 offen offset:1024 sc1
    v_mfma_f32_16x16x32_bf16 v[76:79], v[160:163], a[168:171], v[76:79]
    v_rcp_f32 v12, v12
    v_mfma_f32_16x16x32_bf16 v[104:107], v[160:163], a[172:175], v[104:107]
    v_mul_f32 v238, v238, v11
    s_waitcnt vmcnt(13)
    v_mfma_f32_16x16x32_bf16 v[24:27], v[164:167], a[160:163], v[24:27]
    v_mul_f32 v239, v239, v12
    v_mfma_f32_16x16x32_bf16 v[52:55], v[164:167], a[164:167], v[52:55]
    buffer_load_dwordx4 v[136:139], v2, s[36:39], s54 offen offset:2048 sc1
    v_mfma_f32_16x16x32_bf16 v[80:83], v[164:167], a[168:171], v[80:83]
    v_mfma_f32_16x16x32_bf16 v[108:111], v[164:167], a[172:175], v[108:111]
    s_waitcnt vmcnt(13)
    v_mfma_f32_16x16x32_bf16 v[28:31], v[168:171], a[160:163], v[28:31]
    v_mfma_f32_16x16x32_bf16 v[56:59], v[168:171], a[164:167], v[56:59]
    buffer_load_dwordx4 v[140:143], v2, s[36:39], s54 offen offset:3072 sc1
    v_mfma_f32_16x16x32_bf16 v[84:87], v[168:171], a[168:171], v[84:87]
    v_mfma_f32_16x16x32_bf16 v[112:115], v[168:171], a[172:175], v[112:115]
    s_waitcnt vmcnt(13)
    v_mfma_f32_16x16x32_bf16 v[32:35], v[172:175], a[160:163], v[32:35]
    v_mfma_f32_16x16x32_bf16 v[60:63], v[172:175], a[164:167], v[60:63]
    s_add_u32 s54, s56, 348160
    buffer_load_dwordx4 v[144:147], v2, s[36:39], s54 offen offset:0 sc1
    v_mfma_f32_16x16x32_bf16 v[88:91], v[172:175], a[168:171], v[88:91]
    v_mfma_f32_16x16x32_bf16 v[116:119], v[172:175], a[172:175], v[116:119]
    s_waitcnt vmcnt(13)
    v_mfma_f32_16x16x32_bf16 v[36:39], v[176:179], a[160:163], v[36:39]
    v_mfma_f32_16x16x32_bf16 v[64:67], v[176:179], a[164:167], v[64:67]
    buffer_load_dwordx4 v[148:151], v2, s[36:39], s54 offen offset:1024 sc1
    v_mfma_f32_16x16x32_bf16 v[92:95], v[176:179], a[168:171], v[92:95]
    v_mfma_f32_16x16x32_bf16 v[120:123], v[176:179], a[172:175], v[120:123]
    s_waitcnt vmcnt(13)
    v_mfma_f32_16x16x32_bf16 v[40:43], v[180:183], a[160:163], v[40:43]
    v_mfma_f32_16x16x32_bf16 v[68:71], v[180:183], a[164:167], v[68:71]
    buffer_load_dwordx4 v[152:155], v2, s[36:39], s54 offen offset:2048 sc1
    v_mfma_f32_16x16x32_bf16 v[96:99], v[180:183], a[168:171], v[96:99]
    v_mfma_f32_16x16x32_bf16 v[124:127], v[180:183], a[172:175], v[124:127]
    s_waitcnt vmcnt(13)
    v_mfma_f32_16x16x32_bf16 v[16:19], v[184:187], a[176:179], v[16:19]
    v_mfma_f32_16x16x32_bf16 v[44:47], v[184:187], a[180:183], v[44:47]
    s_add_u32 s54, s57, 344064
    buffer_load_dwordx4 v[156:159], v2, s[36:39], s54 offen offset:0 sc1
    v_mfma_f32_16x16x32_bf16 v[72:75], v[184:187], a[184:187], v[72:75]
    v_mfma_f32_16x16x32_bf16 v[100:103], v[184:187], a[188:191], v[100:103]
    s_waitcnt vmcnt(13)
    v_mfma_f32_16x16x32_bf16 v[20:23], v[188:191], a[176:179], v[20:23]
    v_mfma_f32_16x16x32_bf16 v[48:51], v[188:191], a[180:183], v[48:51]
    buffer_load_dwordx4 v[160:163], v2, s[36:39], s54 offen offset:1024 sc1
    v_mfma_f32_16x16x32_bf16 v[76:79], v[188:191], a[184:187], v[76:79]
    v_mfma_f32_16x16x32_bf16 v[104:107], v[188:191], a[188:191], v[104:107]
    s_waitcnt vmcnt(13)
    v_mfma_f32_16x16x32_bf16 v[24:27], v[192:195], a[176:179], v[24:27]
    v_mfma_f32_16x16x32_bf16 v[52:55], v[192:195], a[180:183], v[52:55]
    buffer_load_dwordx4 v[164:167], v2, s[36:39], s54 offen offset:2048 sc1
    v_mfma_f32_16x16x32_bf16 v[80:83], v[192:195], a[184:187], v[80:83]
    v_mfma_f32_16x16x32_bf16 v[108:111], v[192:195], a[188:191], v[108:111]
    s_waitcnt vmcnt(13)
    v_mfma_f32_16x16x32_bf16 v[28:31], v[196:199], a[176:179], v[28:31]
    v_mfma_f32_16x16x32_bf16 v[56:59], v[196:199], a[180:183], v[56:59]
    buffer_load_dwordx4 v[168:171], v2, s[36:39], s54 offen offset:3072 sc1
    v_mfma_f32_16x16x32_bf16 v[84:87], v[196:199], a[184:187], v[84:87]
    v_mfma_f32_16x16x32_bf16 v[112:115], v[196:199], a[188:191], v[112:115]
    s_waitcnt vmcnt(13)
    v_mfma_f32_16x16x32_bf16 v[32:35], v[200:203], a[176:179], v[32:35]
    v_mfma_f32_16x16x32_bf16 v[60:63], v[200:203], a[180:183], v[60:63]
    s_add_u32 s54, s57, 348160
    buffer_load_dwordx4 v[172:175], v2, s[36:39], s54 offen offset:0 sc1
    v_mfma_f32_16x16x32_bf16 v[88:91], v[200:203], a[184:187], v[88:91]
    v_mfma_f32_16x16x32_bf16 v[116:119], v[200:203], a[188:191], v[116:119]
    s_waitcnt vmcnt(13)
    v_mfma_f32_16x16x32_bf16 v[36:39], v[204:207], a[176:179], v[36:39]
    v_mfma_f32_16x16x32_bf16 v[64:67], v[204:207], a[180:183], v[64:67]
    buffer_load_dwordx4 v[176:179], v2, s[36:39], s54 offen offset:1024 sc1
    v_mfma_f32_16x16x32_bf16 v[92:95], v[204:207], a[184:187], v[92:95]
    v_mfma_f32_16x16x32_bf16 v[120:123], v[204:207], a[188:191], v[120:123]
    s_waitcnt vmcnt(13)
    v_mfma_f32_16x16x32_bf16 v[40:43], v[208:211], a[176:179], v[40:43]
    v_mfma_f32_16x16x32_bf16 v[68:71], v[208:211], a[180:183], v[68:71]
    buffer_load_dwordx4 v[180:183], v2, s[36:39], s54 offen offset:2048 sc1
    v_mfma_f32_16x16x32_bf16 v[96:99], v[208:211], a[184:187], v[96:99]
    v_mfma_f32_16x16x32_bf16 v[124:127], v[208:211], a[188:191], v[124:127]
    s_waitcnt vmcnt(13)
    v_mfma_f32_16x16x32_bf16 v[16:19], v[128:131], a[192:195], v[16:19]
    v_mfma_f32_16x16x32_bf16 v[44:47], v[128:131], a[196:199], v[44:47]
    s_add_u32 s54, s58, 344064
    buffer_load_dwordx4 v[184:187], v2, s[36:39], s54 offen offset:0 sc1
    v_mfma_f32_16x16x32_bf16 v[72:75], v[128:131], a[200:203], v[72:75]
    v_mfma_f32_16x16x32_bf16 v[100:103], v[128:131], a[204:207], v[100:103]
    s_waitcnt vmcnt(13)
    v_mfma_f32_16x16x32_bf16 v[20:23], v[132:135], a[192:195], v[20:23]
    v_mfma_f32_16x16x32_bf16 v[48:51], v[132:135], a[196:199], v[48:51]
    buffer_load_dwordx4 v[188:191], v2, s[36:39], s54 offen offset:1024 sc1
    v_mfma_f32_16x16x32_bf16 v[76:79], v[132:135], a[200:203], v[76:79]
    v_mfma_f32_16x16x32_bf16 v[104:107], v[132:135], a[204:207], v[104:107]
    s_waitcnt vmcnt(13)
    v_mfma_f32_16x16x32_bf16 v[24:27], v[136:139], a[192:195], v[24:27]
    v_mfma_f32_16x16x32_bf16 v[52:55], v[136:139], a[196:199], v[52:55]
    buffer_load_dwordx4 v[192:195], v2, s[36:39], s54 offen offset:2048 sc1
    v_mfma_f32_16x16x32_bf16 v[80:83], v[136:139], a[200:203], v[80:83]
    v_mfma_f32_16x16x32_bf16 v[108:111], v[136:139], a[204:207], v[108:111]
    s_waitcnt vmcnt(13)
    v_mfma_f32_16x16x32_bf16 v[28:31], v[140:143], a[192:195], v[28:31]
    v_mfma_f32_16x16x32_bf16 v[56:59], v[140:143], a[196:199], v[56:59]
    buffer_load_dwordx4 v[196:199], v2, s[36:39], s54 offen offset:3072 sc1
    v_mfma_f32_16x16x32_bf16 v[84:87], v[140:143], a[200:203], v[84:87]
    v_mfma_f32_16x16x32_bf16 v[112:115], v[140:143], a[204:207], v[112:115]
    s_waitcnt vmcnt(13)
    v_mfma_f32_16x16x32_bf16 v[32:35], v[144:147], a[192:195], v[32:35]
    v_mfma_f32_16x16x32_bf16 v[60:63], v[144:147], a[196:199], v[60:63]
    s_add_u32 s54, s58, 348160
    buffer_load_dwordx4 v[200:203], v2, s[36:39], s54 offen offset:0 sc1
    v_mfma_f32_16x16x32_bf16 v[88:91], v[144:147], a[200:203], v[88:91]
    v_mfma_f32_16x16x32_bf16 v[116:119], v[144:147], a[204:207], v[116:119]
    s_waitcnt vmcnt(13)
    v_mfma_f32_16x16x32_bf16 v[36:39], v[148:151], a[192:195], v[36:39]
    v_mfma_f32_16x16x32_bf16 v[64:67], v[148:151], a[196:199], v[64:67]
    buffer_load_dwordx4 v[204:207], v2, s[36:39], s54 offen offset:1024 sc1
    v_mfma_f32_16x16x32_bf16 v[92:95], v[148:151], a[200:203], v[92:95]
    v_mfma_f32_16x16x32_bf16 v[120:123], v[148:151], a[204:207], v[120:123]
    s_waitcnt vmcnt(13)
    v_mfma_f32_16x16x32_bf16 v[40:43], v[152:155], a[192:195], v[40:43]
    v_mfma_f32_16x16x32_bf16 v[68:71], v[152:155], a[196:199], v[68:71]
    buffer_load_dwordx4 v[208:211], v2, s[36:39], s54 offen offset:2048 sc1
    v_mfma_f32_16x16x32_bf16 v[96:99], v[152:155], a[200:203], v[96:99]
    v_mfma_f32_16x16x32_bf16 v[124:127], v[152:155], a[204:207], v[124:127]
    s_barrier
    s_waitcnt vmcnt(13)
    v_mfma_f32_16x16x32_bf16 v[16:19], v[156:159], a[208:211], v[16:19]
    v_mfma_f32_16x16x32_bf16 v[44:47], v[156:159], a[212:215], v[44:47]
    s_add_u32 s54, s59, 344064
    buffer_load_dwordx4 v[128:131], v2, s[36:39], s54 offen offset:0 sc1
    v_mfma_f32_16x16x32_bf16 v[72:75], v[156:159], a[216:219], v[72:75]
    v_mfma_f32_16x16x32_bf16 v[100:103], v[156:159], a[220:223], v[100:103]
    s_waitcnt vmcnt(13)
    v_mfma_f32_16x16x32_bf16 v[20:23], v[160:163], a[208:211], v[20:23]
    v_mfma_f32_16x16x32_bf16 v[48:51], v[160:163], a[212:215], v[48:51]
    buffer_load_dwordx4 v[132:135], v2, s[36:39], s54 offen offset:1024 sc1
    v_mfma_f32_16x16x32_bf16 v[76:79], v[160:163], a[216:219], v[76:79]
    v_mfma_f32_16x16x32_bf16 v[104:107], v[160:163], a[220:223], v[104:107]
    s_waitcnt vmcnt(13)
    v_mfma_f32_16x16x32_bf16 v[24:27], v[164:167], a[208:211], v[24:27]
    v_mfma_f32_16x16x32_bf16 v[52:55], v[164:167], a[212:215], v[52:55]
    buffer_load_dwordx4 v[136:139], v2, s[36:39], s54 offen offset:2048 sc1
    v_mfma_f32_16x16x32_bf16 v[80:83], v[164:167], a[216:219], v[80:83]
    v_mfma_f32_16x16x32_bf16 v[108:111], v[164:167], a[220:223], v[108:111]
    s_waitcnt vmcnt(13)
    v_mfma_f32_16x16x32_bf16 v[28:31], v[168:171], a[208:211], v[28:31]
    v_mfma_f32_16x16x32_bf16 v[56:59], v[168:171], a[212:215], v[56:59]
    buffer_load_dwordx4 v[140:143], v2, s[36:39], s54 offen offset:3072 sc1
    v_mfma_f32_16x16x32_bf16 v[84:87], v[168:171], a[216:219], v[84:87]
    v_mfma_f32_16x16x32_bf16 v[112:115], v[168:171], a[220:223], v[112:115]
    s_waitcnt vmcnt(13)
    v_mfma_f32_16x16x32_bf16 v[32:35], v[172:175], a[208:211], v[32:35]
    v_mfma_f32_16x16x32_bf16 v[60:63], v[172:175], a[212:215], v[60:63]
    s_add_u32 s54, s59, 348160
    buffer_load_dwordx4 v[144:147], v2, s[36:39], s54 offen offset:0 sc1
    v_mfma_f32_16x16x32_bf16 v[88:91], v[172:175], a[216:219], v[88:91]
    v_mfma_f32_16x16x32_bf16 v[116:119], v[172:175], a[220:223], v[116:119]
    s_waitcnt vmcnt(13)
    v_mfma_f32_16x16x32_bf16 v[36:39], v[176:179], a[208:211], v[36:39]
    v_mfma_f32_16x16x32_bf16 v[64:67], v[176:179], a[212:215], v[64:67]
    buffer_load_dwordx4 v[148:151], v2, s[36:39], s54 offen offset:1024 sc1
    v_mfma_f32_16x16x32_bf16 v[92:95], v[176:179], a[216:219], v[92:95]
    v_mfma_f32_16x16x32_bf16 v[120:123], v[176:179], a[220:223], v[120:123]
    s_waitcnt vmcnt(13)
    v_mfma_f32_16x16x32_bf16 v[40:43], v[180:183], a[208:211], v[40:43]
    v_mfma_f32_16x16x32_bf16 v[68:71], v[180:183], a[212:215], v[68:71]
    buffer_load_dwordx4 v[152:155], v2, s[36:39], s54 offen offset:2048 sc1
    v_mfma_f32_16x16x32_bf16 v[96:99], v[180:183], a[216:219], v[96:99]
    v_mfma_f32_16x16x32_bf16 v[124:127], v[180:183], a[220:223], v[124:127]
    s_waitcnt vmcnt(13)
    v_mfma_f32_16x16x32_bf16 v[16:19], v[184:187], a[224:227], v[16:19]
    v_mfma_f32_16x16x32_bf16 v[44:47], v[184:187], a[228:231], v[44:47]
    s_mul_i32 s60, s40, 7168
    s_min_u32 s61, s42, 6
    s_lshl_b32 s61, s61, 7
    s_add_u32 s60, s60, s61
    s_add_u32 m0, s69, 0
    s_nop 0
    buffer_load_dwordx4 v4, s[28:31], s60 offen lds
    v_mfma_f32_16x16x32_bf16 v[72:75], v[184:187], a[232:235], v[72:75]
    v_and_b32 v11, 15, v1
    v_lshrrev_b32 v12, 4, v1
    v_mfma_f32_16x16x32_bf16 v[100:103], v[184:187], a[236:239], v[100:103]
    v_lshlrev_b32 v12, 2, v12
    v_sub_u32 v11, v11, v12
    s_waitcnt vmcnt(13)
    v_mfma_f32_16x16x32_bf16 v[20:23], v[188:191], a[224:227], v[20:23]
    v_mfma_f32_16x16x32_bf16 v[48:51], v[188:191], a[228:231], v[48:51]
    s_add_u32 m0, s69, 4096
    s_add_u32 s60, s60, 28672
    buffer_load_dwordx4 v4, s[28:31], s60 offen lds
    v_mfma_f32_16x16x32_bf16 v[76:79], v[188:191], a[232:235], v[76:79]
    v_mov_b32 v12, 0x3f80
    v_mov_b32 v13, 0x3f800000
    v_mfma_f32_16x16x32_bf16 v[104:107], v[188:191], a[236:239], v[104:107]
    v_mov_b32 v172, 0
    v_mov_b32 v173, 0
    s_waitcnt vmcnt(13)
    v_mfma_f32_16x16x32_bf16 v[24:27], v[192:195], a[224:227], v[24:27]
    v_mfma_f32_16x16x32_bf16 v[52:55], v[192:195], a[228:231], v[52:55]
    s_add_u32 m0, s69, 8192
    s_add_u32 s60, s60, 28672
    buffer_load_dwordx4 v4, s[28:31], s60 offen lds
    v_mfma_f32_16x16x32_bf16 v[80:83], v[192:195], a[232:235], v[80:83]
    v_mov_b32 v176, 0
    v_mov_b32 v177, 0
    v_mfma_f32_16x16x32_bf16 v[108:111], v[192:195], a[236:239], v[108:111]
    v_cmp_eq_u32 vcc, 0, v11
    s_nop 1
    v_cndmask_b32 v14, 0, v12, vcc
    s_waitcnt vmcnt(13)
    v_mfma_f32_16x16x32_bf16 v[28:31], v[196:199], a[224:227], v[28:31]
    v_mfma_f32_16x16x32_bf16 v[56:59], v[196:199], a[228:231], v[56:59]
    s_add_u32 m0, s69, 12288
    s_add_u32 s60, s60, 28672
    buffer_load_dwordx4 v4, s[28:31], s60 offen lds
    v_mfma_f32_16x16x32_bf16 v[84:87], v[196:199], a[232:235], v[84:87]
    v_cmp_eq_u32 vcc, 1, v11
    s_nop 1
    v_cndmask_b32 v174, v14, v13, vcc
    v_mfma_f32_16x16x32_bf16 v[112:115], v[196:199], a[236:239], v[112:115]
    v_cmp_eq_u32 vcc, 2, v11
    s_nop 1
    v_cndmask_b32 v14, 0, v12, vcc
    s_waitcnt vmcnt(13)
    v_mfma_f32_16x16x32_bf16 v[32:35], v[200:203], a[224:227], v[32:35]
    v_mfma_f32_16x16x32_bf16 v[60:63], v[200:203], a[228:231], v[60:63]
    s_add_u32 m0, s69, 16384
    s_add_u32 s60, s60, 28672
    buffer_load_dwordx4 v4, s[28:31], s60 offen lds
    v_mfma_f32_16x16x32_bf16 v[88:91], v[200:203], a[232:235], v[88:91]
    v_cmp_eq_u32 vcc, 3, v11
    s_nop 1
    v_cndmask_b32 v175, v14, v13, vcc
    v_mfma_f32_16x16x32_bf16 v[116:119], v[200:203], a[236:239], v[116:119]
    v_mov_b32 v178, v174
    v_mov_b32 v179, v175
    s_waitcnt vmcnt(13)
    v_mfma_f32_16x16x32_bf16 v[36:39], v[204:207], a[224:227], v[36:39]
    v_mfma_f32_16x16x32_bf16 v[64:67], v[204:207], a[228:231], v[64:67]
    s_add_u32 m0, s69, 20480
    s_add_u32 s60, s60, 28672
    buffer_load_dwordx4 v4, s[28:31], s60 offen lds
    v_mfma_f32_16x16x32_bf16 v[92:95], v[204:207], a[232:235], v[92:95]
    v_mov_b32 v180, v174
    v_mov_b32 v181, v175
    v_mfma_f32_16x16x32_bf16 v[120:123], v[204:207], a[236:239], v[120:123]
    s_waitcnt vmcnt(13)
    v_mfma_f32_16x16x32_bf16 v[40:43], v[208:211], a[224:227], v[40:43]
    v_mfma_f32_16x16x32_bf16 v[68:71], v[208:211], a[228:231], v[68:71]
    s_add_u32 m0, s69, 24576
    s_add_u32 s60, s60, 28672
    buffer_load_dwordx4 v4, s[28:31], s60 offen lds
    v_mfma_f32_16x16x32_bf16 v[96:99], v[208:211], a[232:235], v[96:99]
    v_mfma_f32_16x16x32_bf16 v[124:127], v[208:211], a[236:239], v[124:127]
    s_waitcnt vmcnt(13)
    v_mfma_f32_16x16x32_bf16 v[16:19], v[128:131], a[240:243], v[16:19]
    s_add_u32 m0, s69, 28672
    s_add_u32 s60, s60, 28672
    buffer_load_dwordx4 v4, s[28:31], s60 offen lds
    s_waitcnt vmcnt(13)
    v_mfma_f32_16x16x32_bf16 v[20:23], v[132:135], a[240:243], v[20:23]
    s_add_u32 m0, s69, 32768
    s_add_u32 s60, s60, 28672
    buffer_load_dwordx4 v4, s[28:31], s60 offen lds
    s_waitcnt vmcnt(13)
    v_mfma_f32_16x16x32_bf16 v[24:27], v[136:139], a[240:243], v[24:27]
    s_add_u32 m0, s69, 36864
    s_add_u32 s60, s60, 28672
    buffer_load_dwordx4 v4, s[28:31], s60 offen lds
    s_waitcnt vmcnt(13)
    v_mfma_f32_16x16x32_bf16 v[28:31], v[140:143], a[240:243], v[28:31]
    s_add_u32 m0, s69, 40960
    s_add_u32 s60, s60, 28672
    buffer_load_dwordx4 v4, s[28:31], s60 offen lds
    s_waitcnt vmcnt(13)
    v_mfma_f32_16x16x32_bf16 v[32:35], v[144:147], a[240:243], v[32:35]
    s_add_u32 m0, s69, 45056
    s_add_u32 s60, s60, 28672
    buffer_load_dwordx4 v4, s[28:31], s60 offen lds
    s_waitcnt vmcnt(13)
    v_mfma_f32_16x16x32_bf16 v[36:39], v[148:151], a[240:243], v[36:39]
    s_add_u32 m0, s69, 49152
    s_add_u32 s60, s60, 28672
    buffer_load_dwordx4 v4, s[28:31], s60 offen lds
    s_waitcnt vmcnt(13)
    v_mfma_f32_16x16x32_bf16 v[40:43], v[152:155], a[240:243], v[40:43]
    s_add_u32 m0, s69, 53248
    s_add_u32 s60, s60, 28672
    buffer_load_dwordx4 v4, s[28:31], s60 offen lds
    v_mfma_f32_16x16x32_bf16 v[44:47], v[128:131], a[244:247], v[44:47]
    v_mfma_f32_16x16x32_bf16 v[48:51], v[132:135], a[244:247], v[48:51]
    v_mfma_f32_16x16x32_bf16 v[52:55], v[136:139], a[244:247], v[52:55]
    v_cvt_pk_bf16_f32 v184, v16, v17
    v_cvt_pk_bf16_f32 v185, v18, v19
    v_cvt_pk_bf16_f32 v186, v20, v21
    v_cvt_pk_bf16_f32 v187, v22, v23
    ds_write_b128 v5, v[184:187] offset:0
    v_mfma_f32_16x16x32_bf16 v[56:59], v[140:143], a[244:247], v[56:59]
    v_mfma_f32_16x16x32_bf16 v[60:63], v[144:147], a[244:247], v[60:63]
    v_cvt_pk_bf16_f32 v188, v24, v25
    v_cvt_pk_bf16_f32 v189, v26, v27
    v_cvt_pk_bf16_f32 v190, v28, v29
    v_cvt_pk_bf16_f32 v191, v30, v31
    ds_write_b128 v5, v[188:191] offset:1024
    v_mfma_f32_16x16x32_bf16 v[64:67], v[148:151], a[244:247], v[64:67]
    v_cvt_pk_bf16_f32 v192, v32, v33
    v_cvt_pk_bf16_f32 v193, v34, v35
    v_cvt_pk_bf16_f32 v194, v36, v37
    v_cvt_pk_bf16_f32 v195, v38, v39
    ds_write_b128 v5, v[192:195] offset:2048
    v_mfma_f32_16x16x32_bf16 v[68:71], v[152:155], a[244:247], v[68:71]
    v_cvt_pk_bf16_f32 v196, v40, v41
    v_cvt_pk_bf16_f32 v197, v42, v43
    ds_write_b64 v6, v[196:197] offset:3072
    v_mfma_f32_16x16x32_bf16 v[72:75], v[128:131], a[248:251], v[72:75]
    v_mfma_f32_16x16x32_bf16 v[76:79], v[132:135], a[248:251], v[76:79]
    v_mfma_f32_16x16x32_bf16 v[80:83], v[136:139], a[248:251], v[80:83]
    v_cvt_pk_bf16_f32 v198, v44, v45
    v_cvt_pk_bf16_f32 v199, v46, v47
    v_cvt_pk_bf16_f32 v200, v48, v49
    v_cvt_pk_bf16_f32 v201, v50, v51
    ds_write_b128 v5, v[198:201] offset:3584
    v_mfma_f32_16x16x32_bf16 v[84:87], v[140:143], a[248:251], v[84:87]
    v_mfma_f32_16x16x32_bf16 v[88:91], v[144:147], a[248:251], v[88:91]
    v_cvt_pk_bf16_f32 v202, v52, v53
    v_cvt_pk_bf16_f32 v203, v54, v55
    v_cvt_pk_bf16_f32 v204, v56, v57
    v_cvt_pk_bf16_f32 v205, v58, v59
    ds_write_b128 v5, v[202:205] offset:4608
    v_mfma_f32_16x16x32_bf16 v[92:95], v[148:151], a[248:251], v[92:95]
    v_cvt_pk_bf16_f32 v206, v60, v61
    v_cvt_pk_bf16_f32 v207, v62, v63
    v_cvt_pk_bf16_f32 v208, v64, v65
    v_cvt_pk_bf16_f32 v209, v66, v67
    ds_write_b128 v5, v[206:209] offset:5632
    v_mfma_f32_16x16x32_bf16 v[96:99], v[152:155], a[248:251], v[96:99]
    v_cvt_pk_bf16_f32 v210, v68, v69
    v_cvt_pk_bf16_f32 v211, v70, v71
    ds_write_b64 v6, v[210:211] offset:6656
    v_mfma_f32_16x16x32_bf16 v[100:103], v[128:131], a[252:255], v[100:103]
    v_mfma_f32_16x16x32_bf16 v[104:107], v[132:135], a[252:255], v[104:107]
    v_mfma_f32_16x16x32_bf16 v[108:111], v[136:139], a[252:255], v[108:111]
    v_cvt_pk_bf16_f32 v184, v72, v73
    v_cvt_pk_bf16_f32 v185, v74, v75
    v_cvt_pk_bf16_f32 v186, v76, v77
    v_cvt_pk_bf16_f32 v187, v78, v79
    ds_write_b128 v5, v[184:187] offset:7168
    v_mfma_f32_16x16x32_bf16 v[112:115], v[140:143], a[252:255], v[112:115]
    v_mfma_f32_16x16x32_bf16 v[116:119], v[144:147], a[252:255], v[116:119]
    v_cvt_pk_bf16_f32 v188, v80, v81
    v_cvt_pk_bf16_f32 v189, v82, v83
    v_cvt_pk_bf16_f32 v190, v84, v85
    v_cvt_pk_bf16_f32 v191, v86, v87
    ds_write_b128 v5, v[188:191] offset:8192
    v_mfma_f32_16x16x32_bf16 v[120:123], v[148:151], a[252:255], v[120:123]
    v_cvt_pk_bf16_f32 v192, v88, v89
    v_cvt_pk_bf16_f32 v193, v90, v91
    v_cvt_pk_bf16_f32 v194, v92, v93
    v_cvt_pk_bf16_f32 v195, v94, v95
    ds_write_b128 v5, v[192:195] offset:9216
    v_mfma_f32_16x16x32_bf16 v[124:127], v[152:155], a[252:255], v[124:127]
    v_cvt_pk_bf16_f32 v196, v96, v97
    v_cvt_pk_bf16_f32 v197, v98, v99
    ds_write_b64 v6, v[196:197] offset:10240
    s_mul_i32 s54, s47, 28672
    s_mul_i32 s55, s42, 3584
    s_add_u32 s54, s54, s55
    s_add_u32 s54, s54, 17825792
    v_lshlrev_b32 v11, 3, v1
    v_mov_b32 v70, 0
    v_mov_b32 v71, 0
    s_waitcnt lgkmcnt(0)
    s_barrier
    ds_read_b128 v[16:19], v8 offset:0
    ds_read_b128 v[32:35], v9 offset:0
    ds_read_b128 v[48:51], v10 offset:0
    ds_read_b128 v[20:23], v8 offset:1024
    ds_read_b128 v[36:39], v9 offset:1024
    ds_read_b128 v[52:55], v10 offset:1024
    ds_read_b128 v[24:27], v8 offset:2048
    ds_read_b128 v[40:43], v9 offset:2048
    ds_read_b128 v[56:59], v10 offset:2048
    ds_read_b64 v[64:65], v244 offset:3072
    ds_read_b64 v[66:67], v245 offset:3072
    ds_read_b64 v[68:69], v246 offset:3072
    s_lshl_b32 s49, s47, 5
    s_add_u32 s49, s49, s42
    s_lshl_b32 s49, s49, 2
    s_add_u32 s49, s49, 245760
    s_waitcnt lgkmcnt(11)
    v_mfma_f32_16x16x32_bf16 v[100:103], v[174:177], v[16:19], v[100:103]
    v_mfma_f32_16x16x32_bf16 v[104:107], v[172:175], v[16:19], v[104:107]
    s_waitcnt lgkmcnt(10)
    v_mfma_f32_16x16x32_bf16 v[100:103], v[174:177], v[32:35], v[100:103]
    v_mfma_f32_16x16x32_bf16 v[104:107], v[172:175], v[32:35], v[104:107]
    s_waitcnt lgkmcnt(9)
    v_mfma_f32_16x16x32_bf16 v[100:103], v[174:177], v[48:51], v[100:103]
    v_mfma_f32_16x16x32_bf16 v[104:107], v[172:175], v[48:51], v[104:107]
    s_waitcnt lgkmcnt(8)
    v_mfma_f32_16x16x32_bf16 v[108:111], v[174:177], v[20:23], v[108:111]
    v_mfma_f32_16x16x32_bf16 v[112:115], v[172:175], v[20:23], v[112:115]
    s_waitcnt lgkmcnt(7)
    v_mfma_f32_16x16x32_bf16 v[108:111], v[174:177], v[36:39], v[108:111]
    v_mfma_f32_16x16x32_bf16 v[112:115], v[172:175], v[36:39], v[112:115]
    s_waitcnt lgkmcnt(6)
    v_mfma_f32_16x16x32_bf16 v[108:111], v[174:177], v[52:55], v[108:111]
    v_mfma_f32_16x16x32_bf16 v[112:115], v[172:175], v[52:55], v[112:115]
    s_waitcnt lgkmcnt(5)
    v_mfma_f32_16x16x32_bf16 v[116:119], v[174:177], v[24:27], v[116:119]
    v_mfma_f32_16x16x32_bf16 v[120:123], v[172:175], v[24:27], v[120:123]
    s_waitcnt lgkmcnt(4)
    v_mfma_f32_16x16x32_bf16 v[116:119], v[174:177], v[40:43], v[116:119]
    v_mfma_f32_16x16x32_bf16 v[120:123], v[172:175], v[40:43], v[120:123]
    s_waitcnt lgkmcnt(3)
    v_mfma_f32_16x16x32_bf16 v[116:119], v[174:177], v[56:59], v[116:119]
    v_mfma_f32_16x16x32_bf16 v[120:123], v[172:175], v[56:59], v[120:123]
    s_waitcnt lgkmcnt(1)
    v_mfma_f32_16x16x32_bf16 v[124:127], v[178:181], v[64:67], v[124:127]
    s_waitcnt lgkmcnt(0)
    v_mfma_f32_16x16x32_bf16 v[124:127], v[174:177], v[68:71], v[124:127]
    v_mul_f32 v100, v100, v212
    v_mul_f32 v101, v101, v213
    v_mul_f32 v102, v102, v214
    v_mul_f32 v103, v103, v215
    v_mul_f32 v104, v104, v216
    v_mul_f32 v105, v105, v217
    v_mul_f32 v106, v106, v218
    v_mul_f32 v107, v107, v219
    v_cvt_pk_bf16_f32 v128, v100, v101
    v_cvt_pk_bf16_f32 v129, v102, v103
    v_cvt_pk_bf16_f32 v130, v104, v105
    v_cvt_pk_bf16_f32 v131, v106, v107
    buffer_store_dwordx4 v[128:131], v2, s[36:39], s54 offen offset:0 sc1
    v_mul_f32 v108, v108, v220
    v_mul_f32 v109, v109, v221
    v_mul_f32 v110, v110, v222
    v_mul_f32 v111, v111, v223
    v_mul_f32 v112, v112, v224
    v_mul_f32 v113, v113, v225
    v_mul_f32 v114, v114, v226
    v_mul_f32 v115, v115, v227
    v_cvt_pk_bf16_f32 v132, v108, v109
    v_cvt_pk_bf16_f32 v133, v110, v111
    v_cvt_pk_bf16_f32 v134, v112, v113
    v_cvt_pk_bf16_f32 v135, v114, v115
    buffer_store_dwordx4 v[132:135], v2, s[36:39], s54 offen offset:1024 sc1
    v_mul_f32 v116, v116, v228
    v_mul_f32 v117, v117, v229
    v_mul_f32 v118, v118, v230
    v_mul_f32 v119, v119, v231
    v_mul_f32 v120, v120, v232
    v_mul_f32 v121, v121, v233
    v_mul_f32 v122, v122, v234
    v_mul_f32 v123, v123, v235
    v_cvt_pk_bf16_f32 v136, v116, v117
    v_cvt_pk_bf16_f32 v137, v118, v119
    v_cvt_pk_bf16_f32 v138, v120, v121
    v_cvt_pk_bf16_f32 v139, v122, v123
    buffer_store_dwordx4 v[136:139], v2, s[36:39], s54 offen offset:2048 sc1
    v_mul_f32 v124, v124, v236
    v_mul_f32 v125, v125, v237
    v_mul_f32 v126, v126, v238
    v_mul_f32 v127, v127, v239
    v_cvt_pk_bf16_f32 v140, v124, v125
    v_cvt_pk_bf16_f32 v141, v126, v127
    buffer_store_dwordx2 v[140:141], v11, s[36:39], s54 offen offset:3072 sc1
    s_add_u32 m0, s69, 57344
    s_add_u32 s60, s60, 28672
    buffer_load_dwordx4 v4, s[28:31], s60 offen lds
    s_add_u32 m0, s69, 61440
    s_add_u32 s60, s60, 28672
    buffer_load_dwordx4 v4, s[28:31], s60 offen lds
    s_add_u32 m0, s69, 65536
    s_add_u32 s60, s60, 28672
    buffer_load_dwordx4 v4, s[28:31], s60 offen lds
    s_add_u32 m0, s69, 69632
    s_add_u32 s60, s60, 28672
    buffer_load_dwordx4 v4, s[28:31], s60 offen lds
    s_add_u32 m0, s69, 73728
    s_add_u32 s60, s60, 28672
    buffer_load_dwordx4 v4, s[28:31], s60 offen lds
    s_add_u32 m0, s69, 77824
    s_add_u32 s60, s60, 28672
    buffer_load_dwordx4 v4, s[28:31], s60 offen lds
    v_mov_b32 v12, s45
    v_mov_b32 v13, 0
    s_waitcnt vmcnt(6)
    s_mov_b64 exec, 1
    buffer_store_dword v12, v13, s[36:39], s49 offen sc1
    s_mov_b64 exec, -1
    s_barrier
    s_add_u32 m0, s69, 81920
    s_add_u32 s60, s60, 28672
    buffer_load_dwordx4 v4, s[28:31], s60 offen lds
    s_add_u32 m0, s69, 86016
    s_add_u32 s60, s60, 28672
    buffer_load_dwordx4 v4, s[28:31], s60 offen lds
    s_add_u32 m0, s69, 90112
    s_add_u32 s60, s60, 28672
    buffer_load_dwordx4 v4, s[28:31], s60 offen lds
    s_add_u32 m0, s69, 94208
    s_add_u32 s60, s60, 28672
    buffer_load_dwordx4 v4, s[28:31], s60 offen lds
    s_add_u32 m0, s69, 98304
    s_add_u32 s60, s60, 28672
    buffer_load_dwordx4 v4, s[28:31], s60 offen lds
    s_add_u32 m0, s69, 102400
    s_add_u32 s60, s60, 28672
    buffer_load_dwordx4 v4, s[28:31], s60 offen lds
    s_add_u32 m0, s69, 106496
    s_add_u32 s60, s60, 28672
    buffer_load_dwordx4 v4, s[28:31], s60 offen lds
    s_add_u32 m0, s69, 110592
    s_add_u32 s60, s60, 28672
    buffer_load_dwordx4 v4, s[28:31], s60 offen lds
    s_lshl_b32 s49, s2, 2
    s_add_u32 s49, s49, s40
    s_cmp_lg_u32 s49, 0
    s_cbranch_scc1 L_bump_40
    s_add_u32 s49, s46, 1
    v_mov_b32 v12, s49
    v_mov_b32 v13, 0
    buffer_store_dword v12, v13, s[36:39], 0 offen sc1
L_bump_40:
    s_cmp_eq_u32 s42, 7
    s_cbranch_scc1 L_fin
    v_lshrrev_b32 v185, 4, v1
    v_bfe_u32 v186, v1, 2, 2
    v_and_b32 v187, 3, v1
    v_and_b32 v188, 1, v185
    v_lshrrev_b32 v189, 1, v186
    v_lshl_add_u32 v189, v188, 1, v189
    v_lshl_add_u32 v190, v185, 2, v186
    v_lshlrev_b32 v190, 7, v190
    v_lshl_add_u32 v190, v187, 3, v190
    v_lshlrev_b32 v5, 3, v1
    v_xor_b32 v192, 0, v189
    v_lshl_add_u32 v176, v192, 5, v190
    v_add_u32 v180, 57344, v176
    v_xor_b32 v192, 1, v189
    v_lshl_add_u32 v177, v192, 5, v190
    v_add_u32 v181, 57344, v177
    v_xor_b32 v192, 2, v189
    v_lshl_add_u32 v178, v192, 5, v190
    v_add_u32 v182, 57344, v178
    v_xor_b32 v192, 3, v189
    v_lshl_add_u32 v179, v192, 5, v190
    v_add_u32 v183, 57344, v179
    s_lshl_b32 s53, s47, 7
    s_add_u32 s53, s53, 245760
    v_and_b32 v184, 7, v1
    v_lshl_add_u32 v4, v184, 2, s53
    s_mul_i32 s53, s47, 28672
    s_add_u32 s53, s53, 17825792
    v_and_b32 v184, 15, v1
    v_mul_u32_u24 v184, 896, v184
    v_lshl_add_u32 v184, v188, 5, v184
    v_lshrrev_b32 v185, 5, v1
    v_lshl_add_u32 v184, v185, 4, v184
    s_mul_i32 s55, s47, 14336
    s_lshl_b32 s54, s42, 7
    s_add_u32 s55, s55, s54
    buffer_load_dword v193, v4, s[36:39], 0 offen sc1
    v_lshlrev_b32 v128, 16, v248
    v_and_b32 v129, 0xffff0000, v248
    v_lshlrev_b32 v130, 16, v249
    v_and_b32 v131, 0xffff0000, v249
    v_lshlrev_b32 v132, 16, v250
    v_and_b32 v133, 0xffff0000, v250
    v_lshlrev_b32 v134, 16, v251
    v_and_b32 v135, 0xffff0000, v251
    v_lshlrev_b32 v136, 16, v252
    v_and_b32 v137, 0xffff0000, v252
    v_lshlrev_b32 v138, 16, v253
    v_and_b32 v139, 0xffff0000, v253
    v_lshlrev_b32 v140, 16, v254
    v_and_b32 v141, 0xffff0000, v254
    v_lshlrev_b32 v142, 16, v255
    v_and_b32 v143, 0xffff0000, v255
    ds_read_b64_tr_b16 a[0:1], v176 offset:0
    ds_read_b64_tr_b16 a[2:3], v176 offset:2048
    ds_read_b64_tr_b16 a[4:5], v177 offset:0
    ds_read_b64_tr_b16 a[6:7], v177 offset:2048
    ds_read_b64_tr_b16 a[8:9], v178 offset:0
    ds_read_b64_tr_b16 a[10:11], v178 offset:2048
    ds_read_b64_tr_b16 a[12:13], v179 offset:0
    ds_read_b64_tr_b16 a[14:15], v179 offset:2048
    ds_read_b64_tr_b16 a[16:17], v176 offset:4096
    ds_read_b64_tr_b16 a[18:19], v176 offset:6144
    ds_read_b64_tr_b16 a[20:21], v177 offset:4096
    ds_read_b64_tr_b16 a[22:23], v177 offset:6144
    ds_read_b64_tr_b16 a[24:25], v178 offset:4096
    ds_read_b64_tr_b16 a[26:27], v178 offset:6144
    ds_read_b64_tr_b16 a[28:29], v179 offset:4096
    ds_read_b64_tr_b16 a[30:31], v179 offset:6144
    ds_read_b64_tr_b16 a[32:33], v176 offset:8192
    ds_read_b64_tr_b16 a[34:35], v176 offset:10240
    ds_read_b64_tr_b16 a[36:37], v177 offset:8192
    ds_read_b64_tr_b16 a[38:39], v177 offset:10240
    ds_read_b64_tr_b16 a[40:41], v178 offset:8192
    ds_read_b64_tr_b16 a[42:43], v178 offset:10240
    ds_read_b64_tr_b16 a[44:45], v179 offset:8192
    ds_read_b64_tr_b16 a[46:47], v179 offset:10240
    ds_read_b64_tr_b16 a[48:49], v176 offset:14336
    ds_read_b64_tr_b16 a[50:51], v176 offset:16384
    ds_read_b64_tr_b16 a[52:53], v177 offset:14336
    ds_read_b64_tr_b16 a[54:55], v177 offset:16384
    ds_read_b64_tr_b16 a[56:57], v178 offset:14336
    ds_read_b64_tr_b16 a[58:59], v178 offset:16384
    ds_read_b64_tr_b16 a[60:61], v179 offset:14336
    ds_read_b64_tr_b16 a[62:63], v179 offset:16384
    ds_read_b64_tr_b16 a[64:65], v176 offset:18432
    ds_read_b64_tr_b16 a[66:67], v176 offset:20480
    ds_read_b64_tr_b16 a[68:69], v177 offset:18432
    ds_read_b64_tr_b16 a[70:71], v177 offset:20480
    ds_read_b64_tr_b16 a[72:73], v178 offset:18432
    ds_read_b64_tr_b16 a[74:75], v178 offset:20480
    ds_read_b64_tr_b16 a[76:77], v179 offset:18432
    ds_read_b64_tr_b16 a[78:79], v179 offset:20480
    ds_read_b64_tr_b16 a[80:81], v176 offset:22528
    ds_read_b64_tr_b16 a[82:83], v176 offset:24576
    ds_read_b64_tr_b16 a[84:85], v177 offset:22528
    ds_read_b64_tr_b16 a[86:87], v177 offset:24576
    ds_read_b64_tr_b16 a[88:89], v178 offset:22528
    ds_read_b64_tr_b16 a[90:91], v178 offset:24576
    ds_read_b64_tr_b16 a[92:93], v179 offset:22528
    ds_read_b64_tr_b16 a[94:95], v179 offset:24576
    ds_read_b64_tr_b16 a[96:97], v176 offset:12288
    ds_read_b64_tr_b16 a[98:99], v176 offset:26624
    ds_read_b64_tr_b16 a[100:101], v177 offset:12288
    ds_read_b64_tr_b16 a[102:103], v177 offset:26624
    ds_read_b64_tr_b16 a[104:105], v178 offset:12288
    ds_read_b64_tr_b16 a[106:107], v178 offset:26624
    ds_read_b64_tr_b16 a[108:109], v179 offset:12288
    ds_read_b64_tr_b16 a[110:111], v179 offset:26624
    ds_read_b64_tr_b16 a[112:113], v176 offset:28672
    ds_read_b64_tr_b16 a[114:115], v176 offset:30720
    ds_read_b64_tr_b16 a[116:117], v177 offset:28672
    ds_read_b64_tr_b16 a[118:119], v177 offset:30720
    ds_read_b64_tr_b16 a[120:121], v178 offset:28672
    ds_read_b64_tr_b16 a[122:123], v178 offset:30720
    ds_read_b64_tr_b16 a[124:125], v179 offset:28672
    ds_read_b64_tr_b16 a[126:127], v179 offset:30720
    s_mov_b32 s48, 0
    s_branch L_pollc_42
L_poll_41:
    buffer_load_dword v193, v4, s[36:39], 0 offen sc1
L_pollc_42:
    s_add_u32 s48, s48, 1
    s_cmp_gt_u32 s48, 0x80000
    s_waitcnt vmcnt(0)
    s_cbranch_scc1 L_polld_43
    v_cmp_ne_u32 vcc, s45, v193
    s_nop 1
    s_cbranch_vccnz L_poll_41
L_polld_43:
    s_add_u32 s56, s53, 14336
    buffer_load_dwordx4 v[72:75], v2, s[36:39], s56 offen offset:0 sc1
    ds_read_b64_tr_b16 a[128:129], v176 offset:32768
    ds_read_b64_tr_b16 a[130:131], v176 offset:34816
    ds_read_b64_tr_b16 a[132:133], v177 offset:32768
    ds_read_b64_tr_b16 a[134:135], v177 offset:34816
    ds_read_b64_tr_b16 a[136:137], v178 offset:32768
    buffer_load_dwordx4 v[76:79], v2, s[36:39], s56 offen offset:1024 sc1
    ds_read_b64_tr_b16 a[138:139], v178 offset:34816
    ds_read_b64_tr_b16 a[140:141], v179 offset:32768
    ds_read_b64_tr_b16 a[142:143], v179 offset:34816
    ds_read_b64_tr_b16 a[144:145], v176 offset:36864
    ds_read_b64_tr_b16 a[146:147], v176 offset:38912
    buffer_load_dwordx4 v[80:83], v2, s[36:39], s56 offen offset:2048 sc1
    ds_read_b64_tr_b16 a[148:149], v177 offset:36864
    ds_read_b64_tr_b16 a[150:151], v177 offset:38912
    ds_read_b64_tr_b16 a[152:153], v178 offset:36864
    ds_read_b64_tr_b16 a[154:155], v178 offset:38912
    ds_read_b64_tr_b16 a[156:157], v179 offset:36864
    buffer_load_dwordx2 v[96:97], v5, s[36:39], s56 offen offset:3072 sc1
    ds_read_b64_tr_b16 a[158:159], v179 offset:38912
    ds_read_b64_tr_b16 a[160:161], v176 offset:43008
    ds_read_b64_tr_b16 a[162:163], v176 offset:45056
    ds_read_b64_tr_b16 a[164:165], v177 offset:43008
    ds_read_b64_tr_b16 a[166:167], v177 offset:45056
    s_add_u32 s56, s53, 17920
    buffer_load_dwordx4 v[84:87], v2, s[36:39], s56 offen offset:0 sc1
    ds_read_b64_tr_b16 a[168:169], v178 offset:43008
    ds_read_b64_tr_b16 a[170:171], v178 offset:45056
    ds_read_b64_tr_b16 a[172:173], v179 offset:43008
    ds_read_b64_tr_b16 a[174:175], v179 offset:45056
    buffer_load_dwordx4 v[88:91], v2, s[36:39], s56 offen offset:1024 sc1
    ds_read_b64_tr_b16 a[176:177], v176 offset:47104
    ds_read_b64_tr_b16 a[178:179], v176 offset:49152
    ds_read_b64_tr_b16 a[180:181], v177 offset:47104
    ds_read_b64_tr_b16 a[182:183], v177 offset:49152
    ds_read_b64_tr_b16 a[184:185], v178 offset:47104
    buffer_load_dwordx4 v[92:95], v2, s[36:39], s56 offen offset:2048 sc1
    ds_read_b64_tr_b16 a[186:187], v178 offset:49152
    ds_read_b64_tr_b16 a[188:189], v179 offset:47104
    ds_read_b64_tr_b16 a[190:191], v179 offset:49152
    ds_read_b64_tr_b16 a[192:193], v176 offset:51200
    ds_read_b64_tr_b16 a[194:195], v176 offset:53248
    buffer_load_dwordx2 v[98:99], v5, s[36:39], s56 offen offset:3072 sc1
    ds_read_b64_tr_b16 a[196:197], v177 offset:51200
    ds_read_b64_tr_b16 a[198:199], v177 offset:53248
    ds_read_b64_tr_b16 a[200:201], v178 offset:51200
    ds_read_b64_tr_b16 a[202:203], v178 offset:53248
    ds_read_b64_tr_b16 a[204:205], v179 offset:51200
    s_add_u32 s56, s53, 21504
    buffer_load_dwordx4 v[100:103], v2, s[36:39], s56 offen offset:0 sc1
    ds_read_b64_tr_b16 a[206:207], v179 offset:53248
    ds_read_b64_tr_b16 a[208:209], v176 offset:40960
    ds_read_b64_tr_b16 a[210:211], v176 offset:55296
    ds_read_b64_tr_b16 a[212:213], v177 offset:40960
    ds_read_b64_tr_b16 a[214:215], v177 offset:55296
    buffer_load_dwordx4 v[104:107], v2, s[36:39], s56 offen offset:1024 sc1
    ds_read_b64_tr_b16 a[216:217], v178 offset:40960
    ds_read_b64_tr_b16 a[218:219], v178 offset:55296
    ds_read_b64_tr_b16 a[220:221], v179 offset:40960
    ds_read_b64_tr_b16 a[222:223], v179 offset:55296
    s_barrier
    ds_read_b64_tr_b16 v[144:145], v180 offset:0
    ds_read_b64_tr_b16 v[146:147], v180 offset:2048
    ds_read_b64_tr_b16 v[148:149], v181 offset:0
    ds_read_b64_tr_b16 v[150:151], v181 offset:2048
    ds_read_b64_tr_b16 v[152:153], v182 offset:0
    ds_read_b64_tr_b16 v[154:155], v182 offset:2048
    ds_read_b64_tr_b16 v[156:157], v183 offset:0
    ds_read_b64_tr_b16 v[158:159], v183 offset:2048
    ds_read_b64_tr_b16 v[160:161], v180 offset:4096
    ds_read_b64_tr_b16 v[162:163], v180 offset:6144
    ds_read_b64_tr_b16 v[164:165], v181 offset:4096
    ds_read_b64_tr_b16 v[166:167], v181 offset:6144
    s_waitcnt vmcnt(9) lgkmcnt(8)
    v_mfma_f32_16x16x32_bf16 v[132:135], v[148:151], v[72:75], v[132:135]
    v_mfma_f32_16x16x32_bf16 v[128:131], v[144:147], v[72:75], v[128:131]
    buffer_load_dwordx4 v[108:111], v2, s[36:39], s56 offen offset:2048 sc1
    ds_read_b64_tr_b16 v[168:169], v182 offset:4096
    ds_read_b64_tr_b16 v[170:171], v182 offset:6144
    ds_read_b64_tr_b16 v[172:173], v183 offset:4096
    ds_read_b64_tr_b16 v[174:175], v183 offset:6144
    s_waitcnt lgkmcnt(8)
    v_mfma_f32_16x16x32_bf16 v[140:143], v[156:159], v[72:75], v[140:143]
    v_mfma_f32_16x16x32_bf16 v[136:139], v[152:155], v[72:75], v[136:139]
    buffer_load_dwordx2 v[124:125], v5, s[36:39], s56 offen offset:3072 sc1
    ds_read_b64_tr_b16 v[144:145], v180 offset:8192
    ds_read_b64_tr_b16 v[146:147], v180 offset:10240
    ds_read_b64_tr_b16 v[148:149], v181 offset:8192
    ds_read_b64_tr_b16 v[150:151], v181 offset:10240
    s_waitcnt vmcnt(10) lgkmcnt(8)
    v_mfma_f32_16x16x32_bf16 v[132:135], v[164:167], v[76:79], v[132:135]
    v_mfma_f32_16x16x32_bf16 v[128:131], v[160:163], v[76:79], v[128:131]
    s_add_u32 s56, s53, 25088
    buffer_load_dwordx4 v[112:115], v2, s[36:39], s56 offen offset:0 sc1
    ds_read_b64_tr_b16 v[152:153], v182 offset:8192
    ds_read_b64_tr_b16 v[154:155], v182 offset:10240
    ds_read_b64_tr_b16 v[156:157], v183 offset:8192
    ds_read_b64_tr_b16 v[158:159], v183 offset:10240
    s_waitcnt lgkmcnt(8)
    v_mfma_f32_16x16x32_bf16 v[140:143], v[172:175], v[76:79], v[140:143]
    v_mfma_f32_16x16x32_bf16 v[136:139], v[168:171], v[76:79], v[136:139]
    buffer_load_dwordx4 v[116:119], v2, s[36:39], s56 offen offset:1024 sc1
    ds_read_b64_tr_b16 v[160:161], v180 offset:14336
    ds_read_b64_tr_b16 v[162:163], v180 offset:16384
    ds_read_b64_tr_b16 v[164:165], v181 offset:14336
    ds_read_b64_tr_b16 v[166:167], v181 offset:16384
    s_waitcnt vmcnt(11) lgkmcnt(8)
    v_mfma_f32_16x16x32_bf16 v[132:135], v[148:151], v[80:83], v[132:135]
    v_mfma_f32_16x16x32_bf16 v[128:131], v[144:147], v[80:83], v[128:131]
    buffer_load_dwordx4 v[120:123], v2, s[36:39], s56 offen offset:2048 sc1
    ds_read_b64_tr_b16 v[168:169], v182 offset:14336
    ds_read_b64_tr_b16 v[170:171], v182 offset:16384
    ds_read_b64_tr_b16 v[172:173], v183 offset:14336
    ds_read_b64_tr_b16 v[174:175], v183 offset:16384
    s_waitcnt lgkmcnt(8)
    v_mfma_f32_16x16x32_bf16 v[140:143], v[156:159], v[80:83], v[140:143]
    v_mfma_f32_16x16x32_bf16 v[136:139], v[152:155], v[80:83], v[136:139]
    buffer_load_dwordx2 v[126:127], v5, s[36:39], s56 offen offset:3072 sc1
    ds_read_b64_tr_b16 v[144:145], v180 offset:18432
    ds_read_b64_tr_b16 v[146:147], v180 offset:20480
    ds_read_b64_tr_b16 v[148:149], v181 offset:18432
    ds_read_b64_tr_b16 v[150:151], v181 offset:20480
    s_waitcnt vmcnt(11) lgkmcnt(8)
    v_mfma_f32_16x16x32_bf16 v[132:135], v[164:167], v[84:87], v[132:135]
    v_mfma_f32_16x16x32_bf16 v[128:131], v[160:163], v[84:87], v[128:131]
    s_add_u32 s56, s53, 0
    buffer_load_dwordx4 v[16:19], v2, s[36:39], s56 offen offset:0 sc1
    ds_read_b64_tr_b16 v[152:153], v182 offset:18432
    ds_read_b64_tr_b16 v[154:155], v182 offset:20480
    ds_read_b64_tr_b16 v[156:157], v183 offset:18432
    ds_read_b64_tr_b16 v[158:159], v183 offset:20480
    s_waitcnt lgkmcnt(8)
    v_mfma_f32_16x16x32_bf16 v[140:143], v[172:175], v[84:87], v[140:143]
    v_mfma_f32_16x16x32_bf16 v[136:139], v[168:171], v[84:87], v[136:139]
    buffer_load_dwordx4 v[20:23], v2, s[36:39], s56 offen offset:1024 sc1
    ds_read_b64_tr_b16 v[160:161], v180 offset:22528
    ds_read_b64_tr_b16 v[162:163], v180 offset:24576
    ds_read_b64_tr_b16 v[164:165], v181 offset:22528
    ds_read_b64_tr_b16 v[166:167], v181 offset:24576
    s_waitcnt vmcnt(12) lgkmcnt(8)
    v_mfma_f32_16x16x32_bf16 v[132:135], v[148:151], v[88:91], v[132:135]
    v_mfma_f32_16x16x32_bf16 v[128:131], v[144:147], v[88:91], v[128:131]
    buffer_load_dwordx4 v[24:27], v2, s[36:39], s56 offen offset:2048 sc1
    ds_read_b64_tr_b16 v[168:169], v182 offset:22528
    ds_read_b64_tr_b16 v[170:171], v182 offset:24576
    ds_read_b64_tr_b16 v[172:173], v183 offset:22528
    ds_read_b64_tr_b16 v[174:175], v183 offset:24576
    s_waitcnt lgkmcnt(8)
    v_mfma_f32_16x16x32_bf16 v[140:143], v[156:159], v[88:91], v[140:143]
    v_mfma_f32_16x16x32_bf16 v[136:139], v[152:155], v[88:91], v[136:139]
    buffer_load_dwordx2 v[40:41], v5, s[36:39], s56 offen offset:3072 sc1
    ds_read_b64_tr_b16 v[144:145], v180 offset:12288
    ds_read_b64_tr_b16 v[146:147], v180 offset:26624
    ds_read_b64_tr_b16 v[148:149], v181 offset:12288
    ds_read_b64_tr_b16 v[150:151], v181 offset:26624
    s_waitcnt vmcnt(13) lgkmcnt(8)
    v_mfma_f32_16x16x32_bf16 v[132:135], v[164:167], v[92:95], v[132:135]
    v_mfma_f32_16x16x32_bf16 v[128:131], v[160:163], v[92:95], v[128:131]
    s_add_u32 s56, s53, 3584
    buffer_load_dwordx4 v[28:31], v2, s[36:39], s56 offen offset:0 sc1
    ds_read_b64_tr_b16 v[152:153], v182 offset:12288
    ds_read_b64_tr_b16 v[154:155], v182 offset:26624
    ds_read_b64_tr_b16 v[156:157], v183 offset:12288
    ds_read_b64_tr_b16 v[158:159], v183 offset:26624
    s_waitcnt lgkmcnt(8)
    v_mfma_f32_16x16x32_bf16 v[140:143], v[172:175], v[92:95], v[140:143]
    v_mfma_f32_16x16x32_bf16 v[136:139], v[168:171], v[92:95], v[136:139]
    buffer_load_dwordx4 v[32:35], v2, s[36:39], s56 offen offset:1024 sc1
    ds_read_b64_tr_b16 v[160:161], v180 offset:28672
    ds_read_b64_tr_b16 v[162:163], v180 offset:30720
    ds_read_b64_tr_b16 v[164:165], v181 offset:28672
    ds_read_b64_tr_b16 v[166:167], v181 offset:30720
    s_waitcnt vmcnt(14) lgkmcnt(8)
    v_mfma_f32_16x16x32_bf16 v[132:135], v[148:151], v[96:99], v[132:135]
    v_mfma_f32_16x16x32_bf16 v[128:131], v[144:147], v[96:99], v[128:131]
    buffer_load_dwordx4 v[36:39], v2, s[36:39], s56 offen offset:2048 sc1
    ds_read_b64_tr_b16 v[168:169], v182 offset:28672
    ds_read_b64_tr_b16 v[170:171], v182 offset:30720
    ds_read_b64_tr_b16 v[172:173], v183 offset:28672
    ds_read_b64_tr_b16 v[174:175], v183 offset:30720
    s_waitcnt lgkmcnt(8)
    v_mfma_f32_16x16x32_bf16 v[140:143], v[156:159], v[96:99], v[140:143]
    v_mfma_f32_16x16x32_bf16 v[136:139], v[152:155], v[96:99], v[136:139]
    buffer_load_dwordx2 v[42:43], v5, s[36:39], s56 offen offset:3072 sc1
    ds_read_b64_tr_b16 v[144:145], v180 offset:32768
    ds_read_b64_tr_b16 v[146:147], v180 offset:34816
    ds_read_b64_tr_b16 v[148:149], v181 offset:32768
    ds_read_b64_tr_b16 v[150:151], v181 offset:34816
    s_waitcnt vmcnt(15) lgkmcnt(8)
    v_mfma_f32_16x16x32_bf16 v[132:135], v[164:167], v[100:103], v[132:135]
    v_mfma_f32_16x16x32_bf16 v[128:131], v[160:163], v[100:103], v[128:131]
    s_add_u32 s56, s53, 7168
    buffer_load_dwordx4 v[44:47], v2, s[36:39], s56 offen offset:0 sc1
    ds_read_b64_tr_b16 v[152:153], v182 offset:32768
    ds_read_b64_tr_b16 v[154:155], v182 offset:34816
    ds_read_b64_tr_b16 v[156:157], v183 offset:32768
    ds_read_b64_tr_b16 v[158:159], v183 offset:34816
    s_waitcnt lgkmcnt(8)
    v_mfma_f32_16x16x32_bf16 v[140:143], v[172:175], v[100:103], v[140:143]
    v_mfma_f32_16x16x32_bf16 v[136:139], v[168:171], v[100:103], v[136:139]
    buffer_load_dwordx4 v[48:51], v2, s[36:39], s56 offen offset:1024 sc1
    ds_read_b64_tr_b16 v[160:161], v180 offset:36864
    ds_read_b64_tr_b16 v[162:163], v180 offset:38912
    ds_read_b64_tr_b16 v[164:165], v181 offset:36864
    ds_read_b64_tr_b16 v[166:167], v181 offset:38912
    s_waitcnt vmcnt(16) lgkmcnt(8)
    v_mfma_f32_16x16x32_bf16 v[132:135], v[148:151], v[104:107], v[132:135]
    v_mfma_f32_16x16x32_bf16 v[128:131], v[144:147], v[104:107], v[128:131]
    buffer_load_dwordx4 v[52:55], v2, s[36:39], s56 offen offset:2048 sc1
    ds_read_b64_tr_b16 v[168:169], v182 offset:36864
    ds_read_b64_tr_b16 v[170:171], v182 offset:38912
    ds_read_b64_tr_b16 v[172:173], v183 offset:36864
    ds_read_b64_tr_b16 v[174:175], v183 offset:38912
    s_waitcnt lgkmcnt(8)
    v_mfma_f32_16x16x32_bf16 v[140:143], v[156:159], v[104:107], v[140:143]
    v_mfma_f32_16x16x32_bf16 v[136:139], v[152:155], v[104:107], v[136:139]
    buffer_load_dwordx2 v[68:69], v5, s[36:39], s56 offen offset:3072 sc1
    ds_read_b64_tr_b16 v[144:145], v180 offset:43008
    ds_read_b64_tr_b16 v[146:147], v180 offset:45056
    ds_read_b64_tr_b16 v[148:149], v181 offset:43008
    ds_read_b64_tr_b16 v[150:151], v181 offset:45056
    s_waitcnt vmcnt(17) lgkmcnt(8)
    v_mfma_f32_16x16x32_bf16 v[132:135], v[164:167], v[108:111], v[132:135]
    v_mfma_f32_16x16x32_bf16 v[128:131], v[160:163], v[108:111], v[128:131]
    s_add_u32 s56, s53, 10752
    buffer_load_dwordx4 v[56:59], v2, s[36:39], s56 offen offset:0 sc1
    ds_read_b64_tr_b16 v[152:153], v182 offset:43008
    ds_read_b64_tr_b16 v[154:155], v182 offset:45056
    ds_read_b64_tr_b16 v[156:157], v183 offset:43008
    ds_read_b64_tr_b16 v[158:159], v183 offset:45056
    s_waitcnt lgkmcnt(8)
    v_mfma_f32_16x16x32_bf16 v[140:143], v[172:175], v[108:111], v[140:143]
    v_mfma_f32_16x16x32_bf16 v[136:139], v[168:171], v[108:111], v[136:139]
    buffer_load_dwordx4 v[60:63], v2, s[36:39], s56 offen offset:1024 sc1
    ds_read_b64_tr_b16 v[160:161], v180 offset:47104
    ds_read_b64_tr_b16 v[162:163], v180 offset:49152
    ds_read_b64_tr_b16 v[164:165], v181 offset:47104
    ds_read_b64_tr_b16 v[166:167], v181 offset:49152
    s_waitcnt vmcnt(17) lgkmcnt(8)
    v_mfma_f32_16x16x32_bf16 v[132:135], v[148:151], v[112:115], v[132:135]
    v_mfma_f32_16x16x32_bf16 v[128:131], v[144:147], v[112:115], v[128:131]
    buffer_load_dwordx4 v[64:67], v2, s[36:39], s56 offen offset:2048 sc1
    ds_read_b64_tr_b16 v[168:169], v182 offset:47104
    ds_read_b64_tr_b16 v[170:171], v182 offset:49152
    ds_read_b64_tr_b16 v[172:173], v183 offset:47104
    ds_read_b64_tr_b16 v[174:175], v183 offset:49152
    s_waitcnt lgkmcnt(8)
    v_mfma_f32_16x16x32_bf16 v[140:143], v[156:159], v[112:115], v[140:143]
    v_mfma_f32_16x16x32_bf16 v[136:139], v[152:155], v[112:115], v[136:139]
    buffer_load_dwordx2 v[70:71], v5, s[36:39], s56 offen offset:3072 sc1
    ds_read_b64_tr_b16 v[144:145], v180 offset:51200
    ds_read_b64_tr_b16 v[146:147], v180 offset:53248
    ds_read_b64_tr_b16 v[148:149], v181 offset:51200
    ds_read_b64_tr_b16 v[150:151], v181 offset:53248
    s_waitcnt vmcnt(18) lgkmcnt(8)
    v_mfma_f32_16x16x32_bf16 v[132:135], v[164:167], v[116:119], v[132:135]
    v_mfma_f32_16x16x32_bf16 v[128:131], v[160:163], v[116:119], v[128:131]
    ds_read_b64_tr_b16 v[152:153], v182 offset:51200
    ds_read_b64_tr_b16 v[154:155], v182 offset:53248
    ds_read_b64_tr_b16 v[156:157], v183 offset:51200
    ds_read_b64_tr_b16 v[158:159], v183 offset:53248
    s_waitcnt lgkmcnt(8)
    v_mfma_f32_16x16x32_bf16 v[140:143], v[172:175], v[116:119], v[140:143]
    v_mfma_f32_16x16x32_bf16 v[136:139], v[168:171], v[116:119], v[136:139]
    ds_read_b64_tr_b16 v[160:161], v180 offset:40960
    ds_read_b64_tr_b16 v[162:163], v180 offset:55296
    ds_read_b64_tr_b16 v[164:165], v181 offset:40960
    ds_read_b64_tr_b16 v[166:167], v181 offset:55296
    s_waitcnt vmcnt(17) lgkmcnt(8)
    v_mfma_f32_16x16x32_bf16 v[132:135], v[148:151], v[120:123], v[132:135]
    v_mfma_f32_16x16x32_bf16 v[128:131], v[144:147], v[120:123], v[128:131]
    ds_read_b64_tr_b16 v[168:169], v182 offset:40960
    ds_read_b64_tr_b16 v[170:171], v182 offset:55296
    ds_read_b64_tr_b16 v[172:173], v183 offset:40960
    ds_read_b64_tr_b16 v[174:175], v183 offset:55296
    s_waitcnt lgkmcnt(8)
    v_mfma_f32_16x16x32_bf16 v[140:143], v[156:159], v[120:123], v[140:143]
    v_mfma_f32_16x16x32_bf16 v[136:139], v[152:155], v[120:123], v[136:139]
    s_waitcnt vmcnt(16) lgkmcnt(4)
    v_mfma_f32_16x16x32_bf16 v[132:135], v[164:167], v[124:127], v[132:135]
    v_mfma_f32_16x16x32_bf16 v[128:131], v[160:163], v[124:127], v[128:131]
    s_waitcnt lgkmcnt(0)
    v_mfma_f32_16x16x32_bf16 v[140:143], v[172:175], v[124:127], v[140:143]
    v_mfma_f32_16x16x32_bf16 v[136:139], v[168:171], v[124:127], v[136:139]
    s_waitcnt vmcnt(15)
    v_mfma_f32_16x16x32_bf16 v[128:131], a[0:3], v[16:19], v[128:131]
    v_mfma_f32_16x16x32_bf16 v[132:135], a[4:7], v[16:19], v[132:135]
    v_mfma_f32_16x16x32_bf16 v[136:139], a[8:11], v[16:19], v[136:139]
    v_mfma_f32_16x16x32_bf16 v[140:143], a[12:15], v[16:19], v[140:143]
    s_waitcnt vmcnt(14)
    v_mfma_f32_16x16x32_bf16 v[128:131], a[16:19], v[20:23], v[128:131]
    v_mfma_f32_16x16x32_bf16 v[132:135], a[20:23], v[20:23], v[132:135]
    v_mfma_f32_16x16x32_bf16 v[136:139], a[24:27], v[20:23], v[136:139]
    v_mfma_f32_16x16x32_bf16 v[140:143], a[28:31], v[20:23], v[140:143]
    s_waitcnt vmcnt(13)
    v_mfma_f32_16x16x32_bf16 v[128:131], a[32:35], v[24:27], v[128:131]
    v_mfma_f32_16x16x32_bf16 v[132:135], a[36:39], v[24:27], v[132:135]
    v_mfma_f32_16x16x32_bf16 v[136:139], a[40:43], v[24:27], v[136:139]
    v_mfma_f32_16x16x32_bf16 v[140:143], a[44:47], v[24:27], v[140:143]
    s_waitcnt vmcnt(11)
    v_mfma_f32_16x16x32_bf16 v[128:131], a[48:51], v[28:31], v[128:131]
    v_mfma_f32_16x16x32_bf16 v[132:135], a[52:55], v[28:31], v[132:135]
    v_mfma_f32_16x16x32_bf16 v[136:139], a[56:59], v[28:31], v[136:139]
    v_mfma_f32_16x16x32_bf16 v[140:143], a[60:63], v[28:31], v[140:143]
    s_waitcnt vmcnt(10)
    v_mfma_f32_16x16x32_bf16 v[128:131], a[64:67], v[32:35], v[128:131]
    v_mfma_f32_16x16x32_bf16 v[132:135], a[68:71], v[32:35], v[132:135]
    v_mfma_f32_16x16x32_bf16 v[136:139], a[72:75], v[32:35], v[136:139]
    v_mfma_f32_16x16x32_bf16 v[140:143], a[76:79], v[32:35], v[140:143]
    s_waitcnt vmcnt(9)
    v_mfma_f32_16x16x32_bf16 v[128:131], a[80:83], v[36:39], v[128:131]
    v_mfma_f32_16x16x32_bf16 v[132:135], a[84:87], v[36:39], v[132:135]
    v_mfma_f32_16x16x32_bf16 v[136:139], a[88:91], v[36:39], v[136:139]
    v_mfma_f32_16x16x32_bf16 v[140:143], a[92:95], v[36:39], v[140:143]
    s_waitcnt vmcnt(8)
    v_mfma_f32_16x16x32_bf16 v[128:131], a[96:99], v[40:43], v[128:131]
    v_mfma_f32_16x16x32_bf16 v[132:135], a[100:103], v[40:43], v[132:135]
    v_mfma_f32_16x16x32_bf16 v[136:139], a[104:107], v[40:43], v[136:139]
    v_mfma_f32_16x16x32_bf16 v[140:143], a[108:111], v[40:43], v[140:143]
    s_waitcnt vmcnt(7)
    v_mfma_f32_16x16x32_bf16 v[128:131], a[112:115], v[44:47], v[128:131]
    v_mfma_f32_16x16x32_bf16 v[132:135], a[116:119], v[44:47], v[132:135]
    v_mfma_f32_16x16x32_bf16 v[136:139], a[120:123], v[44:47], v[136:139]
    v_mfma_f32_16x16x32_bf16 v[140:143], a[124:127], v[44:47], v[140:143]
    s_waitcnt vmcnt(6)
    v_mfma_f32_16x16x32_bf16 v[128:131], a[128:131], v[48:51], v[128:131]
    v_mfma_f32_16x16x32_bf16 v[132:135], a[132:135], v[48:51], v[132:135]
    v_mfma_f32_16x16x32_bf16 v[136:139], a[136:139], v[48:51], v[136:139]
    v_mfma_f32_16x16x32_bf16 v[140:143], a[140:143], v[48:51], v[140:143]
    s_waitcnt vmcnt(5)
    v_mfma_f32_16x16x32_bf16 v[128:131], a[144:147], v[52:55], v[128:131]
    v_mfma_f32_16x16x32_bf16 v[132:135], a[148:151], v[52:55], v[132:135]
    v_mfma_f32_16x16x32_bf16 v[136:139], a[152:155], v[52:55], v[136:139]
    v_mfma_f32_16x16x32_bf16 v[140:143], a[156:159], v[52:55], v[140:143]
    s_waitcnt vmcnt(3)
    v_mfma_f32_16x16x32_bf16 v[128:131], a[160:163], v[56:59], v[128:131]
    v_mfma_f32_16x16x32_bf16 v[132:135], a[164:167], v[56:59], v[132:135]
    v_mfma_f32_16x16x32_bf16 v[136:139], a[168:171], v[56:59], v[136:139]
    v_mfma_f32_16x16x32_bf16 v[140:143], a[172:175], v[56:59], v[140:143]
    s_waitcnt vmcnt(2)
    v_mfma_f32_16x16x32_bf16 v[128:131], a[176:179], v[60:63], v[128:131]
    v_mfma_f32_16x16x32_bf16 v[132:135], a[180:183], v[60:63], v[132:135]
    v_mfma_f32_16x16x32_bf16 v[136:139], a[184:187], v[60:63], v[136:139]
    v_mfma_f32_16x16x32_bf16 v[140:143], a[188:191], v[60:63], v[140:143]
    s_waitcnt vmcnt(1)
    v_mfma_f32_16x16x32_bf16 v[128:131], a[192:195], v[64:67], v[128:131]
    v_mfma_f32_16x16x32_bf16 v[132:135], a[196:199], v[64:67], v[132:135]
    v_mfma_f32_16x16x32_bf16 v[136:139], a[200:203], v[64:67], v[136:139]
    v_mfma_f32_16x16x32_bf16 v[140:143], a[204:207], v[64:67], v[140:143]
    s_waitcnt vmcnt(0)
    v_mfma_f32_16x16x32_bf16 v[128:131], a[208:211], v[68:71], v[128:131]
    v_mfma_f32_16x16x32_bf16 v[132:135], a[212:215], v[68:71], v[132:135]
    v_mfma_f32_16x16x32_bf16 v[136:139], a[216:219], v[68:71], v[136:139]
    v_mfma_f32_16x16x32_bf16 v[140:143], a[220:223], v[68:71], v[140:143]
    s_nop 4
    v_cvt_pk_bf16_f32 v40, v128, v129
    v_cvt_pk_bf16_f32 v41, v130, v131
    v_cvt_pk_bf16_f32 v42, v132, v133
    v_cvt_pk_bf16_f32 v43, v134, v135
    s_nop 0
    v_permlane16_swap_b32 v40, v42
    v_permlane16_swap_b32 v41, v43
    buffer_store_dwordx4 v[40:43], v184, s[32:35], s55 offen offset:0
    v_cvt_pk_bf16_f32 v44, v136, v137
    v_cvt_pk_bf16_f32 v45, v138, v139
    v_cvt_pk_bf16_f32 v46, v140, v141
    v_cvt_pk_bf16_f32 v47, v142, v143
    s_nop 0
    v_permlane16_swap_b32 v44, v46
    v_permlane16_swap_b32 v45, v47
    buffer_store_dwordx4 v[44:47], v184, s[32:35], s55 offen offset:64
L_fin:
L_end:
    s_endpgm
.section .rodata,"a"
.p2align 6
.amdhsa_kernel sequential_preLN__softmax_full_mha__mixer_gmlp__prompt_kernel
  .amdhsa_next_free_vgpr 512
  .amdhsa_next_free_sgpr 102
  .amdhsa_accum_offset 256
  .amdhsa_group_segment_fixed_size 0
  .amdhsa_kernarg_size 88
  .amdhsa_user_sgpr_count 2
  .amdhsa_user_sgpr_kernarg_segment_ptr 1
  .amdhsa_system_sgpr_workgroup_id_x 1
  .amdhsa_float_denorm_mode_32 3
.end_amdhsa_kernel
```
